```python
import torch

def _softmax(x, axis=-1):
    return torch.softmax(x, dim=axis)

def _gelu(x):
    return torch.nn.functional.gelu(x, approximate='tanh')

def _silu(x):
    return torch.nn.functional.silu(x)

def _sigmoid(x):
    return torch.sigmoid(x)

def _layernorm(x, axis=-1, eps=1e-05):
    m = x.mean(dim=axis, keepdim=True)
    v = x.var(dim=axis, keepdim=True, unbiased=False)
    return (x - m) / torch.sqrt(v + eps)

def _scatter_add(tgt, idx, src, axis=0):
    return tgt.clone().index_add_(axis, idx, src)

def _segment_sum(src, seg, n):
    out = torch.zeros((n,) + src.shape[1:], dtype=src.dtype)
    return out.index_add_(0, seg, src)

def _pad(x, pw):
    flat = tuple((v for pair in reversed(pw) for v in pair))
    return torch.nn.functional.pad(x, flat)
kernel_name = 'standalone__conformer_family_zipformer__speech'

def setup_inputs():

    _w = lambda a: (lambda t: t.to(torch.bfloat16) if t.is_floating_point() else t)(torch.as_tensor(a))
    B, T, D, K, H = (2, 4000, 256, 15, 4)
    sc = 0.1
    return {'x': _w((lambda *s: torch.randn(*s, dtype=torch.bfloat16) * 0.8)(B, T, D)), 'w_ff1a': _w((lambda *s: torch.randn(*s, dtype=torch.bfloat16) * 0.8)(D, 4 * D) * sc), 'w_ff1b': _w((lambda *s: torch.randn(*s, dtype=torch.bfloat16) * 0.8)(4 * D, D) * sc), 'w_qkv': _w((lambda *s: torch.randn(*s, dtype=torch.bfloat16) * 0.8)(D, 3 * D) * sc), 'w_o': _w((lambda *s: torch.randn(*s, dtype=torch.bfloat16) * 1.6)(D, D) * sc), 'w_pw1': _w((lambda *s: torch.randn(*s, dtype=torch.bfloat16) * 1.6)(D, 2 * D) * sc), 'dw': _w((lambda *s: torch.randn(*s, dtype=torch.bfloat16) * 0.4)(K, D)), 'w_pw2': _w((lambda *s: torch.randn(*s, dtype=torch.bfloat16) * 0.4)(D, D) * sc), 'w_ff2a': _w((lambda *s: torch.randn(*s, dtype=torch.bfloat16) * 0.8)(D, 4 * D) * sc), 'w_ff2b': _w((lambda *s: torch.randn(*s, dtype=torch.bfloat16) * 0.8)(4 * D, D) * sc)}

def reference(x, w_ff1a, w_ff1b, w_qkv, w_o, w_pw1, dw, w_pw2, w_ff2a, w_ff2b):
    B, T, D = x.shape
    K = dw.shape[0]
    H = 4
    Dh = D // H
    h = _layernorm(x, axis=-1)
    h = _silu(h @ w_ff1a) @ w_ff1b
    x = x + 0.5 * h
    h = _layernorm(x, axis=-1)
    qkv = h @ w_qkv
    q = (lambda x, *d: x.permute(*d))(qkv[..., :D].reshape(B, T, H, Dh), 0, 2, 1, 3)
    k = (lambda x, *d: x.permute(*d))(qkv[..., D:2 * D].reshape(B, T, H, Dh), 0, 2, 1, 3)
    v = (lambda x, *d: x.permute(*d))(qkv[..., 2 * D:].reshape(B, T, H, Dh), 0, 2, 1, 3)
    scale = Dh ** (-0.5)
    scores = torch.einsum('bhqd,bhkd->bhqk', q, k) * scale
    p = _softmax(scores, axis=-1)
    att = torch.einsum('bhqk,bhkd->bhqd', p, v)
    att = (lambda x, *d: x.permute(*d))(att, 0, 2, 1, 3).reshape(B, T, D)
    x = x + att @ w_o
    h = _layernorm(x, axis=-1)
    h = h @ w_pw1
    a, b = (h[..., :D].clone(), h[..., D:].clone())
    h = a * _sigmoid(b)
    pad = K // 2
    hp = _pad(h, ((0, 0), (pad, pad), (0, 0)))
    c = torch.zeros_like(h)
    for i in range(K):
        c = c + hp[:, i:i + T, :] * dw[i][None, None, :]
    x = x + _silu(c) @ w_pw2
    h = _layernorm(x, axis=-1)
    h = _silu(h @ w_ff2a) @ w_ff2b
    x = x + 0.5 * h
    return _layernorm(x, axis=-1)
```

```asm
; @launch kernel=zf_a_kernel grid=(256,1,1) block=(256,1,1) lds=163840
; @launch kernel=standalone__conformer_family_zipformer__speech_kernel grid=(256,1,1) block=(256,1,1) lds=125184
.amdgcn_target "amdgcn-amd-amdhsa--gfx950"
.text
.globl zf_a_kernel
.p2align 8
.type zf_a_kernel,@function
zf_a_kernel:
  s_cmp_ge_u32 s2, 256
  s_cbranch_scc1 A_exit
  s_load_dwordx8 s[36:43], s[0:1], 0
  s_load_dwordx2 s[44:45], s[0:1], 96
  v_lshrrev_b32 v1, 6, v0
  v_and_b32 v0, 63, v0
  v_readfirstlane_b32 s24, v1
  v_lshlrev_b32 v1, 4, v0
  s_lshr_b32 s28, s2, 4
  s_lshl_b32 s28, s28, 3
  s_and_b32 s29, s2, 7
  s_add_u32 s29, s29, s28
  s_bfe_u32 s30, s2, 0x10003
  s_mov_b32 s27, 0xffff0000
  s_lshr_b32 s52, s2, 3
  s_mul_i32 s53, s52, 12288
  s_lshl_b32 s52, s52, 14
  s_lshl_b32 s28, s24, 12
  s_add_u32 s52, s52, s28
  s_add_u32 s53, s53, s28
  v_lshlrev_b32 v61, 7, v0
  s_cmp_ge_u32 s29, 125
  s_cbranch_scc1 A_tr
  v_lshrrev_b32 v62, 3, v0
  v_and_b32 v63, 7, v0
  s_lshl_b32 s28, s24, 13
  v_lshl_add_u32 v26, v62, 9, s28
  v_lshl_add_u32 v26, v63, 4, v26
  s_lshl_b32 s47, s29, 15
  s_add_u32 s48, s47, 0x1000
  v_bfe_u32 v59, v0, 4, 1
  v_lshlrev_b32 v59, 2, v59
  v_xor_b32 v59, v59, v63
  v_lshlrev_b32 v59, 4, v59
  s_lshl_b32 s28, s30, 2
  s_add_u32 s28, s28, s24
  s_lshl_b32 s28, s28, 8
  v_lshl_add_u32 v2, v62, 11, v59
  v_add_u32 v2, s28, v2
  v_add_u32 v3, 15360, v2
  v_add_u32 v4, 30720, v2
  v_add_u32 v5, 46080, v2
  s_mul_i32 s28, s24, 24576
  s_add_u32 s54, s28, 65536
  s_add_u32 s55, s28, 69632
  s_add_u32 s56, s28, 73728
  s_add_u32 s57, s28, 77824
  s_add_u32 s58, s28, 81920
  s_add_u32 s59, s28, 86016
  s_lshl_b32 s51, s29, 8
  s_add_u32 s51, s51, 0x1e00000
  s_waitcnt lgkmcnt(0)
  s_mov_b32 s4, s36
  s_mov_b32 s5, s37
  s_mov_b32 s6, 0x3e8000
  s_mov_b32 s7, 0x20000
  buffer_load_dwordx4 v[128:131], v26, s[4:7], s47 offen offset:0
  buffer_load_dwordx4 v[132:135], v26, s[4:7], s47 offen offset:128
  buffer_load_dwordx4 v[136:139], v26, s[4:7], s47 offen offset:256
  buffer_load_dwordx4 v[140:143], v26, s[4:7], s47 offen offset:384
  s_mov_b32 s8, s38
  s_mov_b32 s9, s39
  s_mov_b32 s10, 0x80000
  s_mov_b32 s11, 0x20000
  s_mov_b32 s20, s44
  s_mov_b32 s21, s45
  s_mov_b32 s22, 0x2b00000
  s_mov_b32 s23, 0x20000
  s_barrier
  buffer_load_dwordx4 v[144:147], v26, s[4:7], s48 offen offset:0
  buffer_load_dwordx4 v[148:151], v26, s[4:7], s48 offen offset:128
  buffer_load_dwordx4 v[152:155], v26, s[4:7], s48 offen offset:256
  buffer_load_dwordx4 v[156:159], v26, s[4:7], s48 offen offset:384
  s_barrier
  v_lshlrev_b32 v27, 8, v0
  s_mov_b64 exec, 0xffff
  buffer_load_dword v58, v27, s[8:11], s52 offen offset:0
  s_mov_b64 exec, -1
  buffer_load_dword v43, off, s[20:23], s51
  s_getpc_b64 s[62:63]
pc_zf_a_kernel:
  s_sub_u32 s62, s62, pc_zf_a_kernel-zf_a_kernel
  s_subb_u32 s63, s63, 0
  s_lshr_b32 s64, s2, 3
  s_mul_i32 s64, s64, 896
  v_lshlrev_b32 v57, 7, v0
  v_add_u32 v57, s64, v57
  v_min_u32 v57, end_zf_a_kernel-zf_a_kernel-4, v57
  s_cmp_eq_u32 s24, 0
  s_cselect_b32 s64, 0x7f, 1
  s_mov_b32 exec_lo, s64
  s_mov_b32 exec_hi, 0
  global_load_dword v56, v57, s[62:63]
  s_mov_b64 exec, -1
  s_mov_b32 s12, s40
  s_mov_b32 s13, s41
  s_mov_b32 s14, 0x80000
  s_mov_b32 s15, 0x20000
  s_mov_b32 s16, s42
  s_mov_b32 s17, s43
  s_mov_b32 s18, 0x60000
  s_mov_b32 s19, 0x20000
  s_lshl_b32 s28, s30, 11
  s_add_u32 s28, s28, s24
  s_lshl_b32 s28, s28, 7
  v_lshl_add_u32 v6, v62, 9, v59
  v_add_u32 v6, s28, v6
  v_add_u32 v7, 3072, v6
  v_add_u32 v8, 6144, v6
  v_add_u32 v9, 9216, v6
  s_lshl_b32 s28, s24, 7
  v_mul_u32_u24 v10, 1536, v62
  v_add3_u32 v10, v10, v59, s28
  v_add_u32 v11, 11264, v10
  v_add_u32 v12, 22528, v10
  v_add_u32 v13, 33792, v10
  v_bfe_u32 v28, v0, 2, 2
  v_lshlrev_b32 v28, 7, v28
  v_add_u32 v28, s54, v28
  v_bfe_u32 v29, v0, 3, 1
  v_lshlrev_b32 v29, 6, v29
  v_bfe_u32 v30, v0, 4, 1
  v_lshrrev_b32 v31, 5, v0
  v_and_b32 v32, 3, v0
  v_lshlrev_b32 v33, 3, v32
  v_lshl_add_u32 v33, v30, 5, v33
  v_add3_u32 v33, v33, v29, v28
  v_lshl_add_u32 v14, v31, 10, v33
  v_xor_b32 v15, 64, v14
  v_lshl_add_u32 v16, v31, 9, v33
  v_xor_b32 v17, 64, v16
  v_lshlrev_b32 v33, 4, v32
  v_lshl_add_u32 v33, v30, 6, v33
  v_xor_b32 v33, v33, v29
  v_add_u32 v33, v33, v28
  v_lshl_add_u32 v18, v31, 9, v33
  s_lshr_b32 s28, s24, 1
  s_xor_b32 s28, s28, s30
  s_mul_i32 s28, s28, 16896
  s_and_b32 s46, s24, 1
  s_lshl_b32 s46, s46, 8
  s_add_u32 s28, s28, s46
  s_add_u32 s28, s28, 31744
  v_mul_u32_u24 v19, 528, v63
  v_lshl_add_u32 v19, v62, 4, v19
  v_add_u32 v19, s28, v19
  v_lshlrev_b32 v20, 4, v31
  v_add_u32 v20, v20, v1
  s_mov_b32 s33, 0xc038aa3b
  s_mov_b32 s34, 0x3727c5ac
  s_mov_b32 s46, 0
  s_lshl_b32 s31, s29, 1
  s_add_u32 s31, s31, s30
  s_lshl_b32 s28, s24, 13
  v_add_u32 v21, s28, v1
  s_lshl_b32 s28, s24, 12
  s_add_u32 s28, s28, 16384
  v_add_u32 v24, s28, v1
  v_and_b32 v32, 31, v0
  v_mul_u32_u24 v23, 48, v32
  s_lshl_b32 s28, s24, 3
  v_lshl_add_u32 v22, v31, 2, v23
  v_add_u32 v22, s28, v22
  v_and_b32 v33, 3, v0
  v_lshlrev_b32 v33, 7, v33
  v_bfe_u32 v34, v0, 2, 3
  v_lshl_add_u32 v33, v34, 4, v33
  v_lshl_add_u32 v25, v31, 9, v33
  s_lshl_b32 s28, s24, 7
  v_lshrrev_b32 v33, 3, v0
  v_xor_b32 v34, v33, v0
  v_and_b32 v34, 7, v34
  v_lshlrev_b32 v33, 9, v33
  v_lshl_add_u32 v33, v34, 4, v33
  v_add_u32 v26, s28, v33
  s_lshl_b32 s47, s31, 14
  s_lshl_b32 s28, s24, 12
  s_add_u32 s28, s28, s47
  s_add_u32 s62, s28, 0xc00000
  s_add_u32 s66, s28, 0x1000000
  s_lshl_b32 s28, s28, 1
  s_add_u32 s49, s28, 0x1600000
  s_xor_b32 s28, s28, 0x8000
  s_add_u32 s50, s28, 0x1600000
  s_cmp_ge_u32 s31, 125
  s_cselect_b32 s28, 375, 0
  s_add_u32 s28, s28, s31
  s_mul_i32 s63, s24, 125
  s_add_u32 s28, s28, s63
  s_lshl_b32 s63, s28, 12
  s_add_u32 s63, s63, 0x800000
  s_lshl_b32 s64, s28, 13
  s_add_u32 s65, s64, 0x1000
  s_or_b32 s28, s30, s24
  v_or_b32 v33, s28, v0
  v_cmp_eq_u32 vcc, 0, v33
  v_mov_b32 v33, 0x80000000
  v_mov_b32 v34, s51
  v_cndmask_b32 v60, v33, v34, vcc
  s_waitcnt vmcnt(10)
  v_lshlrev_b32 v64, 16, v128
  v_and_b32 v65, s27, v128
  v_lshlrev_b32 v66, 16, v129
  v_and_b32 v67, s27, v129
  v_lshlrev_b32 v68, 16, v130
  v_and_b32 v69, s27, v130
  v_lshlrev_b32 v70, 16, v131
  v_and_b32 v71, s27, v131
  v_pk_add_f32 v[28:29], v[64:65], v[66:67]
  v_pk_mul_f32 v[30:31], v[64:65], v[64:65]
  v_pk_fma_f32 v[30:31], v[66:67], v[66:67], v[30:31]
  v_pk_add_f32 v[28:29], v[28:29], v[68:69]
  v_pk_fma_f32 v[30:31], v[68:69], v[68:69], v[30:31]
  v_pk_add_f32 v[28:29], v[28:29], v[70:71]
  v_pk_fma_f32 v[30:31], v[70:71], v[70:71], v[30:31]
  s_waitcnt vmcnt(9)
  v_lshlrev_b32 v72, 16, v132
  v_and_b32 v73, s27, v132
  v_lshlrev_b32 v74, 16, v133
  v_and_b32 v75, s27, v133
  v_lshlrev_b32 v76, 16, v134
  v_and_b32 v77, s27, v134
  v_lshlrev_b32 v78, 16, v135
  v_and_b32 v79, s27, v135
  v_pk_add_f32 v[28:29], v[28:29], v[72:73]
  v_pk_fma_f32 v[30:31], v[72:73], v[72:73], v[30:31]
  v_pk_add_f32 v[28:29], v[28:29], v[74:75]
  v_pk_fma_f32 v[30:31], v[74:75], v[74:75], v[30:31]
  v_pk_add_f32 v[28:29], v[28:29], v[76:77]
  v_pk_fma_f32 v[30:31], v[76:77], v[76:77], v[30:31]
  v_pk_add_f32 v[28:29], v[28:29], v[78:79]
  v_pk_fma_f32 v[30:31], v[78:79], v[78:79], v[30:31]
  s_waitcnt vmcnt(8)
  v_lshlrev_b32 v80, 16, v136
  v_and_b32 v81, s27, v136
  v_lshlrev_b32 v82, 16, v137
  v_and_b32 v83, s27, v137
  v_lshlrev_b32 v84, 16, v138
  v_and_b32 v85, s27, v138
  v_lshlrev_b32 v86, 16, v139
  v_and_b32 v87, s27, v139
  v_pk_add_f32 v[28:29], v[28:29], v[80:81]
  v_pk_fma_f32 v[30:31], v[80:81], v[80:81], v[30:31]
  v_pk_add_f32 v[28:29], v[28:29], v[82:83]
  v_pk_fma_f32 v[30:31], v[82:83], v[82:83], v[30:31]
  v_pk_add_f32 v[28:29], v[28:29], v[84:85]
  v_pk_fma_f32 v[30:31], v[84:85], v[84:85], v[30:31]
  v_pk_add_f32 v[28:29], v[28:29], v[86:87]
  v_pk_fma_f32 v[30:31], v[86:87], v[86:87], v[30:31]
  s_waitcnt vmcnt(7)
  v_lshlrev_b32 v88, 16, v140
  v_and_b32 v89, s27, v140
  v_lshlrev_b32 v90, 16, v141
  v_and_b32 v91, s27, v141
  v_lshlrev_b32 v92, 16, v142
  v_and_b32 v93, s27, v142
  v_lshlrev_b32 v94, 16, v143
  v_and_b32 v95, s27, v143
  v_pk_add_f32 v[28:29], v[28:29], v[88:89]
  v_pk_fma_f32 v[30:31], v[88:89], v[88:89], v[30:31]
  v_pk_add_f32 v[28:29], v[28:29], v[90:91]
  v_pk_fma_f32 v[30:31], v[90:91], v[90:91], v[30:31]
  v_pk_add_f32 v[28:29], v[28:29], v[92:93]
  v_pk_fma_f32 v[30:31], v[92:93], v[92:93], v[30:31]
  v_pk_add_f32 v[28:29], v[28:29], v[94:95]
  v_pk_fma_f32 v[30:31], v[94:95], v[94:95], v[30:31]
  v_add_f32 v28, v28, v29
  v_add_f32 v30, v30, v31
  s_mov_b32 m0, s54
  s_mov_b32 s32, 0x0
  buffer_load_dwordx4 v2, s[8:11], s32 offen offset:0 lds
  buffer_load_dwordx4 v3, s[8:11], s32 offen offset:1024 lds
  s_mov_b64 exec, 0xffff
  buffer_load_dword v63, v27, s[8:11], s52 offen offset:128
  s_mov_b64 exec, -1
  v_add_f32_dpp v28, v28, v28 quad_perm:[1,0,3,2] row_mask:0xf bank_mask:0xf
  v_add_f32_dpp v30, v30, v30 quad_perm:[1,0,3,2] row_mask:0xf bank_mask:0xf
  s_nop 0
  v_add_f32_dpp v28, v28, v28 quad_perm:[2,3,0,1] row_mask:0xf bank_mask:0xf
  v_add_f32_dpp v30, v30, v30 quad_perm:[2,3,0,1] row_mask:0xf bank_mask:0xf
  s_nop 0
  v_add_f32_dpp v28, v28, v28 row_half_mirror row_mask:0xf bank_mask:0xf
  v_add_f32_dpp v30, v30, v30 row_half_mirror row_mask:0xf bank_mask:0xf
  v_mul_f32 v28, 0x3b800000, v28
  buffer_load_dwordx4 v4, s[8:11], s32 offen offset:2048 lds
  v_mul_f32 v30, 0x3b800000, v30
  v_fma_f32 v30, -v28, v28, v30
  v_max_f32 v30, 0, v30
  v_add_f32 v30, s34, v30
  v_rsq_f32 v29, v30
  v_mul_f32 v28, 0x3fb8aa3b, v28
  v_mul_f32 v28, v28, v29
  v_mul_f32 v29, 0xbfb8aa3b, v29
  v_pk_fma_f32 v[64:65], v[64:65], v[28:29], v[28:29] op_sel:[0,1,0] op_sel_hi:[1,1,0]
  v_pk_fma_f32 v[66:67], v[66:67], v[28:29], v[28:29] op_sel:[0,1,0] op_sel_hi:[1,1,0]
  buffer_load_dwordx4 v5, s[8:11], s32 offen offset:3072 lds
  v_pk_fma_f32 v[68:69], v[68:69], v[28:29], v[28:29] op_sel:[0,1,0] op_sel_hi:[1,1,0]
  v_pk_fma_f32 v[70:71], v[70:71], v[28:29], v[28:29] op_sel:[0,1,0] op_sel_hi:[1,1,0]
  v_cvt_pk_bf16_f32 v128, v64, v65
  v_cvt_pk_bf16_f32 v129, v66, v67
  v_cvt_pk_bf16_f32 v130, v68, v69
  v_cvt_pk_bf16_f32 v131, v70, v71
  v_pk_fma_f32 v[72:73], v[72:73], v[28:29], v[28:29] op_sel:[0,1,0] op_sel_hi:[1,1,0]
  v_pk_fma_f32 v[74:75], v[74:75], v[28:29], v[28:29] op_sel:[0,1,0] op_sel_hi:[1,1,0]
  v_pk_fma_f32 v[76:77], v[76:77], v[28:29], v[28:29] op_sel:[0,1,0] op_sel_hi:[1,1,0]
  v_pk_fma_f32 v[78:79], v[78:79], v[28:29], v[28:29] op_sel:[0,1,0] op_sel_hi:[1,1,0]
  s_mov_b32 m0, s55
  s_mov_b32 s32, 0x10000
  buffer_load_dwordx4 v2, s[8:11], s32 offen offset:0 lds
  v_cvt_pk_bf16_f32 v132, v72, v73
  v_cvt_pk_bf16_f32 v133, v74, v75
  v_cvt_pk_bf16_f32 v134, v76, v77
  v_cvt_pk_bf16_f32 v135, v78, v79
  v_pk_fma_f32 v[80:81], v[80:81], v[28:29], v[28:29] op_sel:[0,1,0] op_sel_hi:[1,1,0]
  v_pk_fma_f32 v[82:83], v[82:83], v[28:29], v[28:29] op_sel:[0,1,0] op_sel_hi:[1,1,0]
  v_pk_fma_f32 v[84:85], v[84:85], v[28:29], v[28:29] op_sel:[0,1,0] op_sel_hi:[1,1,0]
  v_pk_fma_f32 v[86:87], v[86:87], v[28:29], v[28:29] op_sel:[0,1,0] op_sel_hi:[1,1,0]
  v_cvt_pk_bf16_f32 v136, v80, v81
  v_cvt_pk_bf16_f32 v137, v82, v83
  buffer_load_dwordx4 v3, s[8:11], s32 offen offset:1024 lds
  v_cvt_pk_bf16_f32 v138, v84, v85
  v_cvt_pk_bf16_f32 v139, v86, v87
  v_pk_fma_f32 v[88:89], v[88:89], v[28:29], v[28:29] op_sel:[0,1,0] op_sel_hi:[1,1,0]
  v_pk_fma_f32 v[90:91], v[90:91], v[28:29], v[28:29] op_sel:[0,1,0] op_sel_hi:[1,1,0]
  v_pk_fma_f32 v[92:93], v[92:93], v[28:29], v[28:29] op_sel:[0,1,0] op_sel_hi:[1,1,0]
  v_pk_fma_f32 v[94:95], v[94:95], v[28:29], v[28:29] op_sel:[0,1,0] op_sel_hi:[1,1,0]
  v_cvt_pk_bf16_f32 v140, v88, v89
  v_cvt_pk_bf16_f32 v141, v90, v91
  v_cvt_pk_bf16_f32 v142, v92, v93
  v_cvt_pk_bf16_f32 v143, v94, v95
  s_waitcnt vmcnt(13)
  v_lshlrev_b32 v96, 16, v144
  v_and_b32 v97, s27, v144
  v_lshlrev_b32 v98, 16, v145
  v_and_b32 v99, s27, v145
  v_lshlrev_b32 v100, 16, v146
  v_and_b32 v101, s27, v146
  v_lshlrev_b32 v102, 16, v147
  v_and_b32 v103, s27, v147
  v_pk_add_f32 v[32:33], v[96:97], v[98:99]
  v_pk_mul_f32 v[34:35], v[96:97], v[96:97]
  v_pk_fma_f32 v[34:35], v[98:99], v[98:99], v[34:35]
  v_pk_add_f32 v[32:33], v[32:33], v[100:101]
  v_pk_fma_f32 v[34:35], v[100:101], v[100:101], v[34:35]
  v_pk_add_f32 v[32:33], v[32:33], v[102:103]
  v_pk_fma_f32 v[34:35], v[102:103], v[102:103], v[34:35]
  s_waitcnt vmcnt(12)
  v_lshlrev_b32 v104, 16, v148
  v_and_b32 v105, s27, v148
  v_lshlrev_b32 v106, 16, v149
  v_and_b32 v107, s27, v149
  v_lshlrev_b32 v108, 16, v150
  v_and_b32 v109, s27, v150
  v_lshlrev_b32 v110, 16, v151
  v_and_b32 v111, s27, v151
  v_pk_add_f32 v[32:33], v[32:33], v[104:105]
  v_pk_fma_f32 v[34:35], v[104:105], v[104:105], v[34:35]
  v_pk_add_f32 v[32:33], v[32:33], v[106:107]
  v_pk_fma_f32 v[34:35], v[106:107], v[106:107], v[34:35]
  v_pk_add_f32 v[32:33], v[32:33], v[108:109]
  v_pk_fma_f32 v[34:35], v[108:109], v[108:109], v[34:35]
  v_pk_add_f32 v[32:33], v[32:33], v[110:111]
  v_pk_fma_f32 v[34:35], v[110:111], v[110:111], v[34:35]
  s_waitcnt vmcnt(11)
  v_lshlrev_b32 v112, 16, v152
  v_and_b32 v113, s27, v152
  v_lshlrev_b32 v114, 16, v153
  v_and_b32 v115, s27, v153
  v_lshlrev_b32 v116, 16, v154
  v_and_b32 v117, s27, v154
  v_lshlrev_b32 v118, 16, v155
  v_and_b32 v119, s27, v155
  v_pk_add_f32 v[32:33], v[32:33], v[112:113]
  v_pk_fma_f32 v[34:35], v[112:113], v[112:113], v[34:35]
  v_pk_add_f32 v[32:33], v[32:33], v[114:115]
  v_pk_fma_f32 v[34:35], v[114:115], v[114:115], v[34:35]
  v_pk_add_f32 v[32:33], v[32:33], v[116:117]
  v_pk_fma_f32 v[34:35], v[116:117], v[116:117], v[34:35]
  v_pk_add_f32 v[32:33], v[32:33], v[118:119]
  v_pk_fma_f32 v[34:35], v[118:119], v[118:119], v[34:35]
  s_waitcnt vmcnt(10)
  v_lshlrev_b32 v120, 16, v156
  v_and_b32 v121, s27, v156
  v_lshlrev_b32 v122, 16, v157
  v_and_b32 v123, s27, v157
  v_lshlrev_b32 v124, 16, v158
  v_and_b32 v125, s27, v158
  v_lshlrev_b32 v126, 16, v159
  v_and_b32 v127, s27, v159
  v_pk_add_f32 v[32:33], v[32:33], v[120:121]
  v_pk_fma_f32 v[34:35], v[120:121], v[120:121], v[34:35]
  v_pk_add_f32 v[32:33], v[32:33], v[122:123]
  v_pk_fma_f32 v[34:35], v[122:123], v[122:123], v[34:35]
  v_pk_add_f32 v[32:33], v[32:33], v[124:125]
  v_pk_fma_f32 v[34:35], v[124:125], v[124:125], v[34:35]
  v_pk_add_f32 v[32:33], v[32:33], v[126:127]
  v_pk_fma_f32 v[34:35], v[126:127], v[126:127], v[34:35]
  v_add_f32 v32, v32, v33
  v_add_f32 v34, v34, v35
  s_nop 0
  v_add_f32_dpp v32, v32, v32 quad_perm:[1,0,3,2] row_mask:0xf bank_mask:0xf
  v_add_f32_dpp v34, v34, v34 quad_perm:[1,0,3,2] row_mask:0xf bank_mask:0xf
  s_nop 0
  v_add_f32_dpp v32, v32, v32 quad_perm:[2,3,0,1] row_mask:0xf bank_mask:0xf
  v_add_f32_dpp v34, v34, v34 quad_perm:[2,3,0,1] row_mask:0xf bank_mask:0xf
  s_nop 0
  v_add_f32_dpp v32, v32, v32 row_half_mirror row_mask:0xf bank_mask:0xf
  v_add_f32_dpp v34, v34, v34 row_half_mirror row_mask:0xf bank_mask:0xf
  v_mul_f32 v32, 0x3b800000, v32
  v_mul_f32 v34, 0x3b800000, v34
  v_fma_f32 v34, -v32, v32, v34
  v_max_f32 v34, 0, v34
  v_add_f32 v34, s34, v34
  v_rsq_f32 v33, v34
  v_mul_f32 v32, 0x3fb8aa3b, v32
  v_mul_f32 v32, v32, v33
  v_mul_f32 v33, 0xbfb8aa3b, v33
  s_mov_b32 exec_hi, 0
  buffer_load_dword v63, v61, s[12:15], s52 offen
  s_mov_b32 exec_hi, -1
  v_pk_fma_f32 v[96:97], v[96:97], v[32:33], v[32:33] op_sel:[0,1,0] op_sel_hi:[1,1,0]
  v_pk_fma_f32 v[98:99], v[98:99], v[32:33], v[32:33] op_sel:[0,1,0] op_sel_hi:[1,1,0]
  v_pk_fma_f32 v[100:101], v[100:101], v[32:33], v[32:33] op_sel:[0,1,0] op_sel_hi:[1,1,0]
  v_pk_fma_f32 v[102:103], v[102:103], v[32:33], v[32:33] op_sel:[0,1,0] op_sel_hi:[1,1,0]
  v_cvt_pk_bf16_f32 v144, v96, v97
  v_cvt_pk_bf16_f32 v145, v98, v99
  v_cvt_pk_bf16_f32 v146, v100, v101
  v_cvt_pk_bf16_f32 v147, v102, v103
  v_pk_fma_f32 v[104:105], v[104:105], v[32:33], v[32:33] op_sel:[0,1,0] op_sel_hi:[1,1,0]
  v_pk_fma_f32 v[106:107], v[106:107], v[32:33], v[32:33] op_sel:[0,1,0] op_sel_hi:[1,1,0]
  v_pk_fma_f32 v[108:109], v[108:109], v[32:33], v[32:33] op_sel:[0,1,0] op_sel_hi:[1,1,0]
  v_pk_fma_f32 v[110:111], v[110:111], v[32:33], v[32:33] op_sel:[0,1,0] op_sel_hi:[1,1,0]
  v_cvt_pk_bf16_f32 v148, v104, v105
  v_cvt_pk_bf16_f32 v149, v106, v107
  v_cvt_pk_bf16_f32 v150, v108, v109
  v_cvt_pk_bf16_f32 v151, v110, v111
  v_pk_fma_f32 v[112:113], v[112:113], v[32:33], v[32:33] op_sel:[0,1,0] op_sel_hi:[1,1,0]
  v_pk_fma_f32 v[114:115], v[114:115], v[32:33], v[32:33] op_sel:[0,1,0] op_sel_hi:[1,1,0]
  v_pk_fma_f32 v[116:117], v[116:117], v[32:33], v[32:33] op_sel:[0,1,0] op_sel_hi:[1,1,0]
  v_pk_fma_f32 v[118:119], v[118:119], v[32:33], v[32:33] op_sel:[0,1,0] op_sel_hi:[1,1,0]
  v_cvt_pk_bf16_f32 v152, v112, v113
  v_cvt_pk_bf16_f32 v153, v114, v115
  v_cvt_pk_bf16_f32 v154, v116, v117
  v_cvt_pk_bf16_f32 v155, v118, v119
  v_pk_fma_f32 v[120:121], v[120:121], v[32:33], v[32:33] op_sel:[0,1,0] op_sel_hi:[1,1,0]
  v_pk_fma_f32 v[122:123], v[122:123], v[32:33], v[32:33] op_sel:[0,1,0] op_sel_hi:[1,1,0]
  v_pk_fma_f32 v[124:125], v[124:125], v[32:33], v[32:33] op_sel:[0,1,0] op_sel_hi:[1,1,0]
  v_pk_fma_f32 v[126:127], v[126:127], v[32:33], v[32:33] op_sel:[0,1,0] op_sel_hi:[1,1,0]
  v_cvt_pk_bf16_f32 v156, v120, v121
  v_cvt_pk_bf16_f32 v157, v122, v123
  v_cvt_pk_bf16_f32 v158, v124, v125
  v_cvt_pk_bf16_f32 v159, v126, v127
  ds_write_b128 v19, v[128:131] offset:0
  ds_write_b128 v19, v[132:135] offset:4224
  ds_write_b128 v19, v[136:139] offset:8448
  ds_write_b128 v19, v[140:143] offset:12672
  ds_write_b128 v19, v[144:147] offset:128
  ds_write_b128 v19, v[148:151] offset:4352
  ds_write_b128 v19, v[152:155] offset:8576
  ds_write_b128 v19, v[156:159] offset:12800
  buffer_load_dwordx4 v4, s[8:11], s32 offen offset:2048 lds
  buffer_load_dwordx4 v5, s[8:11], s32 offen offset:3072 lds
  s_waitcnt vmcnt(8)
  ds_read_b64_tr_b16 a[0:1], v14 offset:0
  ds_read_b64_tr_b16 a[2:3], v14 offset:512
  s_waitcnt lgkmcnt(0)
  s_mov_b32 m0, s56
  s_mov_b32 s32, 0x20000
  buffer_load_dwordx4 v2, s[8:11], s32 offen offset:0 lds
  ds_read_b64_tr_b16 a[4:5], v15 offset:0
  ds_read_b64_tr_b16 a[6:7], v15 offset:512
  s_barrier
  buffer_load_dwordx4 v3, s[8:11], s32 offen offset:1024 lds
  s_waitcnt vmcnt(7)
  ds_read_b64_tr_b16 a[8:9], v14 offset:2048
  ds_read_b64_tr_b16 a[10:11], v14 offset:2560
  buffer_load_dwordx4 v4, s[8:11], s32 offen offset:2048 lds
  ds_read_b128 v[128:131], v20 offset:48640
  ds_read_b128 a[192:195], v20 offset:31744
  ds_read_b128 v[132:135], v20 offset:49696
  ds_read_b128 a[196:199], v20 offset:32800
  s_waitcnt lgkmcnt(3)
  v_mfma_f32_32x32x16_bf16 v[64:79], a[0:3], v[128:131], 0
  ds_read_b64_tr_b16 a[12:13], v15 offset:2048
  ds_read_b64_tr_b16 a[14:15], v15 offset:2560
  ds_read_b128 v[136:139], v20 offset:50752
  buffer_load_dwordx4 v5, s[8:11], s32 offen offset:3072 lds
  v_mfma_f32_32x32x16_bf16 v[80:95], a[4:7], v[128:131], 0
  s_waitcnt vmcnt(7)
  ds_read_b64_tr_b16 a[16:17], v14 offset:4096
  ds_read_b64_tr_b16 a[18:19], v14 offset:4608
  s_mov_b32 m0, s57
  s_mov_b32 s32, 0x30000
  s_waitcnt lgkmcnt(7)
  v_mfma_f32_32x32x16_bf16 v[96:111], a[0:3], a[192:195], 0
  ds_read_b64_tr_b16 a[20:21], v15 offset:4096
  ds_read_b64_tr_b16 a[22:23], v15 offset:4608
  ds_read_b128 a[200:203], v20 offset:33856
  buffer_load_dwordx4 v2, s[8:11], s32 offen offset:0 lds
  v_mfma_f32_32x32x16_bf16 v[112:127], a[4:7], a[192:195], 0
  ds_read_b128 v[140:143], v20 offset:51808
  s_waitcnt lgkmcnt(10)
  v_mfma_f32_32x32x16_bf16 v[64:79], a[8:11], v[132:135], v[64:79]
  ds_read_b128 a[204:207], v20 offset:34912
  buffer_load_dwordx4 v3, s[8:11], s32 offen offset:1024 lds
  s_waitcnt lgkmcnt(8)
  v_mfma_f32_32x32x16_bf16 v[80:95], a[12:15], v[132:135], v[80:95]
  buffer_load_dwordx4 v4, s[8:11], s32 offen offset:2048 lds
  v_mfma_f32_32x32x16_bf16 v[96:111], a[8:11], a[196:199], v[96:111]
  ds_read_b128 v[144:147], v20 offset:52864
  v_mfma_f32_32x32x16_bf16 v[112:127], a[12:15], a[196:199], v[112:127]
  ds_read_b128 a[208:211], v20 offset:35968
  buffer_load_dwordx4 v5, s[8:11], s32 offen offset:3072 lds
  s_waitcnt lgkmcnt(7)
  v_mfma_f32_32x32x16_bf16 v[64:79], a[16:19], v[136:139], v[64:79]
  s_mov_b32 m0, s58
  s_mov_b32 s32, 0x40000
  s_waitcnt lgkmcnt(5)
  v_mfma_f32_32x32x16_bf16 v[80:95], a[20:23], v[136:139], v[80:95]
  s_waitcnt vmcnt(8)
  ds_read_b64_tr_b16 a[24:25], v14 offset:6144
  ds_read_b64_tr_b16 a[26:27], v14 offset:6656
  buffer_load_dwordx4 v2, s[8:11], s32 offen offset:0 lds
  buffer_load_dwordx4 v3, s[8:11], s32 offen offset:1024 lds
  ds_read_b128 v[148:151], v20 offset:53920
  s_waitcnt lgkmcnt(7)
  v_mfma_f32_32x32x16_bf16 v[96:111], a[16:19], a[200:203], v[96:111]
  ds_read_b64_tr_b16 a[28:29], v15 offset:6144
  ds_read_b64_tr_b16 a[30:31], v15 offset:6656
  ds_read_b128 a[212:215], v20 offset:37024
  buffer_load_dwordx4 v4, s[8:11], s32 offen offset:2048 lds
  v_mfma_f32_32x32x16_bf16 v[112:127], a[20:23], a[200:203], v[112:127]
  buffer_load_dwordx4 v5, s[8:11], s32 offen offset:3072 lds
  s_waitcnt lgkmcnt(4)
  v_mfma_f32_32x32x16_bf16 v[64:79], a[24:27], v[140:143], v[64:79]
  s_waitcnt vmcnt(10)
  ds_read_b64_tr_b16 a[32:33], v14 offset:8192
  ds_read_b64_tr_b16 a[34:35], v14 offset:8704
  ds_read_b128 v[152:155], v20 offset:54976
  s_mov_b32 m0, s59
  s_mov_b32 s32, 0x50000
  s_waitcnt lgkmcnt(4)
  v_mfma_f32_32x32x16_bf16 v[80:95], a[28:31], v[140:143], v[80:95]
  ds_read_b64_tr_b16 a[36:37], v15 offset:8192
  ds_read_b64_tr_b16 a[38:39], v15 offset:8704
  buffer_load_dwordx4 v2, s[8:11], s32 offen offset:0 lds
  ds_read_b128 a[216:219], v20 offset:38080
  v_mfma_f32_32x32x16_bf16 v[96:111], a[24:27], a[204:207], v[96:111]
  ds_read_b128 v[156:159], v20 offset:56032
  buffer_load_dwordx4 v3, s[8:11], s32 offen offset:1024 lds
  v_mfma_f32_32x32x16_bf16 v[112:127], a[28:31], a[204:207], v[112:127]
  s_waitcnt vmcnt(10)
  ds_read_b64_tr_b16 a[40:41], v14 offset:10240
  ds_read_b64_tr_b16 a[42:43], v14 offset:10752
  s_waitcnt lgkmcnt(7)
  v_mfma_f32_32x32x16_bf16 v[64:79], a[32:35], v[144:147], v[64:79]
  ds_read_b64_tr_b16 a[44:45], v15 offset:10240
  ds_read_b64_tr_b16 a[46:47], v15 offset:10752
  buffer_load_dwordx4 v4, s[8:11], s32 offen offset:2048 lds
  ds_read_b128 a[220:223], v20 offset:39136
  s_waitcnt lgkmcnt(7)
  v_mfma_f32_32x32x16_bf16 v[80:95], a[36:39], v[144:147], v[80:95]
  ds_read_b128 v[160:163], v20 offset:57088
  v_mfma_f32_32x32x16_bf16 v[96:111], a[32:35], a[208:211], v[96:111]
  buffer_load_dwordx4 v5, s[8:11], s32 offen offset:3072 lds
  s_mov_b32 m0, s54
  s_mov_b32 s32, 0x60000
  v_mfma_f32_32x32x16_bf16 v[112:127], a[36:39], a[208:211], v[112:127]
  s_waitcnt vmcnt(10)
  ds_read_b64_tr_b16 a[48:49], v14 offset:12288
  ds_read_b64_tr_b16 a[50:51], v14 offset:12800
  ds_read_b128 a[224:227], v20 offset:40192
  buffer_load_dwordx4 v2, s[8:11], s32 offen offset:0 lds
  s_waitcnt lgkmcnt(7)
  v_mfma_f32_32x32x16_bf16 v[64:79], a[40:43], v[148:151], v[64:79]
  ds_read_b64_tr_b16 a[52:53], v15 offset:12288
  ds_read_b64_tr_b16 a[54:55], v15 offset:12800
  ds_read_b128 v[164:167], v20 offset:58144
  s_waitcnt lgkmcnt(8)
  v_mfma_f32_32x32x16_bf16 v[80:95], a[44:47], v[148:151], v[80:95]
  buffer_load_dwordx4 v3, s[8:11], s32 offen offset:1024 lds
  v_mfma_f32_32x32x16_bf16 v[96:111], a[40:43], a[212:215], v[96:111]
  s_waitcnt vmcnt(10)
  ds_read_b64_tr_b16 a[56:57], v14 offset:14336
  ds_read_b64_tr_b16 a[58:59], v14 offset:14848
  ds_read_b128 a[228:231], v20 offset:41248
  v_mfma_f32_32x32x16_bf16 v[112:127], a[44:47], a[212:215], v[112:127]
  ds_read_b64_tr_b16 a[60:61], v15 offset:14336
  ds_read_b64_tr_b16 a[62:63], v15 offset:14848
  buffer_load_dwordx4 v4, s[8:11], s32 offen offset:2048 lds
  ds_read_b128 v[168:171], v20 offset:59200
  s_waitcnt lgkmcnt(10)
  v_mfma_f32_32x32x16_bf16 v[64:79], a[48:51], v[152:155], v[64:79]
  ds_read_b128 a[232:235], v20 offset:42304
  s_waitcnt lgkmcnt(8)
  v_mfma_f32_32x32x16_bf16 v[80:95], a[52:55], v[152:155], v[80:95]
  buffer_load_dwordx4 v5, s[8:11], s32 offen offset:3072 lds
  s_mov_b32 m0, s55
  s_mov_b32 s32, 0x70000
  v_mfma_f32_32x32x16_bf16 v[96:111], a[48:51], a[216:219], v[96:111]
  ds_read_b128 v[172:175], v20 offset:60256
  buffer_load_dwordx4 v2, s[8:11], s32 offen offset:0 lds
  v_mfma_f32_32x32x16_bf16 v[112:127], a[52:55], a[216:219], v[112:127]
  ds_read_b128 a[236:239], v20 offset:43360
  s_waitcnt lgkmcnt(7)
  v_mfma_f32_32x32x16_bf16 v[64:79], a[56:59], v[156:159], v[64:79]
  buffer_load_dwordx4 v3, s[8:11], s32 offen offset:1024 lds
  s_waitcnt lgkmcnt(4)
  v_mfma_f32_32x32x16_bf16 v[80:95], a[60:63], v[156:159], v[80:95]
  s_waitcnt vmcnt(12)
  ds_read_b64_tr_b16 a[64:65], v14 offset:16384
  ds_read_b64_tr_b16 a[66:67], v14 offset:16896
  buffer_load_dwordx4 v4, s[8:11], s32 offen offset:2048 lds
  buffer_load_dwordx4 v5, s[8:11], s32 offen offset:3072 lds
  ds_read_b128 v[176:179], v20 offset:61312
  s_mov_b32 m0, s56
  s_mov_b32 s32, 0x80
  v_mfma_f32_32x32x16_bf16 v[96:111], a[56:59], a[220:223], v[96:111]
  ds_read_b64_tr_b16 a[68:69], v15 offset:16384
  ds_read_b64_tr_b16 a[70:71], v15 offset:16896
  ds_read_b128 a[240:243], v20 offset:44416
  buffer_load_dwordx4 v2, s[8:11], s32 offen offset:0 lds
  v_mfma_f32_32x32x16_bf16 v[112:127], a[60:63], a[220:223], v[112:127]
  buffer_load_dwordx4 v3, s[8:11], s32 offen offset:1024 lds
  s_waitcnt lgkmcnt(4)
  v_mfma_f32_32x32x16_bf16 v[64:79], a[64:67], v[160:163], v[64:79]
  s_waitcnt vmcnt(14)
  ds_read_b64_tr_b16 a[72:73], v14 offset:18432
  ds_read_b64_tr_b16 a[74:75], v14 offset:18944
  ds_read_b128 v[180:183], v20 offset:62368
  buffer_load_dwordx4 v4, s[8:11], s32 offen offset:2048 lds
  s_waitcnt lgkmcnt(4)
  v_mfma_f32_32x32x16_bf16 v[80:95], a[68:71], v[160:163], v[80:95]
  ds_read_b64_tr_b16 a[76:77], v15 offset:18432
  ds_read_b64_tr_b16 a[78:79], v15 offset:18944
  ds_read_b128 a[244:247], v20 offset:45472
  v_mfma_f32_32x32x16_bf16 v[96:111], a[64:67], a[224:227], v[96:111]
  buffer_load_dwordx4 v5, s[8:11], s32 offen offset:3072 lds
  v_mfma_f32_32x32x16_bf16 v[112:127], a[68:71], a[224:227], v[112:127]
  s_waitcnt vmcnt(14)
  ds_read_b64_tr_b16 a[80:81], v14 offset:20480
  ds_read_b64_tr_b16 a[82:83], v14 offset:20992
  ds_read_b128 v[184:187], v20 offset:63424
  s_mov_b32 m0, s57
  s_mov_b32 s32, 0x10080
  s_waitcnt lgkmcnt(7)
  v_mfma_f32_32x32x16_bf16 v[64:79], a[72:75], v[164:167], v[64:79]
  ds_read_b64_tr_b16 a[84:85], v15 offset:20480
  ds_read_b64_tr_b16 a[86:87], v15 offset:20992
  buffer_load_dwordx4 v2, s[8:11], s32 offen offset:0 lds
  ds_read_b128 a[248:251], v20 offset:46528
  s_waitcnt lgkmcnt(7)
  v_mfma_f32_32x32x16_bf16 v[80:95], a[76:79], v[164:167], v[80:95]
  ds_read_b128 v[188:191], v20 offset:64480
  v_mfma_f32_32x32x16_bf16 v[96:111], a[72:75], a[228:231], v[96:111]
  buffer_load_dwordx4 v3, s[8:11], s32 offen offset:1024 lds
  v_mfma_f32_32x32x16_bf16 v[112:127], a[76:79], a[228:231], v[112:127]
  s_waitcnt vmcnt(14)
  ds_read_b64_tr_b16 a[88:89], v14 offset:22528
  ds_read_b64_tr_b16 a[90:91], v14 offset:23040
  ds_read_b128 a[252:255], v20 offset:47584
  buffer_load_dwordx4 v4, s[8:11], s32 offen offset:2048 lds
  s_waitcnt lgkmcnt(8)
  v_mfma_f32_32x32x16_bf16 v[64:79], a[80:83], v[168:171], v[64:79]
  ds_read_b64_tr_b16 a[92:93], v15 offset:22528
  ds_read_b64_tr_b16 a[94:95], v15 offset:23040
  s_waitcnt lgkmcnt(7)
  v_mfma_f32_32x32x16_bf16 v[80:95], a[84:87], v[168:171], v[80:95]
  buffer_load_dwordx4 v5, s[8:11], s32 offen offset:3072 lds
  v_mfma_f32_32x32x16_bf16 v[96:111], a[80:83], a[232:235], v[96:111]
  s_waitcnt vmcnt(14)
  ds_read_b64_tr_b16 a[96:97], v14 offset:0
  ds_read_b64_tr_b16 a[98:99], v14 offset:512
  s_mov_b32 m0, s58
  s_mov_b32 s32, 0x20080
  v_mfma_f32_32x32x16_bf16 v[112:127], a[84:87], a[232:235], v[112:127]
  ds_read_b64_tr_b16 a[100:101], v15 offset:0
  ds_read_b64_tr_b16 a[102:103], v15 offset:512
  buffer_load_dwordx4 v2, s[8:11], s32 offen offset:0 lds
  s_waitcnt lgkmcnt(7)
  v_mfma_f32_32x32x16_bf16 v[64:79], a[88:91], v[172:175], v[64:79]
  s_waitcnt lgkmcnt(4)
  v_mfma_f32_32x32x16_bf16 v[80:95], a[92:95], v[172:175], v[80:95]
  buffer_load_dwordx4 v3, s[8:11], s32 offen offset:1024 lds
  v_mfma_f32_32x32x16_bf16 v[96:111], a[88:91], a[236:239], v[96:111]
  s_waitcnt vmcnt(14)
  ds_read_b64_tr_b16 a[104:105], v14 offset:2048
  ds_read_b64_tr_b16 a[106:107], v14 offset:2560
  buffer_load_dwordx4 v4, s[8:11], s32 offen offset:2048 lds
  v_mfma_f32_32x32x16_bf16 v[112:127], a[92:95], a[236:239], v[112:127]
  ds_read_b64_tr_b16 a[108:109], v15 offset:2048
  ds_read_b64_tr_b16 a[110:111], v15 offset:2560
  s_waitcnt lgkmcnt(6)
  v_mfma_f32_32x32x16_bf16 v[64:79], a[96:99], v[176:179], v[64:79]
  buffer_load_dwordx4 v5, s[8:11], s32 offen offset:3072 lds
  s_waitcnt lgkmcnt(4)
  v_mfma_f32_32x32x16_bf16 v[80:95], a[100:103], v[176:179], v[80:95]
  s_waitcnt vmcnt(14)
  ds_read_b64_tr_b16 a[112:113], v14 offset:4096
  ds_read_b64_tr_b16 a[114:115], v14 offset:4608
  s_mov_b32 m0, s59
  s_mov_b32 s32, 0x30080
  v_mfma_f32_32x32x16_bf16 v[96:111], a[96:99], a[240:243], v[96:111]
  ds_read_b64_tr_b16 a[116:117], v15 offset:4096
  ds_read_b64_tr_b16 a[118:119], v15 offset:4608
  buffer_load_dwordx4 v2, s[8:11], s32 offen offset:0 lds
  v_mfma_f32_32x32x16_bf16 v[112:127], a[100:103], a[240:243], v[112:127]
  buffer_load_dwordx4 v3, s[8:11], s32 offen offset:1024 lds
  s_waitcnt lgkmcnt(6)
  v_mfma_f32_32x32x16_bf16 v[64:79], a[104:107], v[180:183], v[64:79]
  s_waitcnt lgkmcnt(4)
  v_mfma_f32_32x32x16_bf16 v[80:95], a[108:111], v[180:183], v[80:95]
  buffer_load_dwordx4 v4, s[8:11], s32 offen offset:2048 lds
  v_mfma_f32_32x32x16_bf16 v[96:111], a[104:107], a[244:247], v[96:111]
  v_mfma_f32_32x32x16_bf16 v[112:127], a[108:111], a[244:247], v[112:127]
  buffer_load_dwordx4 v5, s[8:11], s32 offen offset:3072 lds
  s_waitcnt lgkmcnt(2)
  v_mfma_f32_32x32x16_bf16 v[64:79], a[112:115], v[184:187], v[64:79]
  s_mov_b32 m0, s54
  s_mov_b32 s32, 0x40080
  s_waitcnt lgkmcnt(0)
  v_mfma_f32_32x32x16_bf16 v[80:95], a[116:119], v[184:187], v[80:95]
  s_waitcnt vmcnt(16)
  ds_read_b64_tr_b16 a[120:121], v14 offset:6144
  ds_read_b64_tr_b16 a[122:123], v14 offset:6656
  buffer_load_dwordx4 v2, s[8:11], s32 offen offset:0 lds
  buffer_load_dwordx4 v3, s[8:11], s32 offen offset:1024 lds
  v_mfma_f32_32x32x16_bf16 v[96:111], a[112:115], a[248:251], v[96:111]
  ds_read_b64_tr_b16 a[124:125], v15 offset:6144
  ds_read_b64_tr_b16 a[126:127], v15 offset:6656
  buffer_load_dwordx4 v4, s[8:11], s32 offen offset:2048 lds
  v_mfma_f32_32x32x16_bf16 v[112:127], a[116:119], a[248:251], v[112:127]
  buffer_load_dwordx4 v5, s[8:11], s32 offen offset:3072 lds
  s_waitcnt lgkmcnt(2)
  v_mfma_f32_32x32x16_bf16 v[64:79], a[120:123], v[188:191], v[64:79]
  s_waitcnt vmcnt(18)
  ds_read_b64_tr_b16 a[128:129], v14 offset:8192
  ds_read_b64_tr_b16 a[130:131], v14 offset:8704
  s_mov_b32 m0, s55
  s_mov_b32 s32, 0x50080
  s_waitcnt lgkmcnt(2)
  v_mfma_f32_32x32x16_bf16 v[80:95], a[124:127], v[188:191], v[80:95]
  ds_read_b64_tr_b16 a[132:133], v15 offset:8192
  ds_read_b64_tr_b16 a[134:135], v15 offset:8704
  buffer_load_dwordx4 v2, s[8:11], s32 offen offset:0 lds
  v_mfma_f32_32x32x16_bf16 v[96:111], a[120:123], a[252:255], v[96:111]
  buffer_load_dwordx4 v3, s[8:11], s32 offen offset:1024 lds
  v_xor_b32 v27, 0x2a5, v43
  s_movk_i32 s35, 0x7ff
  v_add_u32 v61, 1, v43
  v_and_b32 v27, s35, v27
  v_mfma_f32_32x32x16_bf16 v[112:127], a[124:127], a[252:255], v[112:127]
  s_waitcnt vmcnt(18)
  ds_read_b64_tr_b16 a[136:137], v14 offset:10240
  ds_read_b64_tr_b16 a[138:139], v14 offset:10752
  s_waitcnt lgkmcnt(4)
  v_mfma_f32_32x32x16_bf16 v[192:207], a[128:131], v[128:131], 0
  ds_read_b64_tr_b16 a[140:141], v15 offset:10240
  ds_read_b64_tr_b16 a[142:143], v15 offset:10752
  buffer_load_dwordx4 v4, s[8:11], s32 offen offset:2048 lds
  s_waitcnt lgkmcnt(4)
  v_mfma_f32_32x32x16_bf16 v[208:223], a[132:135], v[128:131], 0
  buffer_load_dwordx4 v5, s[8:11], s32 offen offset:3072 lds
  v_exp_f32 v28, v64
  v_exp_f32 v29, v65
  v_exp_f32 v30, v66
  v_exp_f32 v31, v67
  v_mfma_f32_32x32x16_bf16 v[224:239], a[128:131], a[192:195], 0
  s_waitcnt vmcnt(18)
  ds_read_b64_tr_b16 a[144:145], v14 offset:12288
  ds_read_b64_tr_b16 a[146:147], v14 offset:12800
  v_exp_f32 v32, v68
  v_exp_f32 v33, v69
  v_exp_f32 v34, v70
  s_mov_b32 m0, s56
  s_mov_b32 s32, 0x60080
  v_mfma_f32_32x32x16_bf16 v[240:255], a[132:135], a[192:195], 0
  ds_read_b64_tr_b16 a[148:149], v15 offset:12288
  ds_read_b64_tr_b16 a[150:151], v15 offset:12800
  buffer_load_dwordx4 v2, s[8:11], s32 offen offset:0 lds
  buffer_load_dwordx4 v3, s[8:11], s32 offen offset:1024 lds
  v_exp_f32 v35, v71
  v_fma_f32 v28, v28, s33, s33
  v_fma_f32 v29, v29, s33, s33
  v_fma_f32 v30, v30, s33, s33
  v_fma_f32 v31, v31, s33, s33
  v_fma_f32 v32, v32, s33, s33
  v_fma_f32 v33, v33, s33, s33
  s_waitcnt lgkmcnt(6)
  v_mfma_f32_32x32x16_bf16 v[192:207], a[136:139], v[132:135], v[192:207]
  s_waitcnt vmcnt(18)
  ds_read_b64_tr_b16 a[152:153], v14 offset:14336
  ds_read_b64_tr_b16 a[154:155], v14 offset:14848
  v_fma_f32 v34, v34, s33, s33
  v_fma_f32 v35, v35, s33, s33
  v_rcp_f32 v28, v28
  v_rcp_f32 v29, v29
  s_waitcnt lgkmcnt(6)
  v_mfma_f32_32x32x16_bf16 v[208:223], a[140:143], v[132:135], v[208:223]
  ds_read_b64_tr_b16 a[156:157], v15 offset:14336
  ds_read_b64_tr_b16 a[158:159], v15 offset:14848
  buffer_load_dwordx4 v4, s[8:11], s32 offen offset:2048 lds
  buffer_load_dwordx4 v5, s[8:11], s32 offen offset:3072 lds
  v_rcp_f32 v30, v30
  v_rcp_f32 v31, v31
  v_rcp_f32 v32, v32
  v_rcp_f32 v33, v33
  s_mov_b32 m0, s57
  s_mov_b32 s32, 0x70080
  v_mfma_f32_32x32x16_bf16 v[224:239], a[136:139], a[196:199], v[224:239]
  s_waitcnt vmcnt(18)
  ds_read_b64_tr_b16 a[160:161], v14 offset:16384
  ds_read_b64_tr_b16 a[162:163], v14 offset:16896
  s_waitcnt lgkmcnt(6)
  buffer_load_dwordx4 v2, s[8:11], s32 offen offset:0 lds
  v_rcp_f32 v34, v34
  v_rcp_f32 v35, v35
  v_mul_f32 v28, v64, v28
  v_mul_f32 v29, v65, v29
  v_mul_f32 v30, v66, v30
  v_mfma_f32_32x32x16_bf16 v[240:255], a[140:143], a[196:199], v[240:255]
  ds_read_b64_tr_b16 a[164:165], v15 offset:16384
  ds_read_b64_tr_b16 a[166:167], v15 offset:16896
  buffer_load_dwordx4 v3, s[8:11], s32 offen offset:1024 lds
  s_waitcnt vmcnt(18)
  ds_read_b64_tr_b16 a[168:169], v14 offset:18432
  ds_read_b64_tr_b16 a[170:171], v14 offset:18944
  v_mul_f32 v31, v67, v31
  v_mul_f32 v32, v68, v32
  v_mul_f32 v33, v69, v33
  v_mul_f32 v34, v70, v34
  v_mul_f32 v35, v71, v35
  v_cvt_pk_bf16_f32 v64, v28, v29
  v_cvt_pk_bf16_f32 v65, v30, v31
  v_cvt_pk_bf16_f32 v66, v32, v33
  v_mfma_f32_32x32x16_bf16 v[192:207], a[144:147], v[136:139], v[192:207]
  ds_read_b64_tr_b16 a[172:173], v15 offset:18432
  ds_read_b64_tr_b16 a[174:175], v15 offset:18944
  s_waitcnt lgkmcnt(8)
  buffer_load_dwordx4 v4, s[8:11], s32 offen offset:2048 lds
  v_cvt_pk_bf16_f32 v67, v34, v35
  v_exp_f32 v28, v72
  v_exp_f32 v29, v73
  v_exp_f32 v30, v74
  v_mfma_f32_32x32x16_bf16 v[208:223], a[148:151], v[136:139], v[208:223]
  buffer_load_dwordx4 v5, s[8:11], s32 offen offset:3072 lds
  s_waitcnt vmcnt(18)
  ds_read_b64_tr_b16 a[176:177], v14 offset:20480
  ds_read_b64_tr_b16 a[178:179], v14 offset:20992
  v_exp_f32 v31, v75
  v_exp_f32 v32, v76
  v_exp_f32 v33, v77
  v_exp_f32 v34, v78
  s_mov_b32 m0, s58
  s_mov_b32 s32, 0x0
  v_mfma_f32_32x32x16_bf16 v[224:239], a[144:147], a[200:203], v[224:239]
  ds_read_b64_tr_b16 a[180:181], v15 offset:20480
  ds_read_b64_tr_b16 a[182:183], v15 offset:20992
  s_waitcnt lgkmcnt(8)
  buffer_load_dwordx4 v6, s[12:15], s32 offen offset:0 lds
  v_exp_f32 v35, v79
  v_fma_f32 v28, v28, s33, s33
  v_fma_f32 v29, v29, s33, s33
  v_fma_f32 v30, v30, s33, s33
  v_fma_f32 v31, v31, s33, s33
  v_mfma_f32_32x32x16_bf16 v[240:255], a[148:151], a[200:203], v[240:255]
  buffer_load_dwordx4 v7, s[12:15], s32 offen offset:1024 lds
  s_waitcnt vmcnt(18)
  ds_read_b64_tr_b16 a[184:185], v14 offset:22528
  ds_read_b64_tr_b16 a[186:187], v14 offset:23040
  v_fma_f32 v32, v32, s33, s33
  v_fma_f32 v33, v33, s33, s33
  v_fma_f32 v34, v34, s33, s33
  v_fma_f32 v35, v35, s33, s33
  v_rcp_f32 v28, v28
  v_rcp_f32 v29, v29
  v_mfma_f32_32x32x16_bf16 v[192:207], a[152:155], v[140:143], v[192:207]
  ds_read_b64_tr_b16 a[188:189], v15 offset:22528
  ds_read_b64_tr_b16 a[190:191], v15 offset:23040
  s_waitcnt lgkmcnt(8)
  buffer_load_dwordx4 v8, s[12:15], s32 offen offset:2048 lds
  v_rcp_f32 v30, v30
  v_rcp_f32 v31, v31
  v_rcp_f32 v32, v32
  v_mfma_f32_32x32x16_bf16 v[208:223], a[156:159], v[140:143], v[208:223]
  buffer_load_dwordx4 v9, s[12:15], s32 offen offset:3072 lds
  v_rcp_f32 v33, v33
  v_rcp_f32 v34, v34
  v_rcp_f32 v35, v35
  v_mul_f32 v28, v72, v28
  v_mul_f32 v29, v73, v29
  s_mov_b32 m0, s59
  s_mov_b32 s32, 0x10000
  v_mfma_f32_32x32x16_bf16 v[224:239], a[152:155], a[204:207], v[224:239]
  s_waitcnt vmcnt(18)
  ds_read_b64_tr_b16 a[0:1], v14 offset:0
  ds_read_b64_tr_b16 a[2:3], v14 offset:512
  s_waitcnt lgkmcnt(6)
  buffer_load_dwordx4 v6, s[12:15], s32 offen offset:0 lds
  v_mul_f32 v30, v74, v30
  v_mul_f32 v31, v75, v31
  v_mul_f32 v32, v76, v32
  v_mul_f32 v33, v77, v33
  v_mul_f32 v34, v78, v34
  v_mul_f32 v35, v79, v35
  v_cvt_pk_bf16_f32 v72, v28, v29
  v_mfma_f32_32x32x16_bf16 v[240:255], a[156:159], a[204:207], v[240:255]
  ds_read_b64_tr_b16 a[4:5], v15 offset:0
  ds_read_b64_tr_b16 a[6:7], v15 offset:512
  buffer_load_dwordx4 v7, s[12:15], s32 offen offset:1024 lds
  v_cvt_pk_bf16_f32 v73, v30, v31
  v_cvt_pk_bf16_f32 v74, v32, v33
  v_cvt_pk_bf16_f32 v75, v34, v35
  v_exp_f32 v28, v80
  v_exp_f32 v29, v81
  v_mfma_f32_32x32x16_bf16 v[192:207], a[160:163], v[144:147], v[192:207]
  s_waitcnt vmcnt(18)
  ds_read_b64_tr_b16 a[8:9], v14 offset:2048
  ds_read_b64_tr_b16 a[10:11], v14 offset:2560
  s_waitcnt lgkmcnt(6)
  buffer_load_dwordx4 v8, s[12:15], s32 offen offset:2048 lds
  v_exp_f32 v30, v82
  v_exp_f32 v31, v83
  v_exp_f32 v32, v84
  v_exp_f32 v33, v85
  v_mfma_f32_32x32x16_bf16 v[208:223], a[164:167], v[144:147], v[208:223]
  ds_read_b64_tr_b16 a[12:13], v15 offset:2048
  ds_read_b64_tr_b16 a[14:15], v15 offset:2560
  buffer_load_dwordx4 v9, s[12:15], s32 offen offset:3072 lds
  v_exp_f32 v34, v86
  v_exp_f32 v35, v87
  v_fma_f32 v28, v28, s33, s33
  v_fma_f32 v29, v29, s33, s33
  v_fma_f32 v30, v30, s33, s33
  s_mov_b32 m0, s54
  s_mov_b32 s32, 0x20000
  v_mfma_f32_32x32x16_bf16 v[224:239], a[160:163], a[208:211], v[224:239]
  s_waitcnt vmcnt(18)
  ds_read_b64_tr_b16 a[16:17], v14 offset:4096
  ds_read_b64_tr_b16 a[18:19], v14 offset:4608
  s_waitcnt lgkmcnt(6)
  buffer_load_dwordx4 v6, s[12:15], s32 offen offset:0 lds
  v_fma_f32 v31, v31, s33, s33
  v_fma_f32 v32, v32, s33, s33
  v_fma_f32 v33, v33, s33, s33
  v_fma_f32 v34, v34, s33, s33
  v_fma_f32 v35, v35, s33, s33
  v_rcp_f32 v28, v28
  v_mfma_f32_32x32x16_bf16 v[240:255], a[164:167], a[208:211], v[240:255]
  ds_read_b64_tr_b16 a[20:21], v15 offset:4096
  ds_read_b64_tr_b16 a[22:23], v15 offset:4608
  buffer_load_dwordx4 v7, s[12:15], s32 offen offset:1024 lds
  v_rcp_f32 v29, v29
  v_rcp_f32 v30, v30
  v_rcp_f32 v31, v31
  v_rcp_f32 v32, v32
  v_lshlrev_b32 v63, 7, v0
  s_mov_b32 exec_hi, 0
  buffer_load_dword v63, v63, s[16:19], s53 offen
  s_mov_b32 exec_hi, -1
  v_mfma_f32_32x32x16_bf16 v[192:207], a[168:171], v[148:151], v[192:207]
  s_waitcnt vmcnt(19)
  ds_read_b64_tr_b16 a[24:25], v14 offset:6144
  ds_read_b64_tr_b16 a[26:27], v14 offset:6656
  s_waitcnt lgkmcnt(6)
  buffer_load_dwordx4 v8, s[12:15], s32 offen offset:2048 lds
  ds_read_b64_tr_b16 a[28:29], v15 offset:6144
  ds_read_b64_tr_b16 a[30:31], v15 offset:6656
  v_rcp_f32 v33, v33
  v_rcp_f32 v34, v34
  v_rcp_f32 v35, v35
  v_mul_f32 v28, v80, v28
  v_mfma_f32_32x32x16_bf16 v[208:223], a[172:175], v[148:151], v[208:223]
  buffer_load_dwordx4 v9, s[12:15], s32 offen offset:3072 lds
  v_mul_f32 v29, v81, v29
  v_mul_f32 v30, v82, v30
  v_mul_f32 v31, v83, v31
  v_mul_f32 v32, v84, v32
  v_mul_f32 v33, v85, v33
  v_mul_f32 v34, v86, v34
  v_mul_f32 v35, v87, v35
  v_mfma_f32_32x32x16_bf16 v[224:239], a[168:171], a[212:215], v[224:239]
  s_waitcnt vmcnt(19)
  ds_read_b64_tr_b16 a[32:33], v14 offset:8192
  ds_read_b64_tr_b16 a[34:35], v14 offset:8704
  v_cvt_pk_bf16_f32 v80, v28, v29
  v_cvt_pk_bf16_f32 v81, v30, v31
  v_cvt_pk_bf16_f32 v82, v32, v33
  v_cvt_pk_bf16_f32 v83, v34, v35
  v_exp_f32 v28, v88
  v_mfma_f32_32x32x16_bf16 v[240:255], a[172:175], a[212:215], v[240:255]
  ds_read_b64_tr_b16 a[36:37], v15 offset:8192
  ds_read_b64_tr_b16 a[38:39], v15 offset:8704
  v_exp_f32 v29, v89
  v_exp_f32 v30, v90
  v_exp_f32 v31, v91
  v_exp_f32 v32, v92
  v_mfma_f32_32x32x16_bf16 v[192:207], a[176:179], v[152:155], v[192:207]
  s_waitcnt vmcnt(17)
  ds_read_b64_tr_b16 a[40:41], v14 offset:10240
  ds_read_b64_tr_b16 a[42:43], v14 offset:10752
  v_exp_f32 v33, v93
  v_exp_f32 v34, v94
  v_exp_f32 v35, v95
  v_fma_f32 v28, v28, s33, s33
  v_mfma_f32_32x32x16_bf16 v[208:223], a[180:183], v[152:155], v[208:223]
  ds_read_b64_tr_b16 a[44:45], v15 offset:10240
  ds_read_b64_tr_b16 a[46:47], v15 offset:10752
  v_fma_f32 v29, v29, s33, s33
  v_fma_f32 v30, v30, s33, s33
  v_fma_f32 v31, v31, s33, s33
  v_fma_f32 v32, v32, s33, s33
  v_fma_f32 v33, v33, s33, s33
  v_fma_f32 v34, v34, s33, s33
  v_fma_f32 v35, v35, s33, s33
  v_mfma_f32_32x32x16_bf16 v[224:239], a[176:179], a[216:219], v[224:239]
  s_waitcnt vmcnt(15)
  ds_read_b64_tr_b16 a[48:49], v14 offset:12288
  ds_read_b64_tr_b16 a[50:51], v14 offset:12800
  v_rcp_f32 v28, v28
  v_rcp_f32 v29, v29
  v_rcp_f32 v30, v30
  v_rcp_f32 v31, v31
  v_mfma_f32_32x32x16_bf16 v[240:255], a[180:183], a[216:219], v[240:255]
  ds_read_b64_tr_b16 a[52:53], v15 offset:12288
  ds_read_b64_tr_b16 a[54:55], v15 offset:12800
  v_rcp_f32 v32, v32
  v_rcp_f32 v33, v33
  v_rcp_f32 v34, v34
  v_mfma_f32_32x32x16_bf16 v[192:207], a[184:187], v[156:159], v[192:207]
  s_waitcnt vmcnt(13)
  ds_read_b64_tr_b16 a[56:57], v14 offset:14336
  ds_read_b64_tr_b16 a[58:59], v14 offset:14848
  v_rcp_f32 v35, v35
  v_mul_f32 v28, v88, v28
  v_mul_f32 v29, v89, v29
  v_mul_f32 v30, v90, v30
  v_mul_f32 v31, v91, v31
  v_mul_f32 v32, v92, v32
  v_mul_f32 v33, v93, v33
  v_mfma_f32_32x32x16_bf16 v[208:223], a[188:191], v[156:159], v[208:223]
  ds_read_b64_tr_b16 a[60:61], v15 offset:14336
  ds_read_b64_tr_b16 a[62:63], v15 offset:14848
  v_mul_f32 v34, v94, v34
  v_mul_f32 v35, v95, v35
  v_cvt_pk_bf16_f32 v88, v28, v29
  v_cvt_pk_bf16_f32 v89, v30, v31
  v_cvt_pk_bf16_f32 v90, v32, v33
  v_cvt_pk_bf16_f32 v91, v34, v35
  v_mfma_f32_32x32x16_bf16 v[224:239], a[184:187], a[220:223], v[224:239]
  s_mov_b32 m0, s55
  s_mov_b32 s32, 0x30000
  v_mfma_f32_32x32x16_bf16 v[240:255], a[188:191], a[220:223], v[240:255]
  ds_write_b128 v21, v[64:67] offset:0
  ds_write_b128 v21, v[72:75] offset:1024
  ds_write_b128 v21, v[80:83] offset:2048
  ds_write_b128 v21, v[88:91] offset:3072
  s_waitcnt lgkmcnt(15)
  buffer_load_dwordx4 v6, s[12:15], s32 offen offset:0 lds
  buffer_load_dwordx4 v7, s[12:15], s32 offen offset:1024 lds
  v_mfma_f32_32x32x16_bf16 v[192:207], a[0:3], v[160:163], v[192:207]
  s_waitcnt vmcnt(13)
  ds_read_b64_tr_b16 a[64:65], v16 offset:16384
  ds_read_b64_tr_b16 a[66:67], v16 offset:17408
  v_mfma_f32_32x32x16_bf16 v[208:223], a[4:7], v[160:163], v[208:223]
  ds_read_b64_tr_b16 a[68:69], v17 offset:16384
  ds_read_b64_tr_b16 a[70:71], v17 offset:17408
  s_waitcnt lgkmcnt(15)
  buffer_load_dwordx4 v8, s[12:15], s32 offen offset:2048 lds
  s_waitcnt vmcnt(12)
  ds_read_b64_tr_b16 a[72:73], v16 offset:18432
  ds_read_b64_tr_b16 a[74:75], v16 offset:19456
  buffer_load_dwordx4 v9, s[12:15], s32 offen offset:3072 lds
  v_exp_f32 v28, v96
  v_exp_f32 v29, v97
  v_exp_f32 v30, v98
  v_exp_f32 v31, v99
  v_mfma_f32_32x32x16_bf16 v[224:239], a[0:3], a[224:227], v[224:239]
  ds_read_b64_tr_b16 a[76:77], v17 offset:18432
  ds_read_b64_tr_b16 a[78:79], v17 offset:19456
  v_exp_f32 v32, v100
  v_exp_f32 v33, v101
  v_exp_f32 v34, v102
  s_mov_b32 m0, s56
  s_mov_b32 s32, 0x4000
  v_mfma_f32_32x32x16_bf16 v[240:255], a[4:7], a[224:227], v[240:255]
  s_waitcnt vmcnt(11)
  ds_read_b64_tr_b16 a[80:81], v16 offset:20480
  ds_read_b64_tr_b16 a[82:83], v16 offset:21504
  s_waitcnt lgkmcnt(15)
  buffer_load_dwordx4 v6, s[12:15], s32 offen offset:0 lds
  ds_read_b64_tr_b16 a[84:85], v17 offset:20480
  ds_read_b64_tr_b16 a[86:87], v17 offset:21504
  buffer_load_dwordx4 v7, s[12:15], s32 offen offset:1024 lds
  v_exp_f32 v35, v103
  v_fma_f32 v28, v28, s33, s33
  v_fma_f32 v29, v29, s33, s33
  v_fma_f32 v30, v30, s33, s33
  v_fma_f32 v31, v31, s33, s33
  v_fma_f32 v32, v32, s33, s33
  v_fma_f32 v33, v33, s33, s33
  v_mfma_f32_32x32x16_bf16 v[192:207], a[8:11], v[164:167], v[192:207]
  s_waitcnt vmcnt(11)
  ds_read_b64_tr_b16 a[88:89], v16 offset:22528
  ds_read_b64_tr_b16 a[90:91], v16 offset:23552
  s_waitcnt lgkmcnt(15)
  buffer_load_dwordx4 v8, s[12:15], s32 offen offset:2048 lds
  v_fma_f32 v34, v34, s33, s33
  v_fma_f32 v35, v35, s33, s33
  v_rcp_f32 v28, v28
  v_rcp_f32 v29, v29
  v_mfma_f32_32x32x16_bf16 v[208:223], a[12:15], v[164:167], v[208:223]
  ds_read_b64_tr_b16 a[92:93], v17 offset:22528
  ds_read_b64_tr_b16 a[94:95], v17 offset:23552
  buffer_load_dwordx4 v9, s[12:15], s32 offen offset:3072 lds
  s_waitcnt vmcnt(11)
  ds_read_b64_tr_b16 a[96:97], v16 offset:0
  ds_read_b64_tr_b16 a[98:99], v16 offset:1024
  v_rcp_f32 v30, v30
  v_rcp_f32 v31, v31
  v_rcp_f32 v32, v32
  v_rcp_f32 v33, v33
  s_mov_b32 m0, s57
  s_mov_b32 s32, 0x14000
  v_mfma_f32_32x32x16_bf16 v[224:239], a[8:11], a[228:231], v[224:239]
  ds_read_b64_tr_b16 a[100:101], v17 offset:0
  ds_read_b64_tr_b16 a[102:103], v17 offset:1024
  s_waitcnt lgkmcnt(15)
  buffer_load_dwordx4 v6, s[12:15], s32 offen offset:0 lds
  v_rcp_f32 v34, v34
  v_rcp_f32 v35, v35
  v_mul_f32 v28, v96, v28
  v_mul_f32 v29, v97, v29
  v_mul_f32 v30, v98, v30
  v_mfma_f32_32x32x16_bf16 v[240:255], a[12:15], a[228:231], v[240:255]
  buffer_load_dwordx4 v7, s[12:15], s32 offen offset:1024 lds
  v_mul_f32 v31, v99, v31
  v_mul_f32 v32, v100, v32
  v_mul_f32 v33, v101, v33
  v_mul_f32 v34, v102, v34
  v_mul_f32 v35, v103, v35
  v_cvt_pk_bf16_f32 v96, v28, v29
  v_cvt_pk_bf16_f32 v97, v30, v31
  v_cvt_pk_bf16_f32 v98, v32, v33
  v_mfma_f32_32x32x16_bf16 v[192:207], a[16:19], v[168:171], v[192:207]
  s_waitcnt lgkmcnt(15)
  buffer_load_dwordx4 v8, s[12:15], s32 offen offset:2048 lds
  v_cvt_pk_bf16_f32 v99, v34, v35
  v_exp_f32 v28, v104
  v_exp_f32 v29, v105
  v_exp_f32 v30, v106
  v_mfma_f32_32x32x16_bf16 v[208:223], a[20:23], v[168:171], v[208:223]
  buffer_load_dwordx4 v9, s[12:15], s32 offen offset:3072 lds
  v_exp_f32 v31, v107
  v_exp_f32 v32, v108
  v_exp_f32 v33, v109
  v_exp_f32 v34, v110
  v_mfma_f32_32x32x16_bf16 v[224:239], a[16:19], a[232:235], v[224:239]
  v_exp_f32 v35, v111
  v_fma_f32 v28, v28, s33, s33
  v_fma_f32 v29, v29, s33, s33
  v_fma_f32 v30, v30, s33, s33
  v_fma_f32 v31, v31, s33, s33
  s_mov_b32 m0, s58
  s_mov_b32 s32, 0x24000
  v_mfma_f32_32x32x16_bf16 v[240:255], a[20:23], a[232:235], v[240:255]
  s_waitcnt lgkmcnt(15)
  buffer_load_dwordx4 v6, s[12:15], s32 offen offset:0 lds
  v_fma_f32 v32, v32, s33, s33
  v_fma_f32 v33, v33, s33, s33
  v_fma_f32 v34, v34, s33, s33
  v_fma_f32 v35, v35, s33, s33
  v_rcp_f32 v28, v28
  v_rcp_f32 v29, v29
  v_mfma_f32_32x32x16_bf16 v[192:207], a[24:27], v[172:175], v[192:207]
  buffer_load_dwordx4 v7, s[12:15], s32 offen offset:1024 lds
  v_rcp_f32 v30, v30
  v_rcp_f32 v31, v31
  v_rcp_f32 v32, v32
  v_mfma_f32_32x32x16_bf16 v[208:223], a[28:31], v[172:175], v[208:223]
  s_waitcnt lgkmcnt(12)
  buffer_load_dwordx4 v8, s[12:15], s32 offen offset:2048 lds
  v_rcp_f32 v33, v33
  v_rcp_f32 v34, v34
  v_rcp_f32 v35, v35
  v_mul_f32 v28, v104, v28
  v_mul_f32 v29, v105, v29
  v_mfma_f32_32x32x16_bf16 v[224:239], a[24:27], a[236:239], v[224:239]
  buffer_load_dwordx4 v9, s[12:15], s32 offen offset:3072 lds
  v_mul_f32 v30, v106, v30
  v_mul_f32 v31, v107, v31
  v_mul_f32 v32, v108, v32
  v_mul_f32 v33, v109, v33
  v_mul_f32 v34, v110, v34
  v_mul_f32 v35, v111, v35
  v_cvt_pk_bf16_f32 v104, v28, v29
  v_mfma_f32_32x32x16_bf16 v[240:255], a[28:31], a[236:239], v[240:255]
  v_cvt_pk_bf16_f32 v105, v30, v31
  v_cvt_pk_bf16_f32 v106, v32, v33
  v_cvt_pk_bf16_f32 v107, v34, v35
  v_exp_f32 v28, v112
  v_exp_f32 v29, v113
  s_mov_b32 m0, s59
  s_mov_b32 s32, 0x34000
  v_mfma_f32_32x32x16_bf16 v[192:207], a[32:35], v[176:179], v[192:207]
  s_waitcnt lgkmcnt(8)
  buffer_load_dwordx4 v6, s[12:15], s32 offen offset:0 lds
  s_waitcnt vmcnt(17)
  ds_read_b64_tr_b16 a[104:105], v16 offset:2048
  ds_read_b64_tr_b16 a[106:107], v16 offset:3072
  buffer_load_dwordx4 v7, s[12:15], s32 offen offset:1024 lds
  ds_read_b64_tr_b16 a[108:109], v17 offset:2048
  ds_read_b64_tr_b16 a[110:111], v17 offset:3072
  v_exp_f32 v30, v114
  v_exp_f32 v31, v115
  v_exp_f32 v32, v116
  v_exp_f32 v33, v117
  s_barrier
  s_waitcnt lgkmcnt(8)
  buffer_load_dwordx4 v8, s[12:15], s32 offen offset:2048 lds
  v_mfma_f32_32x32x16_bf16 v[208:223], a[36:39], v[176:179], v[208:223]
  buffer_load_dwordx4 v9, s[12:15], s32 offen offset:3072 lds
  v_exp_f32 v34, v118
  v_exp_f32 v35, v119
  v_fma_f32 v28, v28, s33, s33
  v_fma_f32 v29, v29, s33, s33
  v_fma_f32 v30, v30, s33, s33
  s_mov_b32 m0, s54
  s_mov_b32 s32, 0x8000
  v_mfma_f32_32x32x16_bf16 v[224:239], a[32:35], a[240:243], v[224:239]
  s_waitcnt vmcnt(18)
  ds_read_b64_tr_b16 a[112:113], v16 offset:4096
  ds_read_b64_tr_b16 a[114:115], v16 offset:5120
  s_waitcnt lgkmcnt(6)
  buffer_load_dwordx4 v6, s[12:15], s32 offen offset:0 lds
  v_fma_f32 v31, v31, s33, s33
  v_fma_f32 v32, v32, s33, s33
  v_fma_f32 v33, v33, s33, s33
  v_fma_f32 v34, v34, s33, s33
  v_fma_f32 v35, v35, s33, s33
  v_rcp_f32 v28, v28
  v_mfma_f32_32x32x16_bf16 v[240:255], a[36:39], a[240:243], v[240:255]
  ds_read_b64_tr_b16 a[116:117], v17 offset:4096
  ds_read_b64_tr_b16 a[118:119], v17 offset:5120
  buffer_load_dwordx4 v7, s[12:15], s32 offen offset:1024 lds
  v_rcp_f32 v29, v29
  v_rcp_f32 v30, v30
  v_rcp_f32 v31, v31
  v_rcp_f32 v32, v32
  v_mfma_f32_32x32x16_bf16 v[192:207], a[40:43], v[180:183], v[192:207]
  s_waitcnt lgkmcnt(4)
  buffer_load_dwordx4 v8, s[12:15], s32 offen offset:2048 lds
  s_waitcnt vmcnt(19)
  ds_read_b64_tr_b16 a[120:121], v16 offset:6144
  ds_read_b64_tr_b16 a[122:123], v16 offset:7168
  v_rcp_f32 v33, v33
  v_rcp_f32 v34, v34
  v_rcp_f32 v35, v35
  v_mul_f32 v28, v112, v28
  v_mfma_f32_32x32x16_bf16 v[208:223], a[44:47], v[180:183], v[208:223]
  ds_read_b64_tr_b16 a[124:125], v17 offset:6144
  ds_read_b64_tr_b16 a[126:127], v17 offset:7168
  buffer_load_dwordx4 v9, s[12:15], s32 offen offset:3072 lds
  v_mul_f32 v29, v113, v29
  v_mul_f32 v30, v114, v30
  v_mul_f32 v31, v115, v31
  v_mul_f32 v32, v116, v32
  v_mul_f32 v33, v117, v33
  v_mul_f32 v34, v118, v34
  v_mul_f32 v35, v119, v35
  s_mov_b32 m0, s55
  s_mov_b32 s32, 0x18000
  v_mfma_f32_32x32x16_bf16 v[224:239], a[40:43], a[244:247], v[224:239]
  ds_read_b128 v[160:163], v1 offset:0
  s_waitcnt vmcnt(18)
  ds_read_b64_tr_b16 a[128:129], v16 offset:8192
  ds_read_b64_tr_b16 a[130:131], v16 offset:9216
  s_waitcnt lgkmcnt(7)
  buffer_load_dwordx4 v6, s[12:15], s32 offen offset:0 lds
  v_cvt_pk_bf16_f32 v112, v28, v29
  v_cvt_pk_bf16_f32 v113, v30, v31
  v_cvt_pk_bf16_f32 v114, v32, v33
  v_cvt_pk_bf16_f32 v115, v34, v35
  v_exp_f32 v28, v120
  v_mfma_f32_32x32x16_bf16 v[240:255], a[44:47], a[244:247], v[240:255]
  ds_read_b64_tr_b16 a[132:133], v17 offset:8192
  ds_read_b64_tr_b16 a[134:135], v17 offset:9216
  buffer_load_dwordx4 v7, s[12:15], s32 offen offset:1024 lds
  v_exp_f32 v29, v121
  v_exp_f32 v30, v122
  v_exp_f32 v31, v123
  v_exp_f32 v32, v124
  v_mfma_f32_32x32x16_bf16 v[192:207], a[48:51], v[184:187], v[192:207]
  ds_read_b128 v[164:167], v1 offset:1024
  s_waitcnt vmcnt(18)
  ds_read_b64_tr_b16 a[192:193], v16 offset:10240
  ds_read_b64_tr_b16 a[194:195], v16 offset:11264
  s_waitcnt lgkmcnt(8)
  buffer_load_dwordx4 v8, s[12:15], s32 offen offset:2048 lds
  ds_read_b64_tr_b16 a[136:137], v17 offset:10240
  ds_read_b64_tr_b16 a[138:139], v17 offset:11264
  v_exp_f32 v33, v125
  v_exp_f32 v34, v126
  v_exp_f32 v35, v127
  v_fma_f32 v28, v28, s33, s33
  v_mfma_f32_32x32x16_bf16 v[208:223], a[52:55], v[184:187], v[208:223]
  buffer_load_dwordx4 v9, s[12:15], s32 offen offset:3072 lds
  v_fma_f32 v29, v29, s33, s33
  v_fma_f32 v30, v30, s33, s33
  v_fma_f32 v31, v31, s33, s33
  v_fma_f32 v32, v32, s33, s33
  v_fma_f32 v33, v33, s33, s33
  v_fma_f32 v34, v34, s33, s33
  v_fma_f32 v35, v35, s33, s33
  v_mfma_f32_32x32x16_bf16 v[224:239], a[48:51], a[248:251], v[224:239]
  ds_read_b128 v[168:171], v1 offset:8192
  s_waitcnt vmcnt(18)
  ds_read_b64_tr_b16 a[140:141], v16 offset:12288
  ds_read_b64_tr_b16 a[142:143], v16 offset:13312
  v_rcp_f32 v28, v28
  v_rcp_f32 v29, v29
  v_rcp_f32 v30, v30
  v_rcp_f32 v31, v31
  v_mfma_f32_32x32x16_bf16 v[240:255], a[52:55], a[248:251], v[240:255]
  ds_read_b64_tr_b16 a[196:197], v17 offset:12288
  ds_read_b64_tr_b16 a[198:199], v17 offset:13312
  v_rcp_f32 v32, v32
  v_rcp_f32 v33, v33
  v_rcp_f32 v34, v34
  v_mfma_f32_32x32x16_bf16 v[192:207], a[56:59], v[188:191], v[192:207]
  ds_read_b128 v[172:175], v1 offset:9216
  s_waitcnt vmcnt(16)
  ds_read_b64_tr_b16 a[144:145], v16 offset:14336
  ds_read_b64_tr_b16 a[146:147], v16 offset:15360
  v_rcp_f32 v35, v35
  v_mul_f32 v28, v120, v28
  v_mul_f32 v29, v121, v29
  v_mul_f32 v30, v122, v30
  v_mul_f32 v31, v123, v31
  v_mul_f32 v32, v124, v32
  v_mul_f32 v33, v125, v33
  v_mfma_f32_32x32x16_bf16 v[208:223], a[60:63], v[188:191], v[208:223]
  ds_read_b64_tr_b16 a[148:149], v17 offset:14336
  ds_read_b64_tr_b16 a[150:151], v17 offset:15360
  v_mul_f32 v34, v126, v34
  v_mul_f32 v35, v127, v35
  v_cvt_pk_bf16_f32 v120, v28, v29
  v_cvt_pk_bf16_f32 v121, v30, v31
  v_cvt_pk_bf16_f32 v122, v32, v33
  v_cvt_pk_bf16_f32 v123, v34, v35
  v_mfma_f32_32x32x16_bf16 v[224:239], a[56:59], a[252:255], v[224:239]
  ds_read_b128 v[176:179], v1 offset:16384
  s_mov_b32 m0, s56
  s_mov_b32 s32, 0x28000
  v_mfma_f32_32x32x16_bf16 v[240:255], a[60:63], a[252:255], v[240:255]
  s_waitcnt vmcnt(14)
  ds_read_b64_tr_b16 a[200:201], v16 offset:16384
  ds_read_b64_tr_b16 a[202:203], v16 offset:17408
  ds_write_b128 v21, v[96:99] offset:32768
  ds_write_b128 v21, v[104:107] offset:33792
  ds_write_b128 v21, v[112:115] offset:34816
  ds_write_b128 v21, v[120:123] offset:35840
  s_waitcnt lgkmcnt(15)
  buffer_load_dwordx4 v6, s[12:15], s32 offen offset:0 lds
  buffer_load_dwordx4 v7, s[12:15], s32 offen offset:1024 lds
  v_mfma_f32_32x32x16_bf16 v[128:143], a[64:67], v[160:163], 0
  ds_read_b64_tr_b16 a[152:153], v17 offset:16384
  ds_read_b64_tr_b16 a[154:155], v17 offset:17408
  ds_read_b128 v[180:183], v1 offset:17408
  v_mfma_f32_32x32x16_bf16 v[144:159], a[68:71], v[160:163], 0
  s_waitcnt vmcnt(14)
  ds_read_b64_tr_b16 a[156:157], v16 offset:18432
  ds_read_b64_tr_b16 a[158:159], v16 offset:19456
  s_waitcnt lgkmcnt(15)
  buffer_load_dwordx4 v8, s[12:15], s32 offen offset:2048 lds
  ds_read_b64_tr_b16 a[204:205], v17 offset:18432
  ds_read_b64_tr_b16 a[206:207], v17 offset:19456
  buffer_load_dwordx4 v9, s[12:15], s32 offen offset:3072 lds
  v_exp_f32 v28, v192
  v_exp_f32 v29, v193
  v_exp_f32 v30, v194
  v_exp_f32 v31, v195
  s_mov_b32 m0, s57
  s_mov_b32 s32, 0x38000
  v_mfma_f32_32x32x16_bf16 v[128:143], a[72:75], v[164:167], v[128:143]
  s_waitcnt vmcnt(14)
  ds_read_b64_tr_b16 a[160:161], v16 offset:20480
  ds_read_b64_tr_b16 a[162:163], v16 offset:21504
  ds_read_b128 v[184:187], v1 offset:24576
  s_waitcnt lgkmcnt(15)
  buffer_load_dwordx4 v6, s[12:15], s32 offen offset:0 lds
  ds_read_b64_tr_b16 a[164:165], v17 offset:20480
  ds_read_b64_tr_b16 a[166:167], v17 offset:21504
  v_exp_f32 v32, v196
  v_exp_f32 v33, v197
  v_exp_f32 v34, v198
  v_exp_f32 v35, v199
  v_fma_f32 v28, v28, s33, s33
  v_mfma_f32_32x32x16_bf16 v[144:159], a[76:79], v[164:167], v[144:159]
  s_waitcnt vmcnt(13)
  ds_read_b64_tr_b16 a[208:209], v16 offset:22528
  ds_read_b64_tr_b16 a[210:211], v16 offset:23552
  buffer_load_dwordx4 v7, s[12:15], s32 offen offset:1024 lds
  ds_read_b64_tr_b16 a[168:169], v17 offset:22528
  ds_read_b64_tr_b16 a[170:171], v17 offset:23552
  v_fma_f32 v29, v29, s33, s33
  v_fma_f32 v30, v30, s33, s33
  v_fma_f32 v31, v31, s33, s33
  v_fma_f32 v32, v32, s33, s33
  v_fma_f32 v33, v33, s33, s33
  v_fma_f32 v34, v34, s33, s33
  v_fma_f32 v35, v35, s33, s33
  v_rcp_f32 v28, v28
  v_mfma_f32_32x32x16_bf16 v[128:143], a[80:83], v[168:171], v[128:143]
  s_waitcnt lgkmcnt(15)
  buffer_load_dwordx4 v8, s[12:15], s32 offen offset:2048 lds
  ds_read_b128 v[188:191], v1 offset:25600
  s_waitcnt vmcnt(13)
  ds_read_b64_tr_b16 a[172:173], v16 offset:0
  ds_read_b64_tr_b16 a[174:175], v16 offset:1024
  buffer_load_dwordx4 v9, s[12:15], s32 offen offset:3072 lds
  v_rcp_f32 v29, v29
  v_rcp_f32 v30, v30
  v_rcp_f32 v31, v31
  v_rcp_f32 v32, v32
  s_mov_b32 m0, s58
  s_mov_b32 s32, 0xc000
  v_mfma_f32_32x32x16_bf16 v[144:159], a[84:87], v[168:171], v[144:159]
  ds_read_b64_tr_b16 a[212:213], v17 offset:0
  ds_read_b64_tr_b16 a[214:215], v17 offset:1024
  s_waitcnt lgkmcnt(15)
  buffer_load_dwordx4 v6, s[12:15], s32 offen offset:0 lds
  v_rcp_f32 v33, v33
  v_rcp_f32 v34, v34
  v_rcp_f32 v35, v35
  v_mul_f32 v28, v192, v28
  v_mul_f32 v29, v193, v29
  v_mul_f32 v30, v194, v30
  v_mfma_f32_32x32x16_bf16 v[128:143], a[88:91], v[172:175], v[128:143]
  s_waitcnt vmcnt(13)
  ds_read_b64_tr_b16 a[176:177], v16 offset:2048
  ds_read_b64_tr_b16 a[178:179], v16 offset:3072
  ds_read_b128 v[160:163], v1 offset:2048
  buffer_load_dwordx4 v7, s[12:15], s32 offen offset:1024 lds
  ds_read_b64_tr_b16 a[180:181], v17 offset:2048
  ds_read_b64_tr_b16 a[182:183], v17 offset:3072
  v_mul_f32 v31, v195, v31
  v_mul_f32 v32, v196, v32
  v_mul_f32 v33, v197, v33
  v_mul_f32 v34, v198, v34
  v_mul_f32 v35, v199, v35
  v_cvt_pk_bf16_f32 v192, v28, v29
  v_cvt_pk_bf16_f32 v193, v30, v31
  v_cvt_pk_bf16_f32 v194, v32, v33
  v_mfma_f32_32x32x16_bf16 v[144:159], a[92:95], v[172:175], v[144:159]
  s_waitcnt lgkmcnt(15)
  buffer_load_dwordx4 v8, s[12:15], s32 offen offset:2048 lds
  s_waitcnt vmcnt(13)
  ds_read_b64_tr_b16 a[216:217], v16 offset:4096
  ds_read_b64_tr_b16 a[218:219], v16 offset:5120
  v_cvt_pk_bf16_f32 v195, v34, v35
  v_exp_f32 v28, v200
  v_exp_f32 v29, v201
  v_exp_f32 v30, v202
  v_exp_f32 v31, v203
  v_mfma_f32_32x32x16_bf16 v[128:143], a[96:99], v[176:179], v[128:143]
  ds_read_b64_tr_b16 a[184:185], v17 offset:4096
  ds_read_b64_tr_b16 a[186:187], v17 offset:5120
  buffer_load_dwordx4 v9, s[12:15], s32 offen offset:3072 lds
  ds_read_b128 v[164:167], v1 offset:3072
  v_exp_f32 v32, v204
  v_exp_f32 v33, v205
  v_exp_f32 v34, v206
  v_exp_f32 v35, v207
  s_mov_b32 m0, s59
  s_mov_b32 s32, 0x1c000
  v_fma_f32 v28, v28, s33, s33
  v_mfma_f32_32x32x16_bf16 v[144:159], a[100:103], v[176:179], v[144:159]
  s_waitcnt lgkmcnt(15)
  buffer_load_dwordx4 v6, s[12:15], s32 offen offset:0 lds
  s_waitcnt vmcnt(13)
  ds_read_b64_tr_b16 a[188:189], v16 offset:6144
  ds_read_b64_tr_b16 a[190:191], v16 offset:7168
  buffer_load_dwordx4 v7, s[12:15], s32 offen offset:1024 lds
  ds_read_b64_tr_b16 a[220:221], v17 offset:6144
  ds_read_b64_tr_b16 a[222:223], v17 offset:7168
  v_fma_f32 v29, v29, s33, s33
  v_fma_f32 v30, v30, s33, s33
  v_fma_f32 v31, v31, s33, s33
  v_fma_f32 v32, v32, s33, s33
  v_fma_f32 v33, v33, s33, s33
  v_fma_f32 v34, v34, s33, s33
  v_fma_f32 v35, v35, s33, s33
  v_mfma_f32_32x32x16_bf16 v[128:143], a[104:107], v[180:183], v[128:143]
  ds_read_b128 v[168:171], v1 offset:10240
  s_waitcnt lgkmcnt(15)
  buffer_load_dwordx4 v8, s[12:15], s32 offen offset:2048 lds
  v_rcp_f32 v28, v28
  v_rcp_f32 v29, v29
  v_rcp_f32 v30, v30
  v_rcp_f32 v31, v31
  v_rcp_f32 v32, v32
  v_mfma_f32_32x32x16_bf16 v[144:159], a[108:111], v[180:183], v[144:159]
  buffer_load_dwordx4 v9, s[12:15], s32 offen offset:3072 lds
  v_rcp_f32 v33, v33
  v_rcp_f32 v34, v34
  v_rcp_f32 v35, v35
  v_mul_f32 v28, v200, v28
  v_mul_f32 v29, v201, v29
  s_mov_b32 m0, s54
  s_mov_b32 s32, 0x2c000
  v_mfma_f32_32x32x16_bf16 v[128:143], a[112:115], v[184:187], v[128:143]
  ds_read_b128 v[172:175], v1 offset:11264
  s_waitcnt lgkmcnt(15)
  buffer_load_dwordx4 v6, s[12:15], s32 offen offset:0 lds
  v_mul_f32 v30, v202, v30
  v_mul_f32 v31, v203, v31
  v_mul_f32 v32, v204, v32
  v_mul_f32 v33, v205, v33
  v_mul_f32 v34, v206, v34
  v_mul_f32 v35, v207, v35
  v_cvt_pk_bf16_f32 v200, v28, v29
  v_cvt_pk_bf16_f32 v201, v30, v31
  v_cvt_pk_bf16_f32 v202, v32, v33
  v_add_u32 v62, 0x1000, v1
  v_mfma_f32_32x32x16_bf16 v[144:159], a[116:119], v[184:187], v[144:159]
  buffer_load_dwordx4 v7, s[12:15], s32 offen offset:1024 lds
  v_cvt_pk_bf16_f32 v203, v34, v35
  v_exp_f32 v28, v208
  v_exp_f32 v29, v209
  v_exp_f32 v30, v210
  v_exp_f32 v31, v211
  v_mfma_f32_32x32x16_bf16 v[128:143], a[120:123], v[188:191], v[128:143]
  ds_read_b128 v[176:179], v1 offset:18432
  s_waitcnt lgkmcnt(12)
  buffer_load_dwordx4 v8, s[12:15], s32 offen offset:2048 lds
  v_exp_f32 v32, v212
  v_exp_f32 v33, v213
  v_exp_f32 v34, v214
  v_exp_f32 v35, v215
  v_mfma_f32_32x32x16_bf16 v[144:159], a[124:127], v[188:191], v[144:159]
  buffer_load_dwordx4 v9, s[12:15], s32 offen offset:3072 lds
  v_fma_f32 v28, v28, s33, s33
  v_fma_f32 v29, v29, s33, s33
  v_fma_f32 v30, v30, s33, s33
  v_fma_f32 v31, v31, s33, s33
  v_fma_f32 v32, v32, s33, s33
  v_fma_f32 v33, v33, s33, s33
  v_fma_f32 v34, v34, s33, s33
  v_fma_f32 v35, v35, s33, s33
  s_mov_b32 m0, s55
  s_mov_b32 s32, 0x3c000
  v_mfma_f32_32x32x16_bf16 v[128:143], a[128:131], v[160:163], v[128:143]
  ds_read_b128 v[180:183], v1 offset:19456
  s_waitcnt lgkmcnt(9)
  buffer_load_dwordx4 v6, s[12:15], s32 offen offset:0 lds
  s_waitcnt vmcnt(19)
  ds_read_b64_tr_b16 a[0:1], v16 offset:8192
  ds_read_b64_tr_b16 a[2:3], v16 offset:9216
  v_rcp_f32 v28, v28
  v_rcp_f32 v29, v29
  v_rcp_f32 v30, v30
  v_rcp_f32 v31, v31
  v_mfma_f32_32x32x16_bf16 v[144:159], a[132:135], v[160:163], v[144:159]
  ds_read_b64_tr_b16 a[4:5], v17 offset:8192
  ds_read_b64_tr_b16 a[6:7], v17 offset:9216
  buffer_load_dwordx4 v7, s[12:15], s32 offen offset:1024 lds
  s_waitcnt vmcnt(18)
  ds_read_b64_tr_b16 a[224:225], v16 offset:10240
  ds_read_b64_tr_b16 a[226:227], v16 offset:11264
  s_waitcnt lgkmcnt(10)
  buffer_load_dwordx4 v8, s[12:15], s32 offen offset:2048 lds
  v_rcp_f32 v32, v32
  v_rcp_f32 v33, v33
  v_rcp_f32 v34, v34
  v_rcp_f32 v35, v35
  v_mul_f32 v28, v208, v28
  v_mul_f32 v29, v209, v29
  v_mfma_f32_32x32x16_bf16 v[128:143], a[192:195], v[164:167], v[128:143]
  ds_read_b64_tr_b16 a[8:9], v17 offset:10240
  ds_read_b64_tr_b16 a[10:11], v17 offset:11264
  ds_read_b128 v[184:187], v1 offset:26624
  buffer_load_dwordx4 v9, s[12:15], s32 offen offset:3072 lds
  v_mul_f32 v30, v210, v30
  v_mul_f32 v31, v211, v31
  v_mul_f32 v32, v212, v32
  v_mul_f32 v33, v213, v33
  v_mul_f32 v34, v214, v34
  v_mul_f32 v35, v215, v35
  v_cvt_pk_bf16_f32 v208, v28, v29
  v_cvt_pk_bf16_f32 v209, v30, v31
  v_mfma_f32_32x32x16_bf16 v[144:159], a[136:139], v[164:167], v[144:159]
  s_waitcnt vmcnt(18)
  ds_read_b64_tr_b16 a[12:13], v16 offset:12288
  ds_read_b64_tr_b16 a[14:15], v16 offset:13312
  v_cvt_pk_bf16_f32 v210, v32, v33
  v_cvt_pk_bf16_f32 v211, v34, v35
  v_exp_f32 v28, v216
  v_exp_f32 v29, v217
  v_exp_f32 v30, v218
  s_waitcnt lgkmcnt(14)
  v_mfma_f32_32x32x16_bf16 v[128:143], a[140:143], v[168:171], v[128:143]
  ds_read_b64_tr_b16 a[228:229], v17 offset:12288
  ds_read_b64_tr_b16 a[230:231], v17 offset:13312
  ds_read_b128 v[188:191], v1 offset:27648
  v_exp_f32 v31, v219
  v_exp_f32 v32, v220
  v_exp_f32 v33, v221
  v_exp_f32 v34, v222
  v_exp_f32 v35, v223
  v_mfma_f32_32x32x16_bf16 v[144:159], a[196:199], v[168:171], v[144:159]
  s_waitcnt vmcnt(16)
  ds_read_b64_tr_b16 a[16:17], v16 offset:14336
  ds_read_b64_tr_b16 a[18:19], v16 offset:15360
  ds_read_b64_tr_b16 a[20:21], v17 offset:14336
  ds_read_b64_tr_b16 a[22:23], v17 offset:15360
  v_fma_f32 v28, v28, s33, s33
  v_fma_f32 v29, v29, s33, s33
  v_fma_f32 v30, v30, s33, s33
  v_fma_f32 v31, v31, s33, s33
  v_fma_f32 v32, v32, s33, s33
  v_fma_f32 v33, v33, s33, s33
  v_fma_f32 v34, v34, s33, s33
  v_fma_f32 v35, v35, s33, s33
  s_waitcnt lgkmcnt(15)
  v_mfma_f32_32x32x16_bf16 v[128:143], a[144:147], v[172:175], v[128:143]
  v_rcp_f32 v28, v28
  v_rcp_f32 v29, v29
  v_rcp_f32 v30, v30
  v_rcp_f32 v31, v31
  v_mfma_f32_32x32x16_bf16 v[144:159], a[148:151], v[172:175], v[144:159]
  s_waitcnt vmcnt(14)
  ds_read_b64_tr_b16 a[232:233], v16 offset:16384
  ds_read_b64_tr_b16 a[234:235], v16 offset:17408
  v_rcp_f32 v32, v32
  v_rcp_f32 v33, v33
  v_rcp_f32 v34, v34
  v_rcp_f32 v35, v35
  v_mul_f32 v28, v216, v28
  s_waitcnt lgkmcnt(15)
  v_mfma_f32_32x32x16_bf16 v[128:143], a[200:203], v[176:179], v[128:143]
  ds_read_b64_tr_b16 a[24:25], v17 offset:16384
  ds_read_b64_tr_b16 a[26:27], v17 offset:17408
  v_mul_f32 v29, v217, v29
  v_mul_f32 v30, v218, v30
  v_mul_f32 v31, v219, v31
  v_mul_f32 v32, v220, v32
  v_mul_f32 v33, v221, v33
  v_mul_f32 v34, v222, v34
  v_mul_f32 v35, v223, v35
  v_cvt_pk_bf16_f32 v216, v28, v29
  v_mfma_f32_32x32x16_bf16 v[144:159], a[152:155], v[176:179], v[144:159]
  s_waitcnt vmcnt(12)
  ds_read_b64_tr_b16 a[28:29], v16 offset:18432
  ds_read_b64_tr_b16 a[30:31], v16 offset:19456
  v_cvt_pk_bf16_f32 v217, v30, v31
  v_cvt_pk_bf16_f32 v218, v32, v33
  v_cvt_pk_bf16_f32 v219, v34, v35
  s_mov_b32 m0, s56
  s_mov_b32 s32, 0x0
  s_waitcnt lgkmcnt(15)
  v_mfma_f32_32x32x16_bf16 v[128:143], a[156:159], v[180:183], v[128:143]
  ds_read_b64_tr_b16 a[236:237], v17 offset:18432
  ds_read_b64_tr_b16 a[238:239], v17 offset:19456
  ds_write_b128 v21, v[192:195] offset:4096
  ds_write_b128 v21, v[200:203] offset:5120
  ds_write_b128 v21, v[208:211] offset:6144
  ds_write_b128 v21, v[216:219] offset:7168
  s_waitcnt lgkmcnt(15)
  buffer_load_dwordx4 v10, s[16:19], s32 offen offset:0 lds
  buffer_load_dwordx4 v11, s[16:19], s32 offen offset:1024 lds
  v_mfma_f32_32x32x16_bf16 v[144:159], a[204:207], v[180:183], v[144:159]
  s_waitcnt vmcnt(12)
  ds_read_b64_tr_b16 a[32:33], v16 offset:20480
  ds_read_b64_tr_b16 a[34:35], v16 offset:21504
  s_waitcnt lgkmcnt(15)
  v_mfma_f32_32x32x16_bf16 v[128:143], a[160:163], v[184:187], v[128:143]
  ds_read_b64_tr_b16 a[36:37], v17 offset:20480
  ds_read_b64_tr_b16 a[38:39], v17 offset:21504
  buffer_load_dwordx4 v12, s[16:19], s32 offen offset:2048 lds
  v_mfma_f32_32x32x16_bf16 v[144:159], a[164:167], v[184:187], v[144:159]
  s_waitcnt vmcnt(11)
  ds_read_b64_tr_b16 a[240:241], v16 offset:22528
  ds_read_b64_tr_b16 a[242:243], v16 offset:23552
  s_waitcnt lgkmcnt(15)
  v_mfma_f32_32x32x16_bf16 v[128:143], a[208:211], v[188:191], v[128:143]
  ds_read_b64_tr_b16 a[40:41], v17 offset:22528
  ds_read_b64_tr_b16 a[42:43], v17 offset:23552
  buffer_load_dwordx4 v13, s[16:19], s32 offen offset:3072 lds
  s_waitcnt lgkmcnt(8)
  s_barrier
  s_mov_b32 m0, s57
  s_mov_b32 s32, 0xc000
  buffer_load_dwordx4 v10, s[16:19], s32 offen offset:0 lds
  v_mfma_f32_32x32x16_bf16 v[144:159], a[168:171], v[188:191], v[144:159]
  s_waitcnt vmcnt(11)
  ds_read_b64_tr_b16 a[44:45], v16 offset:0
  ds_read_b64_tr_b16 a[46:47], v16 offset:1024
  buffer_load_dwordx4 v11, s[16:19], s32 offen offset:1024 lds
  v_exp_f32 v28, v224
  v_exp_f32 v29, v225
  s_mov_b32 s68, m0
  s_lshl_b32 s69, s24, 13
  s_add_u32 s69, s69, 36864
  s_mov_b32 m0, s69
  s_nop 0
  buffer_load_dwordx4 v26, s[4:7], s47 offen offset:0 lds
  s_addk_i32 s47, 3072
  buffer_load_dwordx4 v26, s[4:7], s47 offen offset:1024 lds
  s_addk_i32 s47, 3072
  buffer_load_dwordx4 v26, s[4:7], s47 offen offset:2048 lds
  s_addk_i32 s47, 3072
  buffer_load_dwordx4 v26, s[4:7], s47 offen offset:3072 lds
  s_mov_b32 m0, s68
  ds_read_b64_tr_b16 a[244:245], v17 offset:0
  ds_read_b64_tr_b16 a[246:247], v17 offset:1024
  ds_read_b128 v[160:163], v1 offset:4096
  ds_read_b128 v[164:167], v1 offset:5120
  ds_read_b128 v[168:171], v1 offset:12288
  ds_read_b128 v[172:175], v1 offset:13312
  ds_read_b128 v[176:179], v1 offset:20480
  s_waitcnt lgkmcnt(4)
  v_mfma_f32_32x32x16_bf16 v[128:143], a[172:175], v[160:163], v[128:143]
  s_waitcnt vmcnt(14)
  ds_read_b64_tr_b16 a[48:49], v16 offset:2048
  ds_read_b64_tr_b16 a[50:51], v16 offset:3072
  ds_read_b128 v[180:183], v1 offset:21504
  v_exp_f32 v30, v226
  v_exp_f32 v31, v227
  v_mfma_f32_32x32x16_bf16 v[144:159], a[212:215], v[160:163], v[144:159]
  ds_read_b64_tr_b16 a[52:53], v17 offset:2048
  ds_read_b64_tr_b16 a[54:55], v17 offset:3072
  buffer_load_dwordx4 v12, s[16:19], s32 offen offset:2048 lds
  v_exp_f32 v32, v228
  v_exp_f32 v33, v229
  s_waitcnt lgkmcnt(8)
  v_mfma_f32_32x32x16_bf16 v[128:143], a[176:179], v[164:167], v[128:143]
  s_waitcnt vmcnt(13)
  ds_read_b64_tr_b16 a[248:249], v16 offset:4096
  ds_read_b64_tr_b16 a[250:251], v16 offset:5120
  buffer_load_dwordx4 v13, s[16:19], s32 offen offset:3072 lds
  ds_read_b128 v[184:187], v1 offset:28672
  v_exp_f32 v34, v230
  v_exp_f32 v35, v231
  s_mov_b32 m0, s58
  s_mov_b32 s32, 0x18000
  v_mfma_f32_32x32x16_bf16 v[144:159], a[180:183], v[164:167], v[144:159]
  ds_read_b64_tr_b16 a[56:57], v17 offset:4096
  ds_read_b64_tr_b16 a[58:59], v17 offset:5120
  buffer_load_dwordx4 v10, s[16:19], s32 offen offset:0 lds
  v_fma_f32 v28, v28, s33, s33
  v_fma_f32 v29, v29, s33, s33
  v_fma_f32 v30, v30, s33, s33
  s_waitcnt lgkmcnt(12)
  v_mfma_f32_32x32x16_bf16 v[128:143], a[216:219], v[168:171], v[128:143]
  s_waitcnt vmcnt(13)
  ds_read_b64_tr_b16 a[60:61], v16 offset:6144
  ds_read_b64_tr_b16 a[62:63], v16 offset:7168
  ds_read_b128 v[188:191], v1 offset:29696
  buffer_load_dwordx4 v11, s[16:19], s32 offen offset:1024 lds
  v_fma_f32 v31, v31, s33, s33
  v_fma_f32 v32, v32, s33, s33
  v_fma_f32 v33, v33, s33, s33
  v_fma_f32 v34, v34, s33, s33
  v_mfma_f32_32x32x16_bf16 v[144:159], a[184:187], v[168:171], v[144:159]
  ds_read_b64_tr_b16 a[252:253], v17 offset:6144
  ds_read_b64_tr_b16 a[254:255], v17 offset:7168
  v_fma_f32 v35, v35, s33, s33
  v_rcp_f32 v28, v28
  s_waitcnt lgkmcnt(15)
  v_mfma_f32_32x32x16_bf16 v[128:143], a[188:191], v[172:175], v[128:143]
  ds_read_b128 v[160:163], v1 offset:6144
  buffer_load_dwordx4 v12, s[16:19], s32 offen offset:2048 lds
  v_rcp_f32 v29, v29
  v_rcp_f32 v30, v30
  v_mfma_f32_32x32x16_bf16 v[144:159], a[220:223], v[172:175], v[144:159]
  v_rcp_f32 v31, v31
  v_rcp_f32 v32, v32
  s_waitcnt lgkmcnt(15)
  v_mfma_f32_32x32x16_bf16 v[128:143], a[0:3], v[176:179], v[128:143]
  buffer_load_dwordx4 v13, s[16:19], s32 offen offset:3072 lds
  ds_read_b128 v[164:167], v1 offset:7168
  v_rcp_f32 v33, v33
  v_rcp_f32 v34, v34
  s_mov_b32 m0, s59
  s_mov_b32 s32, 0x24000
  v_mfma_f32_32x32x16_bf16 v[144:159], a[4:7], v[176:179], v[144:159]
  buffer_load_dwordx4 v10, s[16:19], s32 offen offset:0 lds
  v_rcp_f32 v35, v35
  v_mul_f32 v28, v224, v28
  v_mul_f32 v29, v225, v29
  s_waitcnt lgkmcnt(14)
  v_mfma_f32_32x32x16_bf16 v[128:143], a[224:227], v[180:183], v[128:143]
  ds_read_b128 v[168:171], v1 offset:14336
  buffer_load_dwordx4 v11, s[16:19], s32 offen offset:1024 lds
  v_mul_f32 v30, v226, v30
  v_mul_f32 v31, v227, v31
  v_mul_f32 v32, v228, v32
  v_and_b32 v63, 31, v0
  v_lshlrev_b32 v63, 7, v63
  v_and_b32 v26, 7, v0
  v_lshl_add_u32 v63, v26, 4, v63
  v_mfma_f32_32x32x16_bf16 v[144:159], a[8:11], v[180:183], v[144:159]
  v_mul_f32 v33, v229, v33
  v_mul_f32 v34, v230, v34
  v_mul_f32 v35, v231, v35
  v_cvt_pk_bf16_f32 v224, v28, v29
  v_lshrrev_b32 v26, 5, v0
  v_lshl_add_u32 v63, v26, 3, v63
  v_add_u32 v63, s69, v63
  v_xor_b32 v44, 0, v63
  s_waitcnt lgkmcnt(10)
  v_mfma_f32_32x32x16_bf16 v[128:143], a[12:15], v[184:187], v[128:143]
  buffer_load_dwordx4 v12, s[16:19], s32 offen offset:2048 lds
  ds_read_b128 v[172:175], v1 offset:15360
  s_waitcnt vmcnt(9)
  ds_read_b64 v[44:45], v44
  v_cvt_pk_bf16_f32 v225, v30, v31
  v_cvt_pk_bf16_f32 v226, v32, v33
  v_cvt_pk_bf16_f32 v227, v34, v35
  v_xor_b32 v46, 64, v63
  v_xor_b32 v48, 16, v63
  v_mfma_f32_32x32x16_bf16 v[144:159], a[228:231], v[184:187], v[144:159]
  ds_read_b64 v[46:47], v46
  buffer_load_dwordx4 v13, s[16:19], s32 offen offset:3072 lds
  ds_read_b64 v[48:49], v48
  v_exp_f32 v28, v232
  v_exp_f32 v29, v233
  v_xor_b32 v50, 80, v63
  s_mov_b32 m0, s54
  s_mov_b32 s32, 0x30000
  s_waitcnt lgkmcnt(9)
  v_mfma_f32_32x32x16_bf16 v[128:143], a[16:19], v[188:191], v[128:143]
  ds_read_b64 v[50:51], v50
  ds_read_b128 v[176:179], v1 offset:22528
  ds_read_b64_tr_b16 v[64:65], v16 offset:8192
  ds_read_b64_tr_b16 v[66:67], v16 offset:9216
  buffer_load_dwordx4 v10, s[16:19], s32 offen offset:0 lds
  ds_read_b64_tr_b16 v[68:69], v17 offset:8192
  ds_read_b64_tr_b16 v[70:71], v17 offset:9216
  v_exp_f32 v30, v234
  v_exp_f32 v31, v235
  v_xor_b32 v52, 32, v63
  v_xor_b32 v54, 96, v63
  s_waitcnt lgkmcnt(8)
  v_lshlrev_b32 v192, 16, v44
  v_and_b32 v193, s27, v44
  v_mfma_f32_32x32x16_bf16 v[144:159], a[20:23], v[188:191], v[144:159]
  ds_read_b64 v[52:53], v52
  buffer_load_dwordx4 v11, s[16:19], s32 offen offset:1024 lds
  ds_read_b64 v[54:55], v54
  ds_read_b64_tr_b16 v[72:73], v16 offset:10240
  ds_read_b64_tr_b16 v[74:75], v16 offset:11264
  buffer_load_dwordx4 v12, s[16:19], s32 offen offset:2048 lds
  v_exp_f32 v32, v236
  v_exp_f32 v33, v237
  v_xor_b32 v56, 48, v63
  v_xor_b32 v58, 112, v63
  v_lshlrev_b32 v194, 16, v45
  v_and_b32 v195, s27, v45
  v_mfma_f32_32x32x16_bf16 v[128:143], a[232:235], v[160:163], v[128:143]
  ds_read_b64 v[56:57], v56
  ds_read_b64 v[58:59], v58
  ds_read_b64_tr_b16 v[76:77], v17 offset:10240
  ds_read_b64_tr_b16 v[78:79], v17 offset:11264
  ds_read_b128 v[180:183], v1 offset:23552
  buffer_load_dwordx4 v13, s[16:19], s32 offen offset:3072 lds
  v_exp_f32 v34, v238
  v_exp_f32 v35, v239
  s_waitcnt lgkmcnt(15)
  v_lshlrev_b32 v208, 16, v46
  v_and_b32 v209, s27, v46
  s_mov_b32 m0, s55
  s_mov_b32 s32, 0x3c000
  v_mfma_f32_32x32x16_bf16 v[144:159], a[24:27], v[160:163], v[144:159]
  ds_read_b64_tr_b16 v[80:81], v16 offset:12288
  ds_read_b64_tr_b16 v[82:83], v16 offset:13312
  buffer_load_dwordx4 v10, s[16:19], s32 offen offset:0 lds
  v_fma_f32 v28, v28, s33, s33
  v_fma_f32 v29, v29, s33, s33
  v_fma_f32 v30, v30, s33, s33
  v_fma_f32 v31, v31, s33, s33
  v_lshlrev_b32 v210, 16, v47
  v_and_b32 v211, s27, v47
  v_mfma_f32_32x32x16_bf16 v[128:143], a[28:31], v[164:167], v[128:143]
  ds_read_b64_tr_b16 v[84:85], v17 offset:12288
  ds_read_b64_tr_b16 v[86:87], v17 offset:13312
  ds_read_b128 v[184:187], v1 offset:30720
  buffer_load_dwordx4 v11, s[16:19], s32 offen offset:1024 lds
  v_fma_f32 v32, v32, s33, s33
  v_fma_f32 v33, v33, s33, s33
  v_fma_f32 v34, v34, s33, s33
  s_waitcnt lgkmcnt(15)
  v_lshlrev_b32 v196, 16, v48
  v_and_b32 v197, s27, v48
  v_mfma_f32_32x32x16_bf16 v[144:159], a[236:239], v[164:167], v[144:159]
  buffer_load_dwordx4 v12, s[16:19], s32 offen offset:2048 lds
  v_fma_f32 v35, v35, s33, s33
  v_rcp_f32 v28, v28
  v_rcp_f32 v29, v29
  v_lshlrev_b32 v198, 16, v49
  v_and_b32 v199, s27, v49
  v_mfma_f32_32x32x16_bf16 v[128:143], a[32:35], v[168:171], v[128:143]
  ds_read_b128 v[188:191], v1 offset:31744
  buffer_load_dwordx4 v13, s[16:19], s32 offen offset:3072 lds
  v_rcp_f32 v30, v30
  v_rcp_f32 v31, v31
  s_waitcnt lgkmcnt(15)
  v_lshlrev_b32 v212, 16, v50
  v_and_b32 v213, s27, v50
  v_mfma_f32_32x32x16_bf16 v[144:159], a[36:39], v[168:171], v[144:159]
  v_rcp_f32 v32, v32
  v_lshlrev_b32 v214, 16, v51
  v_and_b32 v215, s27, v51
  s_mov_b32 m0, s56
  s_mov_b32 s32, 0x48000
  v_mfma_f32_32x32x16_bf16 v[128:143], a[240:243], v[172:175], v[128:143]
  ds_read_b128 v[160:163], v1 offset:32768
  s_waitcnt lgkmcnt(15)
  buffer_load_dwordx4 v10, s[16:19], s32 offen offset:0 lds
  v_rcp_f32 v33, v33
  v_rcp_f32 v34, v34
  s_waitcnt lgkmcnt(15)
  v_lshlrev_b32 v200, 16, v52
  v_and_b32 v201, s27, v52
  v_mfma_f32_32x32x16_bf16 v[144:159], a[40:43], v[172:175], v[144:159]
  buffer_load_dwordx4 v11, s[16:19], s32 offen offset:1024 lds
  v_rcp_f32 v35, v35
  v_mul_f32 v28, v232, v28
  v_mul_f32 v29, v233, v29
  v_lshlrev_b32 v202, 16, v53
  v_and_b32 v203, s27, v53
  v_mfma_f32_32x32x16_bf16 v[128:143], a[44:47], v[176:179], v[128:143]
  ds_read_b128 v[164:167], v1 offset:33792
  s_waitcnt vmcnt(18)
  ds_read_b64_tr_b16 v[88:89], v16 offset:14336
  ds_read_b64_tr_b16 v[90:91], v16 offset:15360
  s_waitcnt lgkmcnt(11)
  buffer_load_dwordx4 v12, s[16:19], s32 offen offset:2048 lds
  v_mul_f32 v30, v234, v30
  v_mul_f32 v31, v235, v31
  v_mul_f32 v32, v236, v32
  v_mul_f32 v33, v237, v33
  v_lshlrev_b32 v216, 16, v54
  v_and_b32 v217, s27, v54
  v_mfma_f32_32x32x16_bf16 v[144:159], a[244:247], v[176:179], v[144:159]
  ds_read_b64_tr_b16 v[92:93], v17 offset:14336
  ds_read_b64_tr_b16 v[94:95], v17 offset:15360
  buffer_load_dwordx4 v13, s[16:19], s32 offen offset:3072 lds
  v_mul_f32 v34, v238, v34
  v_mul_f32 v35, v239, v35
  v_cvt_pk_bf16_f32 v232, v28, v29
  v_cvt_pk_bf16_f32 v233, v30, v31
  v_lshlrev_b32 v218, 16, v55
  v_and_b32 v219, s27, v55
  s_mov_b32 m0, s57
  s_mov_b32 s32, 0x54000
  s_waitcnt lgkmcnt(12)
  v_mfma_f32_32x32x16_bf16 v[128:143], a[48:51], v[180:183], v[128:143]
  ds_read_b128 v[168:171], v1 offset:40960
  s_waitcnt vmcnt(18)
  ds_read_b64_tr_b16 v[96:97], v16 offset:16384
  ds_read_b64_tr_b16 v[98:99], v16 offset:17408
  s_waitcnt lgkmcnt(11)
  buffer_load_dwordx4 v10, s[16:19], s32 offen offset:0 lds
  v_cvt_pk_bf16_f32 v234, v32, v33
  v_cvt_pk_bf16_f32 v235, v34, v35
  v_exp_f32 v28, v240
  v_lshlrev_b32 v204, 16, v56
  v_and_b32 v205, s27, v56
  v_mfma_f32_32x32x16_bf16 v[144:159], a[52:55], v[180:183], v[144:159]
  ds_read_b64_tr_b16 v[100:101], v17 offset:16384
  ds_read_b64_tr_b16 v[102:103], v17 offset:17408
  buffer_load_dwordx4 v11, s[16:19], s32 offen offset:1024 lds
  v_exp_f32 v29, v241
  v_exp_f32 v30, v242
  v_lshlrev_b32 v206, 16, v57
  v_and_b32 v207, s27, v57
  s_waitcnt lgkmcnt(12)
  v_mfma_f32_32x32x16_bf16 v[128:143], a[248:251], v[184:187], v[128:143]
  ds_read_b128 v[172:175], v1 offset:41984
  s_waitcnt vmcnt(18)
  ds_read_b64_tr_b16 v[104:105], v16 offset:18432
  ds_read_b64_tr_b16 v[106:107], v16 offset:19456
  v_exp_f32 v31, v243
  v_exp_f32 v32, v244
  v_lshlrev_b32 v220, 16, v58
  v_and_b32 v221, s27, v58
  v_mfma_f32_32x32x16_bf16 v[144:159], a[56:59], v[184:187], v[144:159]
  ds_read_b64_tr_b16 v[108:109], v17 offset:18432
  ds_read_b64_tr_b16 v[110:111], v17 offset:19456
  v_exp_f32 v33, v245
  v_exp_f32 v34, v246
  v_lshlrev_b32 v222, 16, v59
  v_and_b32 v223, s27, v59
  s_waitcnt lgkmcnt(15)
  v_mfma_f32_32x32x16_bf16 v[128:143], a[60:63], v[188:191], v[128:143]
  ds_read_b128 v[176:179], v1 offset:49152
  v_exp_f32 v35, v247
  v_fma_f32 v28, v28, s33, s33
  v_mfma_f32_32x32x16_bf16 v[144:159], a[252:255], v[188:191], v[144:159]
  s_waitcnt vmcnt(16)
  ds_read_b64_tr_b16 v[112:113], v16 offset:20480
  ds_read_b64_tr_b16 v[114:115], v16 offset:21504
  v_fma_f32 v29, v29, s33, s33
  v_fma_f32 v30, v30, s33, s33
  v_fma_f32 v31, v31, s33, s33
  s_waitcnt lgkmcnt(15)
  v_mfma_f32_32x32x16_bf16 v[192:207], a[64:67], v[160:163], v[192:207]
  ds_read_b64_tr_b16 v[116:117], v17 offset:20480
  ds_read_b64_tr_b16 v[118:119], v17 offset:21504
  ds_read_b128 v[180:183], v1 offset:50176
  v_fma_f32 v32, v32, s33, s33
  v_fma_f32 v33, v33, s33, s33
  v_fma_f32 v34, v34, s33, s33
  v_fma_f32 v35, v35, s33, s33
  v_mfma_f32_32x32x16_bf16 v[208:223], a[68:71], v[160:163], v[208:223]
  v_rcp_f32 v28, v28
  v_rcp_f32 v29, v29
  s_waitcnt lgkmcnt(15)
  v_mfma_f32_32x32x16_bf16 v[192:207], a[72:75], v[164:167], v[192:207]
  ds_read_b128 v[184:187], v1 offset:57344
  s_waitcnt vmcnt(14)
  ds_read_b64_tr_b16 v[120:121], v16 offset:22528
  ds_read_b64_tr_b16 v[122:123], v16 offset:23552
  v_bfi_b32 v128, s35, v27, v128
  v_bfi_b32 v130, s35, v27, v130
  v_mfma_f32_32x32x16_bf16 v[208:223], a[76:79], v[164:167], v[208:223]
  buffer_store_dwordx4 v[128:131], v1, s[20:23], s50 offen offset:0 sc1
  ds_read_b64_tr_b16 v[124:125], v17 offset:22528
  ds_read_b64_tr_b16 v[126:127], v17 offset:23552
  v_bfi_b32 v132, s35, v27, v132
  v_bfi_b32 v134, s35, v27, v134
  s_waitcnt lgkmcnt(15)
  v_mfma_f32_32x32x16_bf16 v[192:207], a[80:83], v[168:171], v[192:207]
  buffer_store_dwordx4 v[132:135], v1, s[20:23], s50 offen offset:1024 sc1
  ds_read_b128 v[188:191], v1 offset:58368
  v_bfi_b32 v136, s35, v27, v136
  v_bfi_b32 v138, s35, v27, v138
  v_mfma_f32_32x32x16_bf16 v[208:223], a[84:87], v[168:171], v[208:223]
  buffer_store_dwordx4 v[136:139], v1, s[20:23], s50 offen offset:2048 sc1
  v_bfi_b32 v140, s35, v27, v140
  v_bfi_b32 v142, s35, v27, v142
  s_waitcnt lgkmcnt(15)
  v_mfma_f32_32x32x16_bf16 v[192:207], a[88:91], v[172:175], v[192:207]
  buffer_store_dwordx4 v[140:143], v1, s[20:23], s50 offen offset:3072 sc1
  s_waitcnt vmcnt(16)
  ds_read_b64_tr_b16 a[64:65], v16 offset:0
  ds_read_b64_tr_b16 a[66:67], v16 offset:1024
  ds_read_b128 v[160:163], v1 offset:34816
  v_bfi_b32 v144, s35, v27, v144
  v_bfi_b32 v146, s35, v27, v146
  s_addk_i32 s50, 0x1000
  v_mfma_f32_32x32x16_bf16 v[208:223], a[92:95], v[172:175], v[208:223]
  buffer_store_dwordx4 v[144:147], v1, s[20:23], s50 offen offset:0 sc1
  ds_read_b64_tr_b16 a[68:69], v17 offset:0
  ds_read_b64_tr_b16 a[70:71], v17 offset:1024
  v_bfi_b32 v148, s35, v27, v148
  v_bfi_b32 v150, s35, v27, v150
  s_waitcnt lgkmcnt(15)
  v_mfma_f32_32x32x16_bf16 v[192:207], a[96:99], v[176:179], v[192:207]
  buffer_store_dwordx4 v[148:151], v1, s[20:23], s50 offen offset:1024 sc1
  ds_read_b128 v[164:167], v1 offset:35840
  v_bfi_b32 v152, s35, v27, v152
  v_bfi_b32 v154, s35, v27, v154
  v_mfma_f32_32x32x16_bf16 v[208:223], a[100:103], v[176:179], v[208:223]
  buffer_store_dwordx4 v[152:155], v1, s[20:23], s50 offen offset:2048 sc1
  s_waitcnt vmcnt(17)
  ds_read_b64_tr_b16 a[72:73], v16 offset:2048
  ds_read_b64_tr_b16 a[74:75], v16 offset:3072
  v_bfi_b32 v156, s35, v27, v156
  v_bfi_b32 v158, s35, v27, v158
  s_waitcnt lgkmcnt(14)
  v_mfma_f32_32x32x16_bf16 v[192:207], a[104:107], v[180:183], v[192:207]
  buffer_store_dwordx4 v[156:159], v1, s[20:23], s50 offen offset:3072 sc1
  ds_read_b64_tr_b16 a[76:77], v17 offset:2048
  ds_read_b64_tr_b16 a[78:79], v17 offset:3072
  ds_read_b128 v[168:171], v1 offset:43008
  v_rcp_f32 v30, v30
  v_rcp_f32 v31, v31
  v_rcp_f32 v32, v32
  v_mfma_f32_32x32x16_bf16 v[208:223], a[108:111], v[180:183], v[208:223]
  s_waitcnt vmcnt(16)
  ds_read_b64_tr_b16 a[80:81], v16 offset:4096
  ds_read_b64_tr_b16 a[82:83], v16 offset:5120
  v_rcp_f32 v33, v33
  v_rcp_f32 v34, v34
  v_rcp_f32 v35, v35
  v_mul_f32 v28, v240, v28
  s_waitcnt lgkmcnt(15)
  v_mfma_f32_32x32x16_bf16 v[192:207], a[112:115], v[184:187], v[192:207]
  ds_read_b64_tr_b16 a[84:85], v17 offset:4096
  ds_read_b64_tr_b16 a[86:87], v17 offset:5120
  ds_read_b128 v[172:175], v1 offset:44032
  v_mul_f32 v29, v241, v29
  v_mul_f32 v30, v242, v30
  v_mul_f32 v31, v243, v31
  v_mul_f32 v32, v244, v32
  v_mul_f32 v33, v245, v33
  v_mul_f32 v34, v246, v34
  v_mfma_f32_32x32x16_bf16 v[208:223], a[116:119], v[184:187], v[208:223]
  s_waitcnt vmcnt(14)
  ds_read_b64_tr_b16 a[88:89], v16 offset:6144
  ds_read_b64_tr_b16 a[90:91], v16 offset:7168
  v_mul_f32 v35, v247, v35
  v_cvt_pk_bf16_f32 v240, v28, v29
  v_cvt_pk_bf16_f32 v241, v30, v31
  v_cvt_pk_bf16_f32 v242, v32, v33
  v_cvt_pk_bf16_f32 v243, v34, v35
  s_waitcnt lgkmcnt(15)
  v_mfma_f32_32x32x16_bf16 v[192:207], a[120:123], v[188:191], v[192:207]
  ds_read_b64_tr_b16 a[92:93], v17 offset:6144
  ds_read_b64_tr_b16 a[94:95], v17 offset:7168
  ds_read_b128 v[176:179], v1 offset:51200
  v_exp_f32 v28, v248
  v_exp_f32 v29, v249
  v_exp_f32 v30, v250
  v_mfma_f32_32x32x16_bf16 v[208:223], a[124:127], v[188:191], v[208:223]
  s_waitcnt vmcnt(12)
  ds_read_b64_tr_b16 a[96:97], v16 offset:8192
  ds_read_b64_tr_b16 a[98:99], v16 offset:9216
  v_exp_f32 v31, v251
  v_exp_f32 v32, v252
  v_exp_f32 v33, v253
  v_exp_f32 v34, v254
  s_waitcnt lgkmcnt(15)
  v_mfma_f32_32x32x16_bf16 v[192:207], a[128:131], v[160:163], v[192:207]
  ds_read_b64_tr_b16 a[100:101], v17 offset:8192
  ds_read_b64_tr_b16 a[102:103], v17 offset:9216
  ds_read_b128 v[180:183], v1 offset:52224
  v_exp_f32 v35, v255
  v_fma_f32 v28, v28, s33, s33
  v_fma_f32 v29, v29, s33, s33
  v_fma_f32 v30, v30, s33, s33
  v_mfma_f32_32x32x16_bf16 v[208:223], a[132:135], v[160:163], v[208:223]
  s_waitcnt vmcnt(10)
  ds_read_b64_tr_b16 a[104:105], v16 offset:10240
  ds_read_b64_tr_b16 a[106:107], v16 offset:11264
  v_fma_f32 v31, v31, s33, s33
  v_fma_f32 v32, v32, s33, s33
  v_fma_f32 v33, v33, s33, s33
  v_fma_f32 v34, v34, s33, s33
  v_fma_f32 v35, v35, s33, s33
  v_rcp_f32 v28, v28
  s_waitcnt lgkmcnt(15)
  v_mfma_f32_32x32x16_bf16 v[192:207], a[192:195], v[164:167], v[192:207]
  ds_read_b64_tr_b16 a[108:109], v17 offset:10240
  ds_read_b64_tr_b16 a[110:111], v17 offset:11264
  ds_read_b128 v[184:187], v1 offset:59392
  v_rcp_f32 v29, v29
  v_rcp_f32 v30, v30
  v_rcp_f32 v31, v31
  v_mfma_f32_32x32x16_bf16 v[208:223], a[136:139], v[164:167], v[208:223]
  v_rcp_f32 v32, v32
  v_rcp_f32 v33, v33
  v_rcp_f32 v34, v34
  s_waitcnt lgkmcnt(15)
  v_mfma_f32_32x32x16_bf16 v[192:207], a[140:143], v[168:171], v[192:207]
  s_waitcnt vmcnt(8)
  ds_read_b64_tr_b16 a[112:113], v16 offset:12288
  ds_read_b64_tr_b16 a[114:115], v16 offset:13312
  ds_read_b128 v[188:191], v1 offset:60416
  v_rcp_f32 v35, v35
  v_mul_f32 v28, v248, v28
  v_mul_f32 v29, v249, v29
  v_mul_f32 v30, v250, v30
  v_mul_f32 v31, v251, v31
  v_mfma_f32_32x32x16_bf16 v[208:223], a[196:199], v[168:171], v[208:223]
  ds_read_b64_tr_b16 a[116:117], v17 offset:12288
  ds_read_b64_tr_b16 a[118:119], v17 offset:13312
  v_mul_f32 v32, v252, v32
  v_mul_f32 v33, v253, v33
  v_mul_f32 v34, v254, v34
  v_mul_f32 v35, v255, v35
  v_cvt_pk_bf16_f32 v248, v28, v29
  v_cvt_pk_bf16_f32 v249, v30, v31
  s_waitcnt lgkmcnt(15)
  v_mfma_f32_32x32x16_bf16 v[192:207], a[144:147], v[172:175], v[192:207]
  v_cvt_pk_bf16_f32 v250, v32, v33
  v_cvt_pk_bf16_f32 v251, v34, v35
  v_mfma_f32_32x32x16_bf16 v[208:223], a[148:151], v[172:175], v[208:223]
  s_waitcnt lgkmcnt(15)
  v_mfma_f32_32x32x16_bf16 v[192:207], a[200:203], v[176:179], v[192:207]
  ds_write_b128 v21, v[224:227] offset:36864
  ds_write_b128 v21, v[232:235] offset:37888
  ds_write_b128 v21, v[240:243] offset:38912
  ds_write_b128 v21, v[248:251] offset:39936
  buffer_load_dwordx4 v12, s[16:19], s32 offen offset:2048 lds
  buffer_load_dwordx4 v13, s[16:19], s32 offen offset:3072 lds
  v_mfma_f32_32x32x16_bf16 v[208:223], a[152:155], v[176:179], v[208:223]
  s_mov_b32 m0, s58
  s_mov_b32 s32, 0x200
  s_waitcnt lgkmcnt(14)
  v_mfma_f32_32x32x16_bf16 v[192:207], a[156:159], v[180:183], v[192:207]
  buffer_load_dwordx4 v10, s[16:19], s32 offen offset:0 lds
  v_mfma_f32_32x32x16_bf16 v[208:223], a[204:207], v[180:183], v[208:223]
  s_waitcnt lgkmcnt(9)
  v_mfma_f32_32x32x16_bf16 v[192:207], a[160:163], v[184:187], v[192:207]
  buffer_load_dwordx4 v11, s[16:19], s32 offen offset:1024 lds
  s_waitcnt lgkmcnt(0)
  s_barrier
  buffer_load_dwordx4 v12, s[16:19], s32 offen offset:2048 lds
  v_mfma_f32_32x32x16_bf16 v[208:223], a[164:167], v[184:187], v[208:223]
  ds_read_b128 v[160:163], v1 offset:36864
  ds_read_b128 v[164:167], v1 offset:37888
  ds_read_b128 v[168:171], v1 offset:45056
  ds_read_b128 v[172:175], v1 offset:46080
  v_mfma_f32_32x32x16_bf16 v[192:207], a[208:211], v[188:191], v[192:207]
  ds_read_b128 v[176:179], v1 offset:53248
  buffer_load_dwordx4 v13, s[16:19], s32 offen offset:3072 lds
  s_mov_b32 m0, s59
  s_mov_b32 s32, 0xc200
  v_mfma_f32_32x32x16_bf16 v[208:223], a[168:171], v[188:191], v[208:223]
  buffer_load_dwordx4 v10, s[16:19], s32 offen offset:0 lds
  s_waitcnt lgkmcnt(4)
  v_mfma_f32_32x32x16_bf16 v[192:207], a[172:175], v[160:163], v[192:207]
  ds_read_b128 v[180:183], v1 offset:54272
  v_mfma_f32_32x32x16_bf16 v[208:223], a[212:215], v[160:163], v[208:223]
  buffer_load_dwordx4 v11, s[16:19], s32 offen offset:1024 lds
  s_waitcnt lgkmcnt(4)
  v_mfma_f32_32x32x16_bf16 v[192:207], a[176:179], v[164:167], v[192:207]
  ds_read_b128 v[184:187], v1 offset:61440
  v_mfma_f32_32x32x16_bf16 v[208:223], a[180:183], v[164:167], v[208:223]
  buffer_load_dwordx4 v12, s[16:19], s32 offen offset:2048 lds
  s_waitcnt lgkmcnt(4)
  v_mfma_f32_32x32x16_bf16 v[192:207], a[216:219], v[168:171], v[192:207]
  ds_read_b128 v[188:191], v1 offset:62464
  v_mfma_f32_32x32x16_bf16 v[208:223], a[184:187], v[168:171], v[208:223]
  buffer_load_dwordx4 v13, s[16:19], s32 offen offset:3072 lds
  s_mov_b32 m0, s54
  s_mov_b32 s32, 0x18200
  s_waitcnt lgkmcnt(4)
  v_mfma_f32_32x32x16_bf16 v[192:207], a[188:191], v[172:175], v[192:207]
  ds_read_b128 v[160:163], v1 offset:38912
  buffer_load_dwordx4 v10, s[16:19], s32 offen offset:0 lds
  v_mfma_f32_32x32x16_bf16 v[208:223], a[220:223], v[172:175], v[208:223]
  s_waitcnt lgkmcnt(4)
  v_mfma_f32_32x32x16_bf16 v[192:207], a[0:3], v[176:179], v[192:207]
  ds_read_b128 v[164:167], v1 offset:39936
  buffer_load_dwordx4 v11, s[16:19], s32 offen offset:1024 lds
  v_mfma_f32_32x32x16_bf16 v[208:223], a[4:7], v[176:179], v[208:223]
  s_waitcnt lgkmcnt(4)
  v_mfma_f32_32x32x16_bf16 v[192:207], a[224:227], v[180:183], v[192:207]
  ds_read_b128 v[168:171], v1 offset:47104
  buffer_load_dwordx4 v12, s[16:19], s32 offen offset:2048 lds
  v_mfma_f32_32x32x16_bf16 v[208:223], a[8:11], v[180:183], v[208:223]
  s_waitcnt lgkmcnt(4)
  v_mfma_f32_32x32x16_bf16 v[192:207], a[12:15], v[184:187], v[192:207]
  buffer_load_dwordx4 v13, s[16:19], s32 offen offset:3072 lds
  ds_read_b128 v[172:175], v1 offset:48128
  buffer_load_dwordx4 v[224:227], v1, s[20:23], s49 offen offset:0 sc1
  v_mfma_f32_32x32x16_bf16 v[208:223], a[228:231], v[184:187], v[208:223]
  buffer_load_dwordx4 v[228:231], v1, s[20:23], s49 offen offset:1024 sc1
  s_waitcnt lgkmcnt(4)
  v_mfma_f32_32x32x16_bf16 v[192:207], a[16:19], v[188:191], v[192:207]
  ds_read_b128 v[176:179], v1 offset:55296
  buffer_load_dwordx4 v[232:235], v1, s[20:23], s49 offen offset:2048 sc1
  v_mfma_f32_32x32x16_bf16 v[208:223], a[20:23], v[188:191], v[208:223]
  buffer_load_dwordx4 v[236:239], v1, s[20:23], s49 offen offset:3072 sc1
  s_waitcnt lgkmcnt(4)
  v_mfma_f32_32x32x16_bf16 v[192:207], a[232:235], v[160:163], v[192:207]
  ds_read_b128 v[180:183], v1 offset:56320
  buffer_load_dwordx4 v[240:243], v62, s[20:23], s49 offen offset:0 sc1
  v_mfma_f32_32x32x16_bf16 v[208:223], a[24:27], v[160:163], v[208:223]
  buffer_load_dwordx4 v[244:247], v62, s[20:23], s49 offen offset:1024 sc1
  s_waitcnt lgkmcnt(4)
  v_mfma_f32_32x32x16_bf16 v[192:207], a[28:31], v[164:167], v[192:207]
  ds_read_b128 v[184:187], v1 offset:63488
  buffer_load_dwordx4 v[248:251], v62, s[20:23], s49 offen offset:2048 sc1
  v_mfma_f32_32x32x16_bf16 v[208:223], a[236:239], v[164:167], v[208:223]
  buffer_load_dwordx4 v[252:255], v62, s[20:23], s49 offen offset:3072 sc1
  s_waitcnt lgkmcnt(4)
  v_mfma_f32_32x32x16_bf16 v[192:207], a[32:35], v[168:171], v[192:207]
  s_waitcnt vmcnt(20)
  ds_read_b64_tr_b16 a[120:121], v16 offset:14336
  ds_read_b64_tr_b16 a[122:123], v16 offset:15360
  ds_read_b128 v[188:191], v1 offset:64512
  v_mfma_f32_32x32x16_bf16 v[208:223], a[36:39], v[168:171], v[208:223]
  ds_read_b64_tr_b16 a[124:125], v17 offset:14336
  ds_read_b64_tr_b16 a[126:127], v17 offset:15360
  s_mov_b32 m0, s55
  s_mov_b32 s32, 0x24200
  s_waitcnt lgkmcnt(8)
  v_mfma_f32_32x32x16_bf16 v[192:207], a[240:243], v[172:175], v[192:207]
  s_waitcnt vmcnt(18)
  ds_read_b64_tr_b16 a[128:129], v16 offset:16384
  ds_read_b64_tr_b16 a[130:131], v16 offset:17408
  buffer_load_dwordx4 v10, s[16:19], s32 offen offset:0 lds
  v_mfma_f32_32x32x16_bf16 v[208:223], a[40:43], v[172:175], v[208:223]
  ds_read_b64_tr_b16 a[132:133], v17 offset:16384
  ds_read_b64_tr_b16 a[134:135], v17 offset:17408
  s_waitcnt lgkmcnt(11)
  v_mfma_f32_32x32x16_bf16 v[192:207], a[44:47], v[176:179], v[192:207]
  buffer_load_dwordx4 v11, s[16:19], s32 offen offset:1024 lds
  v_mfma_f32_32x32x16_bf16 v[208:223], a[244:247], v[176:179], v[208:223]
  buffer_load_dwordx4 v12, s[16:19], s32 offen offset:2048 lds
  s_waitcnt lgkmcnt(10)
  v_mfma_f32_32x32x16_bf16 v[192:207], a[48:51], v[180:183], v[192:207]
  s_waitcnt vmcnt(19)
  ds_read_b64_tr_b16 a[192:193], v16 offset:18432
  ds_read_b64_tr_b16 a[194:195], v16 offset:19456
  v_mfma_f32_32x32x16_bf16 v[208:223], a[52:55], v[180:183], v[208:223]
  ds_read_b64_tr_b16 a[136:137], v17 offset:18432
  ds_read_b64_tr_b16 a[138:139], v17 offset:19456
  buffer_load_dwordx4 v13, s[16:19], s32 offen offset:3072 lds
  s_waitcnt lgkmcnt(13)
  v_mfma_f32_32x32x16_bf16 v[192:207], a[248:251], v[184:187], v[192:207]
  s_mov_b32 m0, s56
  s_mov_b32 s32, 0x30200
  v_mfma_f32_32x32x16_bf16 v[208:223], a[56:59], v[184:187], v[208:223]
  s_waitcnt vmcnt(18)
  ds_read_b64_tr_b16 a[140:141], v16 offset:20480
  ds_read_b64_tr_b16 a[142:143], v16 offset:21504
  buffer_load_dwordx4 v10, s[16:19], s32 offen offset:0 lds
  s_waitcnt lgkmcnt(12)
  v_mfma_f32_32x32x16_bf16 v[192:207], a[60:63], v[188:191], v[192:207]
  ds_read_b64_tr_b16 a[196:197], v17 offset:20480
  ds_read_b64_tr_b16 a[198:199], v17 offset:21504
  v_mfma_f32_32x32x16_bf16 v[208:223], a[252:255], v[188:191], v[208:223]
  buffer_load_dwordx4 v11, s[16:19], s32 offen offset:1024 lds
  s_waitcnt vmcnt(18)
  ds_read_b64_tr_b16 a[144:145], v16 offset:22528
  ds_read_b64_tr_b16 a[146:147], v16 offset:23552
  buffer_load_dwordx4 v12, s[16:19], s32 offen offset:2048 lds
  s_waitcnt vmcnt(14)
  v_xor_b32 v224, v27, v224
  v_xor_b32 v226, v27, v226
  v_or_b32 v32, v224, v226
  v_pk_add_f32 v[128:129], v[192:193], v[224:225]
  v_pk_add_f32 v[130:131], v[194:195], v[226:227]
  ds_read_b64_tr_b16 a[148:149], v17 offset:22528
  ds_read_b64_tr_b16 a[150:151], v17 offset:23552
  v_pk_add_f32 v[28:29], v[128:129], v[130:131]
  v_pk_mul_f32 v[30:31], v[128:129], v[128:129]
  v_pk_fma_f32 v[30:31], v[130:131], v[130:131], v[30:31]
  buffer_load_dwordx4 v13, s[16:19], s32 offen offset:3072 lds
  s_waitcnt vmcnt(14)
  v_xor_b32 v228, v27, v228
  v_xor_b32 v230, v27, v230
  v_or3_b32 v32, v32, v228, v230
  v_pk_add_f32 v[132:133], v[196:197], v[228:229]
  v_pk_add_f32 v[134:135], v[198:199], v[230:231]
  v_pk_add_f32 v[28:29], v[28:29], v[132:133]
  v_pk_fma_f32 v[30:31], v[132:133], v[132:133], v[30:31]
  v_pk_add_f32 v[28:29], v[28:29], v[134:135]
  v_pk_fma_f32 v[30:31], v[134:135], v[134:135], v[30:31]
  ds_read_b64_tr_b16 a[200:201], v16 offset:0
  ds_read_b64_tr_b16 a[202:203], v16 offset:1024
  s_mov_b32 m0, s57
  s_mov_b32 s32, 0x3c200
  buffer_load_dwordx4 v10, s[16:19], s32 offen offset:0 lds
  s_waitcnt vmcnt(14)
  v_xor_b32 v232, v27, v232
  v_xor_b32 v234, v27, v234
  v_or3_b32 v32, v32, v232, v234
  v_pk_add_f32 v[136:137], v[200:201], v[232:233]
  ds_read_b64_tr_b16 a[152:153], v17 offset:0
  ds_read_b64_tr_b16 a[154:155], v17 offset:1024
  v_pk_add_f32 v[138:139], v[202:203], v[234:235]
  v_pk_add_f32 v[28:29], v[28:29], v[136:137]
  v_pk_fma_f32 v[30:31], v[136:137], v[136:137], v[30:31]
  buffer_load_dwordx4 v11, s[16:19], s32 offen offset:1024 lds
  v_pk_add_f32 v[28:29], v[28:29], v[138:139]
  v_pk_fma_f32 v[30:31], v[138:139], v[138:139], v[30:31]
  s_waitcnt vmcnt(14)
  v_xor_b32 v236, v27, v236
  v_xor_b32 v238, v27, v238
  v_or3_b32 v32, v32, v236, v238
  v_pk_add_f32 v[140:141], v[204:205], v[236:237]
  v_pk_add_f32 v[142:143], v[206:207], v[238:239]
  v_pk_add_f32 v[28:29], v[28:29], v[140:141]
  v_pk_fma_f32 v[30:31], v[140:141], v[140:141], v[30:31]
  ds_read_b64_tr_b16 a[156:157], v16 offset:2048
  ds_read_b64_tr_b16 a[158:159], v16 offset:3072
  s_waitcnt lgkmcnt(15)
  buffer_load_dwordx4 v12, s[16:19], s32 offen offset:2048 lds
  v_pk_add_f32 v[28:29], v[28:29], v[142:143]
  v_pk_fma_f32 v[30:31], v[142:143], v[142:143], v[30:31]
  s_waitcnt vmcnt(14)
  v_xor_b32 v240, v27, v240
  v_xor_b32 v242, v27, v242
  v_or3_b32 v32, v32, v240, v242
  ds_read_b64_tr_b16 a[204:205], v17 offset:2048
  ds_read_b64_tr_b16 a[206:207], v17 offset:3072
  v_pk_add_f32 v[144:145], v[208:209], v[240:241]
  v_pk_add_f32 v[146:147], v[210:211], v[242:243]
  v_pk_add_f32 v[28:29], v[28:29], v[144:145]
  v_pk_fma_f32 v[30:31], v[144:145], v[144:145], v[30:31]
  buffer_load_dwordx4 v13, s[16:19], s32 offen offset:3072 lds
  v_pk_add_f32 v[28:29], v[28:29], v[146:147]
  v_pk_fma_f32 v[30:31], v[146:147], v[146:147], v[30:31]
  s_waitcnt vmcnt(14)
  v_xor_b32 v244, v27, v244
  v_xor_b32 v246, v27, v246
  v_or3_b32 v32, v32, v244, v246
  v_pk_add_f32 v[148:149], v[212:213], v[244:245]
  v_pk_add_f32 v[150:151], v[214:215], v[246:247]
  v_pk_add_f32 v[28:29], v[28:29], v[148:149]
  v_pk_fma_f32 v[30:31], v[148:149], v[148:149], v[30:31]
  v_pk_add_f32 v[28:29], v[28:29], v[150:151]
  v_pk_fma_f32 v[30:31], v[150:151], v[150:151], v[30:31]
  s_mov_b32 m0, s58
  s_mov_b32 s32, 0x48200
  s_waitcnt lgkmcnt(15)
  buffer_load_dwordx4 v10, s[16:19], s32 offen offset:0 lds
  s_waitcnt vmcnt(14)
  v_xor_b32 v248, v27, v248
  v_xor_b32 v250, v27, v250
  v_or3_b32 v32, v32, v248, v250
  v_pk_add_f32 v[152:153], v[216:217], v[248:249]
  v_pk_add_f32 v[154:155], v[218:219], v[250:251]
  v_pk_add_f32 v[28:29], v[28:29], v[152:153]
  v_pk_fma_f32 v[30:31], v[152:153], v[152:153], v[30:31]
  v_pk_add_f32 v[28:29], v[28:29], v[154:155]
  v_pk_fma_f32 v[30:31], v[154:155], v[154:155], v[30:31]
  buffer_load_dwordx4 v11, s[16:19], s32 offen offset:1024 lds
  s_waitcnt vmcnt(14)
  v_xor_b32 v252, v27, v252
  v_xor_b32 v254, v27, v254
  v_or3_b32 v32, v32, v252, v254
  v_pk_add_f32 v[156:157], v[220:221], v[252:253]
  v_pk_add_f32 v[158:159], v[222:223], v[254:255]
  v_pk_add_f32 v[28:29], v[28:29], v[156:157]
  v_pk_fma_f32 v[30:31], v[156:157], v[156:157], v[30:31]
  v_pk_add_f32 v[28:29], v[28:29], v[158:159]
  v_pk_fma_f32 v[30:31], v[158:159], v[158:159], v[30:31]
  v_and_b32 v32, s35, v32
  v_cmp_ne_u32 vcc, 0, v32
  s_nop 3
  s_cbranch_vccnz A_retry
A_go:
  s_waitcnt lgkmcnt(15)
  buffer_load_dwordx4 v12, s[16:19], s32 offen offset:2048 lds
  v_add_f32 v34, v28, v29
  v_add_f32 v35, v30, v31
  s_nop 1
  v_permlane32_swap_b32 v34, v35
  v_add_f32 v34, v34, v35
  ds_write_b32 v22, v34 offset:0
  buffer_store_dword v61, v60, s[20:23], 0 offen sc1
  v_cvt_pk_bf16_f32 v224, v128, v129
  v_cvt_pk_bf16_f32 v225, v130, v131
  v_cvt_pk_bf16_f32 v226, v144, v145
  v_cvt_pk_bf16_f32 v227, v146, v147
  s_nop 0
  v_permlane32_swap_b32 v224, v226
  v_permlane32_swap_b32 v225, v227
  buffer_store_dwordx4 v[224:227], v1, s[20:23], s62 offen offset:0 sc1
  v_cvt_pk_bf16_f32 v228, v132, v133
  v_cvt_pk_bf16_f32 v229, v134, v135
  v_cvt_pk_bf16_f32 v230, v148, v149
  v_cvt_pk_bf16_f32 v231, v150, v151
  s_nop 0
  v_permlane32_swap_b32 v228, v230
  v_permlane32_swap_b32 v229, v231
  buffer_store_dwordx4 v[228:231], v1, s[20:23], s62 offen offset:1024 sc1
  v_cvt_pk_bf16_f32 v232, v136, v137
  v_cvt_pk_bf16_f32 v233, v138, v139
  v_cvt_pk_bf16_f32 v234, v152, v153
  v_cvt_pk_bf16_f32 v235, v154, v155
  s_nop 0
  v_permlane32_swap_b32 v232, v234
  v_permlane32_swap_b32 v233, v235
  buffer_store_dwordx4 v[232:235], v1, s[20:23], s62 offen offset:2048 sc1
  v_cvt_pk_bf16_f32 v236, v140, v141
  v_cvt_pk_bf16_f32 v237, v142, v143
  v_cvt_pk_bf16_f32 v238, v156, v157
  v_cvt_pk_bf16_f32 v239, v158, v159
  s_nop 0
  v_permlane32_swap_b32 v236, v238
  v_permlane32_swap_b32 v237, v239
  buffer_store_dwordx4 v[236:239], v1, s[20:23], s62 offen offset:3072 sc1
  s_waitcnt lgkmcnt(0)
  s_barrier
  ds_read_b128 v[36:39], v23 offset:0
  ds_read_b128 v[40:43], v23 offset:16
  s_waitcnt lgkmcnt(1)
  v_pk_add_f32 v[36:37], v[36:37], v[38:39]
  s_waitcnt vmcnt(18)
  ds_read_b64_tr_b16 a[160:161], v16 offset:4096
  ds_read_b64_tr_b16 a[162:163], v16 offset:5120
  buffer_load_dwordx4 v13, s[16:19], s32 offen offset:3072 lds
  s_waitcnt lgkmcnt(2)
  v_pk_add_f32 v[40:41], v[40:41], v[42:43]
  v_pk_add_f32 v[36:37], v[36:37], v[40:41]
  v_mul_f32 v38, 0x3b800000, v36
  v_mul_f32 v37, 0x3b800000, v37
  v_fma_f32 v37, -v38, v38, v37
  ds_read_b64_tr_b16 a[164:165], v17 offset:4096
  ds_read_b64_tr_b16 a[166:167], v17 offset:5120
  v_max_f32 v37, 0, v37
  v_add_f32 v37, s34, v37
  v_rsq_f32 v35, v37
  s_mov_b32 m0, s59
  s_mov_b32 s32, 0x54200
  buffer_load_dwordx4 v10, s[16:19], s32 offen offset:0 lds
  v_mul_f32 v38, 0xbed96d27, v38
  v_mul_f32 v34, v38, v35
  v_mul_f32 v35, 0x3ed96d27, v35
  v_pk_fma_f32 v[160:161], v[128:129], v[34:35], v[34:35] op_sel:[0,1,0] op_sel_hi:[1,1,0]
  v_pk_fma_f32 v[162:163], v[130:131], v[34:35], v[34:35] op_sel:[0,1,0] op_sel_hi:[1,1,0]
  v_pk_fma_f32 v[164:165], v[132:133], v[34:35], v[34:35] op_sel:[0,1,0] op_sel_hi:[1,1,0]
  v_pk_fma_f32 v[166:167], v[134:135], v[34:35], v[34:35] op_sel:[0,1,0] op_sel_hi:[1,1,0]
  s_waitcnt vmcnt(18)
  ds_read_b64_tr_b16 a[208:209], v16 offset:6144
  ds_read_b64_tr_b16 a[210:211], v16 offset:7168
  buffer_load_dwordx4 v11, s[16:19], s32 offen offset:1024 lds
  v_cvt_pk_bf16_f32 v44, v160, v161
  v_cvt_pk_bf16_f32 v45, v162, v163
  v_cvt_pk_bf16_f32 v46, v164, v165
  v_cvt_pk_bf16_f32 v47, v166, v167
  v_pk_fma_f32 v[168:169], v[136:137], v[34:35], v[34:35] op_sel:[0,1,0] op_sel_hi:[1,1,0]
  ds_read_b64_tr_b16 a[168:169], v17 offset:6144
  ds_read_b64_tr_b16 a[170:171], v17 offset:7168
  v_pk_fma_f32 v[170:171], v[138:139], v[34:35], v[34:35] op_sel:[0,1,0] op_sel_hi:[1,1,0]
  v_pk_fma_f32 v[172:173], v[140:141], v[34:35], v[34:35] op_sel:[0,1,0] op_sel_hi:[1,1,0]
  v_pk_fma_f32 v[174:175], v[142:143], v[34:35], v[34:35] op_sel:[0,1,0] op_sel_hi:[1,1,0]
  v_cvt_pk_bf16_f32 v48, v168, v169
  v_cvt_pk_bf16_f32 v49, v170, v171
  v_cvt_pk_bf16_f32 v50, v172, v173
  v_cvt_pk_bf16_f32 v51, v174, v175
  v_pk_fma_f32 v[176:177], v[144:145], v[34:35], v[34:35] op_sel:[0,1,0] op_sel_hi:[1,1,0]
  v_pk_fma_f32 v[178:179], v[146:147], v[34:35], v[34:35] op_sel:[0,1,0] op_sel_hi:[1,1,0]
  v_pk_fma_f32 v[180:181], v[148:149], v[34:35], v[34:35] op_sel:[0,1,0] op_sel_hi:[1,1,0]
  v_pk_fma_f32 v[182:183], v[150:151], v[34:35], v[34:35] op_sel:[0,1,0] op_sel_hi:[1,1,0]
  v_cvt_pk_bf16_f32 v52, v176, v177
  v_cvt_pk_bf16_f32 v53, v178, v179
  s_waitcnt vmcnt(17)
  ds_read_b64_tr_b16 a[172:173], v16 offset:8192
  ds_read_b64_tr_b16 a[174:175], v16 offset:9216
  v_cvt_pk_bf16_f32 v54, v180, v181
  v_cvt_pk_bf16_f32 v55, v182, v183
  v_pk_fma_f32 v[184:185], v[152:153], v[34:35], v[34:35] op_sel:[0,1,0] op_sel_hi:[1,1,0]
  v_pk_fma_f32 v[186:187], v[154:155], v[34:35], v[34:35] op_sel:[0,1,0] op_sel_hi:[1,1,0]
  v_pk_fma_f32 v[188:189], v[156:157], v[34:35], v[34:35] op_sel:[0,1,0] op_sel_hi:[1,1,0]
  v_pk_fma_f32 v[190:191], v[158:159], v[34:35], v[34:35] op_sel:[0,1,0] op_sel_hi:[1,1,0]
  ds_read_b64_tr_b16 a[212:213], v17 offset:8192
  ds_read_b64_tr_b16 a[214:215], v17 offset:9216
  v_cvt_pk_bf16_f32 v56, v184, v185
  v_cvt_pk_bf16_f32 v57, v186, v187
  v_cvt_pk_bf16_f32 v58, v188, v189
  v_cvt_pk_bf16_f32 v59, v190, v191
  ds_write_b128 v24, v[44:47] offset:0
  ds_write_b128 v24, v[48:51] offset:1024
  ds_write_b128 v24, v[52:55] offset:2048
  ds_write_b128 v24, v[56:59] offset:3072
  buffer_load_dwordx4 v12, s[16:19], s32 offen offset:2048 lds
  buffer_load_dwordx4 v13, s[16:19], s32 offen offset:3072 lds
  s_waitcnt vmcnt(17)
  ds_read_b64_tr_b16 a[176:177], v16 offset:10240
  ds_read_b64_tr_b16 a[178:179], v16 offset:11264
  s_waitcnt lgkmcnt(2)
  s_barrier
  s_mov_b32 m0, s54
  s_mov_b32 s32, 0x400
  buffer_load_dwordx4 v10, s[16:19], s32 offen offset:0 lds
  ds_read_b64_tr_b16 a[180:181], v17 offset:10240
  ds_read_b64_tr_b16 a[182:183], v17 offset:11264
  ds_read_b128 v[192:195], v1 offset:16384
  ds_read_b128 v[196:199], v1 offset:17408
  ds_read_b128 v[200:203], v1 offset:18432
  ds_read_b128 v[204:207], v1 offset:19456
  buffer_load_dwordx4 v11, s[16:19], s32 offen offset:1024 lds
  s_waitcnt lgkmcnt(3)
  v_mfma_f32_32x32x16_bf16 v[128:143], v[64:67], v[192:195], 0
  s_waitcnt vmcnt(17)
  ds_read_b64_tr_b16 a[216:217], v16 offset:12288
  ds_read_b64_tr_b16 a[218:219], v16 offset:13312
  ds_read_b128 v[208:211], v1 offset:20480
  v_mfma_f32_32x32x16_bf16 v[144:159], v[68:71], v[192:195], 0
  ds_read_b64_tr_b16 a[184:185], v17 offset:12288
  ds_read_b64_tr_b16 a[186:187], v17 offset:13312
  buffer_load_dwordx4 v12, s[16:19], s32 offen offset:2048 lds
  ds_read_b128 v[212:215], v1 offset:21504
  s_waitcnt lgkmcnt(8)
  v_mfma_f32_32x32x16_bf16 v[128:143], v[72:75], v[196:199], v[128:143]
  s_waitcnt vmcnt(16)
  ds_read_b64_tr_b16 a[188:189], v16 offset:14336
  ds_read_b64_tr_b16 a[190:191], v16 offset:15360
  ds_read_b128 v[216:219], v1 offset:22528
  v_mfma_f32_32x32x16_bf16 v[144:159], v[76:79], v[196:199], v[144:159]
  ds_read_b64_tr_b16 a[220:221], v17 offset:14336
  ds_read_b64_tr_b16 a[222:223], v17 offset:15360
  buffer_load_dwordx4 v13, s[16:19], s32 offen offset:3072 lds
  ds_read_b128 v[220:223], v1 offset:23552
  s_mov_b32 m0, s55
  s_mov_b32 s32, 0xc400
  s_waitcnt lgkmcnt(13)
  v_mfma_f32_32x32x16_bf16 v[128:143], v[80:83], v[200:203], v[128:143]
  ds_read_b128 v[224:227], v1 offset:24576
  buffer_load_dwordx4 v10, s[16:19], s32 offen offset:0 lds
  v_mfma_f32_32x32x16_bf16 v[144:159], v[84:87], v[200:203], v[144:159]
  s_waitcnt vmcnt(16)
  ds_read_b64_tr_b16 a[0:1], v16 offset:16384
  ds_read_b64_tr_b16 a[2:3], v16 offset:17408
  ds_read_b128 v[228:231], v1 offset:25600
  s_waitcnt lgkmcnt(15)
  v_mfma_f32_32x32x16_bf16 v[128:143], v[88:91], v[204:207], v[128:143]
  ds_read_b64_tr_b16 a[4:5], v17 offset:16384
  ds_read_b64_tr_b16 a[6:7], v17 offset:17408
  ds_read_b128 v[232:235], v1 offset:26624
  buffer_load_dwordx4 v11, s[16:19], s32 offen offset:1024 lds
  v_mfma_f32_32x32x16_bf16 v[144:159], v[92:95], v[204:207], v[144:159]
  ds_read_b128 v[236:239], v1 offset:27648
  s_waitcnt lgkmcnt(15)
  v_mfma_f32_32x32x16_bf16 v[128:143], v[96:99], v[208:211], v[128:143]
  ds_read_b128 v[240:243], v1 offset:28672
  buffer_load_dwordx4 v12, s[16:19], s32 offen offset:2048 lds
  v_mfma_f32_32x32x16_bf16 v[144:159], v[100:103], v[208:211], v[144:159]
  ds_read_b128 v[244:247], v1 offset:29696
  s_waitcnt lgkmcnt(15)
  v_mfma_f32_32x32x16_bf16 v[128:143], v[104:107], v[212:215], v[128:143]
  buffer_load_dwordx4 v13, s[16:19], s32 offen offset:3072 lds
  ds_read_b128 v[248:251], v1 offset:30720
  s_mov_b32 m0, s56
  s_mov_b32 s32, 0x18400
  v_mfma_f32_32x32x16_bf16 v[144:159], v[108:111], v[212:215], v[144:159]
  ds_read_b128 v[252:255], v1 offset:31744
  buffer_load_dwordx4 v10, s[16:19], s32 offen offset:0 lds
  s_waitcnt lgkmcnt(15)
  v_mfma_f32_32x32x16_bf16 v[128:143], v[112:115], v[216:219], v[128:143]
  v_mfma_f32_32x32x16_bf16 v[144:159], v[116:119], v[216:219], v[144:159]
  buffer_load_dwordx4 v11, s[16:19], s32 offen offset:1024 lds
  s_waitcnt lgkmcnt(12)
  v_mfma_f32_32x32x16_bf16 v[128:143], v[120:123], v[220:223], v[128:143]
  v_mfma_f32_32x32x16_bf16 v[144:159], v[124:127], v[220:223], v[144:159]
  buffer_load_dwordx4 v12, s[16:19], s32 offen offset:2048 lds
  s_waitcnt lgkmcnt(11)
  v_mfma_f32_32x32x16_bf16 v[128:143], a[64:67], v[224:227], v[128:143]
  buffer_load_dwordx4 v13, s[16:19], s32 offen offset:3072 lds
  v_mfma_f32_32x32x16_bf16 v[144:159], a[68:71], v[224:227], v[144:159]
  s_mov_b32 m0, s57
  s_mov_b32 s32, 0x24400
  s_waitcnt lgkmcnt(8)
  v_mfma_f32_32x32x16_bf16 v[128:143], a[72:75], v[228:231], v[128:143]
  buffer_load_dwordx4 v10, s[16:19], s32 offen offset:0 lds
  v_mfma_f32_32x32x16_bf16 v[144:159], a[76:79], v[228:231], v[144:159]
  s_waitcnt lgkmcnt(5)
  v_mfma_f32_32x32x16_bf16 v[128:143], a[80:83], v[232:235], v[128:143]
  buffer_load_dwordx4 v11, s[16:19], s32 offen offset:1024 lds
  v_mfma_f32_32x32x16_bf16 v[144:159], a[84:87], v[232:235], v[144:159]
  s_waitcnt lgkmcnt(4)
  v_mfma_f32_32x32x16_bf16 v[128:143], a[88:91], v[236:239], v[128:143]
  buffer_load_dwordx4 v12, s[16:19], s32 offen offset:2048 lds
  v_mfma_f32_32x32x16_bf16 v[144:159], a[92:95], v[236:239], v[144:159]
  buffer_load_dwordx4 v13, s[16:19], s32 offen offset:3072 lds
  s_waitcnt lgkmcnt(3)
  v_mfma_f32_32x32x16_bf16 v[128:143], a[96:99], v[240:243], v[128:143]
  s_mov_b32 m0, s58
  s_mov_b32 s32, 0x30400
  v_mfma_f32_32x32x16_bf16 v[144:159], a[100:103], v[240:243], v[144:159]
  buffer_load_dwordx4 v10, s[16:19], s32 offen offset:0 lds
  s_waitcnt lgkmcnt(2)
  v_mfma_f32_32x32x16_bf16 v[128:143], a[104:107], v[244:247], v[128:143]
  v_mfma_f32_32x32x16_bf16 v[144:159], a[108:111], v[244:247], v[144:159]
  buffer_load_dwordx4 v11, s[16:19], s32 offen offset:1024 lds
  s_waitcnt lgkmcnt(1)
  v_mfma_f32_32x32x16_bf16 v[128:143], a[112:115], v[248:251], v[128:143]
  v_mfma_f32_32x32x16_bf16 v[144:159], a[116:119], v[248:251], v[144:159]
  s_waitcnt vmcnt(22)
  ds_read_b64_tr_b16 a[224:225], v16 offset:18432
  ds_read_b64_tr_b16 a[226:227], v16 offset:19456
  s_waitcnt lgkmcnt(2)
  v_mfma_f32_32x32x16_bf16 v[128:143], a[120:123], v[252:255], v[128:143]
  ds_read_b64_tr_b16 a[8:9], v17 offset:18432
  ds_read_b64_tr_b16 a[10:11], v17 offset:19456
  v_mfma_f32_32x32x16_bf16 v[144:159], a[124:127], v[252:255], v[144:159]
  s_waitcnt vmcnt(20)
  ds_read_b64_tr_b16 a[12:13], v16 offset:20480
  ds_read_b64_tr_b16 a[14:15], v16 offset:21504
  v_mfma_f32_32x32x16_bf16 v[160:175], a[128:131], v[192:195], 0
  ds_read_b64_tr_b16 a[228:229], v17 offset:20480
  ds_read_b64_tr_b16 a[230:231], v17 offset:21504
  v_mfma_f32_32x32x16_bf16 v[176:191], a[132:135], v[192:195], 0
  s_waitcnt vmcnt(18)
  ds_read_b64_tr_b16 a[16:17], v16 offset:22528
  ds_read_b64_tr_b16 a[18:19], v16 offset:23552
  v_mfma_f32_32x32x16_bf16 v[160:175], a[192:195], v[196:199], v[160:175]
  ds_read_b64_tr_b16 a[20:21], v17 offset:22528
  ds_read_b64_tr_b16 a[22:23], v17 offset:23552
  s_waitcnt lgkmcnt(8)
  buffer_load_dwordx4 v12, s[16:19], s32 offen offset:2048 lds
  buffer_load_dwordx4 v13, s[16:19], s32 offen offset:3072 lds
  v_mfma_f32_32x32x16_bf16 v[176:191], a[136:139], v[196:199], v[176:191]
  s_waitcnt vmcnt(18)
  ds_read_b64_tr_b16 a[232:233], v18 offset:0
  ds_read_b64_tr_b16 a[234:235], v18 offset:1024
  s_mov_b32 m0, s59
  s_mov_b32 s32, 0x3c400
  v_mfma_f32_32x32x16_bf16 v[160:175], a[140:143], v[200:203], v[160:175]
  ds_read_b64_tr_b16 a[24:25], v18 offset:8
  ds_read_b64_tr_b16 a[26:27], v18 offset:1032
  s_waitcnt lgkmcnt(8)
  buffer_load_dwordx4 v10, s[16:19], s32 offen offset:0 lds
  v_mfma_f32_32x32x16_bf16 v[176:191], a[196:199], v[200:203], v[176:191]
  s_waitcnt vmcnt(17)
  ds_read_b64_tr_b16 a[28:29], v18 offset:2048
  ds_read_b64_tr_b16 a[30:31], v18 offset:3072
  buffer_load_dwordx4 v11, s[16:19], s32 offen offset:1024 lds
  v_mfma_f32_32x32x16_bf16 v[160:175], a[144:147], v[204:207], v[160:175]
  ds_read_b64_tr_b16 a[236:237], v18 offset:2056
  ds_read_b64_tr_b16 a[238:239], v18 offset:3080
  s_waitcnt lgkmcnt(8)
  buffer_load_dwordx4 v12, s[16:19], s32 offen offset:2048 lds
  v_mfma_f32_32x32x16_bf16 v[176:191], a[148:151], v[204:207], v[176:191]
  s_waitcnt vmcnt(17)
  ds_read_b64_tr_b16 a[32:33], v18 offset:4096
  ds_read_b64_tr_b16 a[34:35], v18 offset:5120
  v_mfma_f32_32x32x16_bf16 v[160:175], a[200:203], v[208:211], v[160:175]
  ds_read_b64_tr_b16 a[36:37], v18 offset:4104
  ds_read_b64_tr_b16 a[38:39], v18 offset:5128
  buffer_load_dwordx4 v13, s[16:19], s32 offen offset:3072 lds
  v_mfma_f32_32x32x16_bf16 v[176:191], a[152:155], v[208:211], v[176:191]
  s_mov_b32 m0, s54
  s_mov_b32 s32, 0x48400
  v_mfma_f32_32x32x16_bf16 v[160:175], a[156:159], v[212:215], v[160:175]
  s_waitcnt lgkmcnt(8)
  buffer_load_dwordx4 v10, s[16:19], s32 offen offset:0 lds
  v_mfma_f32_32x32x16_bf16 v[176:191], a[204:207], v[212:215], v[176:191]
  s_waitcnt vmcnt(17)
  ds_read_b64_tr_b16 a[240:241], v18 offset:6144
  ds_read_b64_tr_b16 a[242:243], v18 offset:7168
  v_mfma_f32_32x32x16_bf16 v[160:175], a[160:163], v[216:219], v[160:175]
  ds_read_b64_tr_b16 a[40:41], v18 offset:6152
  ds_read_b64_tr_b16 a[42:43], v18 offset:7176
  buffer_load_dwordx4 v11, s[16:19], s32 offen offset:1024 lds
  v_mfma_f32_32x32x16_bf16 v[176:191], a[164:167], v[216:219], v[176:191]
  s_waitcnt lgkmcnt(8)
  buffer_load_dwordx4 v12, s[16:19], s32 offen offset:2048 lds
  v_mfma_f32_32x32x16_bf16 v[160:175], a[208:211], v[220:223], v[160:175]
  s_waitcnt vmcnt(17)
  ds_read_b64_tr_b16 a[44:45], v18 offset:8192
  ds_read_b64_tr_b16 a[46:47], v18 offset:9216
  v_mfma_f32_32x32x16_bf16 v[176:191], a[168:171], v[220:223], v[176:191]
  ds_read_b64_tr_b16 a[244:245], v18 offset:8200
  ds_read_b64_tr_b16 a[246:247], v18 offset:9224
  buffer_load_dwordx4 v13, s[16:19], s32 offen offset:3072 lds
  v_mfma_f32_32x32x16_bf16 v[160:175], a[172:175], v[224:227], v[160:175]
  s_mov_b32 m0, s55
  s_mov_b32 s32, 0x54400
  v_mfma_f32_32x32x16_bf16 v[176:191], a[212:215], v[224:227], v[176:191]
  s_waitcnt lgkmcnt(8)
  buffer_load_dwordx4 v10, s[16:19], s32 offen offset:0 lds
  v_mfma_f32_32x32x16_bf16 v[160:175], a[176:179], v[228:231], v[160:175]
  s_waitcnt vmcnt(17)
  ds_read_b64_tr_b16 a[48:49], v18 offset:10240
  ds_read_b64_tr_b16 a[50:51], v18 offset:11264
  v_mfma_f32_32x32x16_bf16 v[176:191], a[180:183], v[228:231], v[176:191]
  ds_read_b64_tr_b16 a[52:53], v18 offset:10248
  ds_read_b64_tr_b16 a[54:55], v18 offset:11272
  buffer_load_dwordx4 v11, s[16:19], s32 offen offset:1024 lds
  v_mfma_f32_32x32x16_bf16 v[160:175], a[216:219], v[232:235], v[160:175]
  s_waitcnt lgkmcnt(8)
  buffer_load_dwordx4 v12, s[16:19], s32 offen offset:2048 lds
  v_mfma_f32_32x32x16_bf16 v[176:191], a[184:187], v[232:235], v[176:191]
  s_waitcnt vmcnt(17)
  ds_read_b64_tr_b16 a[248:249], v18 offset:12288
  ds_read_b64_tr_b16 a[250:251], v18 offset:13312
  v_mfma_f32_32x32x16_bf16 v[160:175], a[188:191], v[236:239], v[160:175]
  ds_read_b64_tr_b16 a[56:57], v18 offset:12296
  ds_read_b64_tr_b16 a[58:59], v18 offset:13320
  buffer_load_dwordx4 v13, s[16:19], s32 offen offset:3072 lds
  v_mfma_f32_32x32x16_bf16 v[176:191], a[220:223], v[236:239], v[176:191]
  v_mfma_f32_32x32x16_bf16 v[160:175], a[0:3], v[240:243], v[160:175]
  s_waitcnt vmcnt(16)
  ds_read_b64_tr_b16 a[60:61], v18 offset:14336
  ds_read_b64_tr_b16 a[62:63], v18 offset:15360
  v_mfma_f32_32x32x16_bf16 v[176:191], a[4:7], v[240:243], v[176:191]
  ds_read_b64_tr_b16 a[252:253], v18 offset:14344
  ds_read_b64_tr_b16 a[254:255], v18 offset:15368
  v_mfma_f32_32x32x16_bf16 v[160:175], a[224:227], v[244:247], v[160:175]
  v_mfma_f32_32x32x16_bf16 v[176:191], a[8:11], v[244:247], v[176:191]
  v_mfma_f32_32x32x16_bf16 v[160:175], a[12:15], v[248:251], v[160:175]
  s_waitcnt vmcnt(14)
  ds_read_b64_tr_b16 a[64:65], v18 offset:16384
  ds_read_b64_tr_b16 a[66:67], v18 offset:17408
  v_mfma_f32_32x32x16_bf16 v[176:191], a[228:231], v[248:251], v[176:191]
  ds_read_b64_tr_b16 a[68:69], v18 offset:16392
  ds_read_b64_tr_b16 a[70:71], v18 offset:17416
  v_mfma_f32_32x32x16_bf16 v[160:175], a[16:19], v[252:255], v[160:175]
  v_mfma_f32_32x32x16_bf16 v[176:191], a[20:23], v[252:255], v[176:191]
  v_mfma_f32_32x32x16_bf16 v[64:79], v[192:195], a[232:235], 0
  v_mfma_f32_32x32x16_bf16 v[80:95], v[192:195], a[24:27], 0
  v_mfma_f32_32x32x16_bf16 v[64:79], v[196:199], a[28:31], v[64:79]
  s_waitcnt vmcnt(12)
  ds_read_b64_tr_b16 a[72:73], v18 offset:18432
  ds_read_b64_tr_b16 a[74:75], v18 offset:19456
  v_cvt_pk_bf16_f32 v28, v128, v129
  v_mfma_f32_32x32x16_bf16 v[80:95], v[196:199], a[236:239], v[80:95]
  ds_read_b64_tr_b16 a[76:77], v18 offset:18440
  ds_read_b64_tr_b16 a[78:79], v18 offset:19464
  v_cvt_pk_bf16_f32 v29, v130, v131
  v_cvt_pk_bf16_f32 v30, v132, v133
  v_mfma_f32_32x32x16_bf16 v[64:79], v[200:203], a[32:35], v[64:79]
  v_cvt_pk_bf16_f32 v31, v134, v135
  v_mfma_f32_32x32x16_bf16 v[80:95], v[200:203], a[36:39], v[80:95]
  buffer_store_dwordx4 v[28:31], v1, s[20:23], s63 offen offset:0 sc1
  v_cvt_pk_bf16_f32 v32, v136, v137
  v_mfma_f32_32x32x16_bf16 v[64:79], v[204:207], a[240:243], v[64:79]
  s_waitcnt vmcnt(11)
  ds_read_b64_tr_b16 a[80:81], v18 offset:20480
  ds_read_b64_tr_b16 a[82:83], v18 offset:21504
  v_cvt_pk_bf16_f32 v33, v138, v139
  v_mfma_f32_32x32x16_bf16 v[80:95], v[204:207], a[40:43], v[80:95]
  ds_read_b64_tr_b16 a[84:85], v18 offset:20488
  ds_read_b64_tr_b16 a[86:87], v18 offset:21512
  v_cvt_pk_bf16_f32 v34, v140, v141
  v_cvt_pk_bf16_f32 v35, v142, v143
  s_waitcnt lgkmcnt(15)
  v_mfma_f32_32x32x16_bf16 v[64:79], v[208:211], a[44:47], v[64:79]
  buffer_store_dwordx4 v[32:35], v1, s[20:23], s63 offen offset:1024 sc1
  s_waitcnt lgkmcnt(15)
  v_mfma_f32_32x32x16_bf16 v[80:95], v[208:211], a[244:247], v[80:95]
  s_waitcnt vmcnt(10)
  ds_read_b64_tr_b16 a[88:89], v18 offset:22528
  ds_read_b64_tr_b16 a[90:91], v18 offset:23552
  v_cvt_pk_bf16_f32 v36, v144, v145
  s_waitcnt lgkmcnt(15)
  v_mfma_f32_32x32x16_bf16 v[64:79], v[212:215], a[48:51], v[64:79]
  ds_read_b64_tr_b16 a[92:93], v18 offset:22536
  ds_read_b64_tr_b16 a[94:95], v18 offset:23560
  v_cvt_pk_bf16_f32 v37, v146, v147
  v_cvt_pk_bf16_f32 v38, v148, v149
  s_waitcnt lgkmcnt(15)
  v_mfma_f32_32x32x16_bf16 v[80:95], v[212:215], a[52:55], v[80:95]
  v_cvt_pk_bf16_f32 v39, v150, v151
  s_waitcnt lgkmcnt(15)
  v_mfma_f32_32x32x16_bf16 v[64:79], v[216:219], a[248:251], v[64:79]
  buffer_store_dwordx4 v[36:39], v1, s[20:23], s63 offen offset:2048 sc1
  v_cvt_pk_bf16_f32 v40, v152, v153
  s_waitcnt lgkmcnt(15)
  v_mfma_f32_32x32x16_bf16 v[80:95], v[216:219], a[56:59], v[80:95]
  s_waitcnt vmcnt(9)
  ds_read_b64_tr_b16 a[96:97], v18 offset:0
  ds_read_b64_tr_b16 a[98:99], v18 offset:1024
  v_cvt_pk_bf16_f32 v41, v154, v155
  s_waitcnt lgkmcnt(15)
  v_mfma_f32_32x32x16_bf16 v[64:79], v[220:223], a[60:63], v[64:79]
  ds_read_b64_tr_b16 a[100:101], v18 offset:8
  ds_read_b64_tr_b16 a[102:103], v18 offset:1032
  v_cvt_pk_bf16_f32 v42, v156, v157
  v_cvt_pk_bf16_f32 v43, v158, v159
  s_waitcnt lgkmcnt(15)
  v_mfma_f32_32x32x16_bf16 v[80:95], v[220:223], a[252:255], v[80:95]
  buffer_store_dwordx4 v[40:43], v1, s[20:23], s63 offen offset:3072 sc1
  s_waitcnt lgkmcnt(15)
  v_mfma_f32_32x32x16_bf16 v[64:79], v[224:227], a[64:67], v[64:79]
  s_waitcnt vmcnt(8)
  ds_read_b64_tr_b16 a[104:105], v18 offset:2048
  ds_read_b64_tr_b16 a[106:107], v18 offset:3072
  v_cvt_pk_bf16_f32 v28, v160, v161
  s_waitcnt lgkmcnt(15)
  v_mfma_f32_32x32x16_bf16 v[80:95], v[224:227], a[68:71], v[80:95]
  ds_read_b64_tr_b16 a[108:109], v18 offset:2056
  ds_read_b64_tr_b16 a[110:111], v18 offset:3080
  v_cvt_pk_bf16_f32 v29, v162, v163
  v_cvt_pk_bf16_f32 v30, v164, v165
  s_waitcnt lgkmcnt(15)
  v_mfma_f32_32x32x16_bf16 v[64:79], v[228:231], a[72:75], v[64:79]
  v_cvt_pk_bf16_f32 v31, v166, v167
  s_waitcnt lgkmcnt(15)
  v_mfma_f32_32x32x16_bf16 v[80:95], v[228:231], a[76:79], v[80:95]
  buffer_store_dwordx4 v[28:31], v1, s[20:23], s64 offen offset:0 sc1
  v_cvt_pk_bf16_f32 v32, v168, v169
  s_waitcnt lgkmcnt(14)
  v_mfma_f32_32x32x16_bf16 v[64:79], v[232:235], a[80:83], v[64:79]
  s_waitcnt vmcnt(7)
  ds_read_b64_tr_b16 a[112:113], v18 offset:4096
  ds_read_b64_tr_b16 a[114:115], v18 offset:5120
  v_cvt_pk_bf16_f32 v33, v170, v171
  s_waitcnt lgkmcnt(14)
  v_mfma_f32_32x32x16_bf16 v[80:95], v[232:235], a[84:87], v[80:95]
  ds_read_b64_tr_b16 a[116:117], v18 offset:4104
  ds_read_b64_tr_b16 a[118:119], v18 offset:5128
  v_cvt_pk_bf16_f32 v34, v172, v173
  v_cvt_pk_bf16_f32 v35, v174, v175
  s_waitcnt lgkmcnt(14)
  v_mfma_f32_32x32x16_bf16 v[64:79], v[236:239], a[88:91], v[64:79]
  buffer_store_dwordx4 v[32:35], v1, s[20:23], s64 offen offset:1024 sc1
  s_waitcnt lgkmcnt(12)
  v_mfma_f32_32x32x16_bf16 v[80:95], v[236:239], a[92:95], v[80:95]
  s_waitcnt vmcnt(6)
  ds_read_b64_tr_b16 a[120:121], v18 offset:6144
  ds_read_b64_tr_b16 a[122:123], v18 offset:7168
  v_cvt_pk_bf16_f32 v36, v176, v177
  s_waitcnt lgkmcnt(12)
  v_mfma_f32_32x32x16_bf16 v[64:79], v[240:243], a[96:99], v[64:79]
  ds_read_b64_tr_b16 a[124:125], v18 offset:6152
  ds_read_b64_tr_b16 a[126:127], v18 offset:7176
  v_cvt_pk_bf16_f32 v37, v178, v179
  v_cvt_pk_bf16_f32 v38, v180, v181
  s_waitcnt lgkmcnt(12)
  v_mfma_f32_32x32x16_bf16 v[80:95], v[240:243], a[100:103], v[80:95]
  v_cvt_pk_bf16_f32 v39, v182, v183
  s_waitcnt lgkmcnt(10)
  v_mfma_f32_32x32x16_bf16 v[64:79], v[244:247], a[104:107], v[64:79]
  buffer_store_dwordx4 v[36:39], v1, s[20:23], s64 offen offset:2048 sc1
  v_cvt_pk_bf16_f32 v40, v184, v185
  s_waitcnt lgkmcnt(8)
  v_mfma_f32_32x32x16_bf16 v[80:95], v[244:247], a[108:111], v[80:95]
  v_cvt_pk_bf16_f32 v41, v186, v187
  s_waitcnt lgkmcnt(6)
  v_mfma_f32_32x32x16_bf16 v[64:79], v[248:251], a[112:115], v[64:79]
  v_cvt_pk_bf16_f32 v42, v188, v189
  v_cvt_pk_bf16_f32 v43, v190, v191
  s_waitcnt lgkmcnt(4)
  v_mfma_f32_32x32x16_bf16 v[80:95], v[248:251], a[116:119], v[80:95]
  buffer_store_dwordx4 v[40:43], v1, s[20:23], s64 offen offset:3072 sc1
  s_waitcnt lgkmcnt(2)
  v_mfma_f32_32x32x16_bf16 v[64:79], v[252:255], a[120:123], v[64:79]
  s_waitcnt lgkmcnt(0)
  v_mfma_f32_32x32x16_bf16 v[80:95], v[252:255], a[124:127], v[80:95]
  s_nop 9
  v_cvt_pk_bf16_f32 v28, v64, v65
  v_cvt_pk_bf16_f32 v29, v66, v67
  v_cvt_pk_bf16_f32 v30, v68, v69
  v_cvt_pk_bf16_f32 v31, v70, v71
  buffer_store_dwordx4 v[28:31], v25, s[20:23], s65 offen offset:0 sc1
  v_cvt_pk_bf16_f32 v32, v72, v73
  v_cvt_pk_bf16_f32 v33, v74, v75
  v_cvt_pk_bf16_f32 v34, v76, v77
  v_cvt_pk_bf16_f32 v35, v78, v79
  buffer_store_dwordx4 v[32:35], v25, s[20:23], s65 offen offset:1024 sc1
  v_cvt_pk_bf16_f32 v36, v80, v81
  v_cvt_pk_bf16_f32 v37, v82, v83
  v_cvt_pk_bf16_f32 v38, v84, v85
  v_cvt_pk_bf16_f32 v39, v86, v87
  buffer_store_dwordx4 v[36:39], v25, s[20:23], s65 offen offset:2048 sc1
  v_cvt_pk_bf16_f32 v40, v88, v89
  v_cvt_pk_bf16_f32 v41, v90, v91
  v_cvt_pk_bf16_f32 v42, v92, v93
  v_cvt_pk_bf16_f32 v43, v94, v95
  buffer_store_dwordx4 v[40:43], v25, s[20:23], s65 offen offset:3072 sc1
A_exit:
  s_endpgm
A_retry:
  buffer_load_dwordx4 v[224:227], v1, s[20:23], s49 offen offset:0 sc1
  buffer_load_dwordx4 v[228:231], v1, s[20:23], s49 offen offset:1024 sc1
  buffer_load_dwordx4 v[232:235], v1, s[20:23], s49 offen offset:2048 sc1
  buffer_load_dwordx4 v[236:239], v1, s[20:23], s49 offen offset:3072 sc1
  buffer_load_dwordx4 v[240:243], v62, s[20:23], s49 offen offset:0 sc1
  buffer_load_dwordx4 v[244:247], v62, s[20:23], s49 offen offset:1024 sc1
  buffer_load_dwordx4 v[248:251], v62, s[20:23], s49 offen offset:2048 sc1
  buffer_load_dwordx4 v[252:255], v62, s[20:23], s49 offen offset:3072 sc1
  s_add_u32 s46, s46, 1
  s_waitcnt vmcnt(7)
  v_xor_b32 v224, v27, v224
  v_xor_b32 v226, v27, v226
  v_or_b32 v32, v224, v226
  v_pk_add_f32 v[128:129], v[192:193], v[224:225]
  v_pk_add_f32 v[130:131], v[194:195], v[226:227]
  v_pk_add_f32 v[28:29], v[128:129], v[130:131]
  v_pk_mul_f32 v[30:31], v[128:129], v[128:129]
  v_pk_fma_f32 v[30:31], v[130:131], v[130:131], v[30:31]
  s_waitcnt vmcnt(6)
  v_xor_b32 v228, v27, v228
  v_xor_b32 v230, v27, v230
  v_or3_b32 v32, v32, v228, v230
  v_pk_add_f32 v[132:133], v[196:197], v[228:229]
  v_pk_add_f32 v[134:135], v[198:199], v[230:231]
  v_pk_add_f32 v[28:29], v[28:29], v[132:133]
  v_pk_fma_f32 v[30:31], v[132:133], v[132:133], v[30:31]
  v_pk_add_f32 v[28:29], v[28:29], v[134:135]
  v_pk_fma_f32 v[30:31], v[134:135], v[134:135], v[30:31]
  s_waitcnt vmcnt(5)
  v_xor_b32 v232, v27, v232
  v_xor_b32 v234, v27, v234
  v_or3_b32 v32, v32, v232, v234
  v_pk_add_f32 v[136:137], v[200:201], v[232:233]
  v_pk_add_f32 v[138:139], v[202:203], v[234:235]
  v_pk_add_f32 v[28:29], v[28:29], v[136:137]
  v_pk_fma_f32 v[30:31], v[136:137], v[136:137], v[30:31]
  v_pk_add_f32 v[28:29], v[28:29], v[138:139]
  v_pk_fma_f32 v[30:31], v[138:139], v[138:139], v[30:31]
  s_waitcnt vmcnt(4)
  v_xor_b32 v236, v27, v236
  v_xor_b32 v238, v27, v238
  v_or3_b32 v32, v32, v236, v238
  v_pk_add_f32 v[140:141], v[204:205], v[236:237]
  v_pk_add_f32 v[142:143], v[206:207], v[238:239]
  v_pk_add_f32 v[28:29], v[28:29], v[140:141]
  v_pk_fma_f32 v[30:31], v[140:141], v[140:141], v[30:31]
  v_pk_add_f32 v[28:29], v[28:29], v[142:143]
  v_pk_fma_f32 v[30:31], v[142:143], v[142:143], v[30:31]
  s_waitcnt vmcnt(3)
  v_xor_b32 v240, v27, v240
  v_xor_b32 v242, v27, v242
  v_or3_b32 v32, v32, v240, v242
  v_pk_add_f32 v[144:145], v[208:209], v[240:241]
  v_pk_add_f32 v[146:147], v[210:211], v[242:243]
  v_pk_add_f32 v[28:29], v[28:29], v[144:145]
  v_pk_fma_f32 v[30:31], v[144:145], v[144:145], v[30:31]
  v_pk_add_f32 v[28:29], v[28:29], v[146:147]
  v_pk_fma_f32 v[30:31], v[146:147], v[146:147], v[30:31]
  s_waitcnt vmcnt(2)
  v_xor_b32 v244, v27, v244
  v_xor_b32 v246, v27, v246
  v_or3_b32 v32, v32, v244, v246
  v_pk_add_f32 v[148:149], v[212:213], v[244:245]
  v_pk_add_f32 v[150:151], v[214:215], v[246:247]
  v_pk_add_f32 v[28:29], v[28:29], v[148:149]
  v_pk_fma_f32 v[30:31], v[148:149], v[148:149], v[30:31]
  v_pk_add_f32 v[28:29], v[28:29], v[150:151]
  v_pk_fma_f32 v[30:31], v[150:151], v[150:151], v[30:31]
  s_waitcnt vmcnt(1)
  v_xor_b32 v248, v27, v248
  v_xor_b32 v250, v27, v250
  v_or3_b32 v32, v32, v248, v250
  v_pk_add_f32 v[152:153], v[216:217], v[248:249]
  v_pk_add_f32 v[154:155], v[218:219], v[250:251]
  v_pk_add_f32 v[28:29], v[28:29], v[152:153]
  v_pk_fma_f32 v[30:31], v[152:153], v[152:153], v[30:31]
  v_pk_add_f32 v[28:29], v[28:29], v[154:155]
  v_pk_fma_f32 v[30:31], v[154:155], v[154:155], v[30:31]
  s_waitcnt vmcnt(0)
  v_xor_b32 v252, v27, v252
  v_xor_b32 v254, v27, v254
  v_or3_b32 v32, v32, v252, v254
  v_pk_add_f32 v[156:157], v[220:221], v[252:253]
  v_pk_add_f32 v[158:159], v[222:223], v[254:255]
  v_pk_add_f32 v[28:29], v[28:29], v[156:157]
  v_pk_fma_f32 v[30:31], v[156:157], v[156:157], v[30:31]
  v_pk_add_f32 v[28:29], v[28:29], v[158:159]
  v_pk_fma_f32 v[30:31], v[158:159], v[158:159], v[30:31]
  v_and_b32 v32, s35, v32
  v_cmp_ne_u32 vcc, 0, v32
  s_nop 3
  s_cbranch_vccz A_go
  s_cmp_lt_u32 s46, 0x4000
  s_cbranch_scc1 A_retry
  s_branch A_go
A_tr:
  s_load_dwordx4 s[48:51], s[0:1], 32
  s_load_dwordx2 s[54:55], s[0:1], 56
  s_load_dwordx4 s[56:59], s[0:1], 64
  s_mov_b32 s25, 0x05040100
  s_mov_b32 s26, 0x07060302
  v_and_b32 v8, 31, v0
  v_lshrrev_b32 v9, 5, v0
  s_sub_u32 s28, s29, 125
  s_lshl_b32 s28, s28, 1
  s_add_u32 s28, s28, s30
  s_lshl_b32 s28, s28, 2
  s_add_u32 s28, s28, s24
  s_waitcnt lgkmcnt(0)
  s_mov_b32 s20, s44
  s_mov_b32 s21, s45
  s_mov_b32 s22, 0x2b00000
  s_mov_b32 s23, 0x20000
  s_mov_b32 s12, s40
  s_mov_b32 s13, s41
  s_mov_b32 s14, 0x80000
  s_mov_b32 s15, 0x20000
  s_mov_b32 s16, s42
  s_mov_b32 s17, s43
  s_mov_b32 s18, 0x60000
  s_mov_b32 s19, 0x20000
  s_and_b32 s29, s28, 15
  s_lshl_b32 s29, s29, 10
  s_add_u32 s29, s29, 0x1e80000
  v_mov_b32 v12, 0
  v_mov_b32 v13, 0
  v_mov_b32 v14, 0
  v_mov_b32 v15, 0
  buffer_store_dwordx4 v[12:15], v1, s[20:23], s29 offen sc1
  s_mov_b32 s46, 393216
  s_mov_b32 s47, 1024
  s_mov_b32 s33, 9
  s_mov_b32 s30, 5
  s_mov_b32 s31, 4
  s_cmp_lt_u32 s28, 2
  s_cbranch_scc1 A_tr_wo
  s_cmp_lt_u32 s28, 6
  s_cbranch_scc1 A_tr_pw1
  s_cmp_lt_u32 s28, 8
  s_cbranch_scc1 A_tr_pw2
  s_cmp_lt_u32 s28, 16
  s_cbranch_scc1 A_tr_ff2a
  s_mov_b32 s4, s58
  s_mov_b32 s5, s59
  s_mov_b32 s6, 0x80000
  s_mov_b32 s7, 0x20000
  s_sub_u32 s28, s28, 16
  s_lshl_b32 s34, s28, 16
  s_lshl_b32 s35, s28, 14
  s_add_u32 s35, s35, 0x1440000
  s_branch A_tr_go
A_tr_wo:
  s_mov_b32 s4, s48
  s_mov_b32 s5, s49
  s_mov_b32 s6, 0x20000
  s_mov_b32 s7, 0x20000
  s_lshl_b32 s34, s28, 16
  s_lshl_b32 s35, s28, 14
  s_add_u32 s35, s35, 0x1400000
  s_branch A_tr_go
A_tr_pw2:
  s_mov_b32 s4, s54
  s_mov_b32 s5, s55
  s_mov_b32 s6, 0x20000
  s_mov_b32 s7, 0x20000
  s_sub_u32 s28, s28, 6
  s_lshl_b32 s34, s28, 16
  s_lshl_b32 s35, s28, 14
  s_add_u32 s35, s35, 0x1418000
  s_branch A_tr_go
A_tr_pw1:
  s_mov_b32 s4, s50
  s_mov_b32 s5, s51
  s_mov_b32 s6, 0x40000
  s_mov_b32 s7, 0x20000
  s_sub_u32 s28, s28, 2
  s_lshr_b32 s29, s28, 1
  s_and_b32 s28, s28, 1
  s_lshl_b32 s34, s28, 17
  s_lshl_b32 s35, s29, 9
  s_add_u32 s34, s34, s35
  s_lshl_b32 s35, s28, 14
  s_lshl_b32 s29, s29, 10
  s_add_u32 s35, s35, s29
  s_add_u32 s35, s35, 0x1408000
  s_mov_b32 s33, 10
  s_mov_b32 s47, 32768
  s_branch A_tr_go
A_tr_ff2a:
  s_mov_b32 s4, s56
  s_mov_b32 s5, s57
  s_mov_b32 s6, 0x80000
  s_mov_b32 s7, 0x20000
  s_sub_u32 s28, s28, 8
  s_lshr_b32 s29, s28, 1
  s_and_b32 s28, s28, 1
  s_lshl_b32 s34, s28, 18
  s_lshl_b32 s35, s29, 9
  s_add_u32 s34, s34, s35
  s_lshl_b32 s35, s28, 14
  s_mul_i32 s29, s29, 393216
  s_add_u32 s35, s35, s29
  s_add_u32 s35, s35, 0x1420000
  s_mov_b32 s33, 11
  s_mov_b32 s46, 32768
A_tr_go:
  s_add_u32 s28, s33, s30
  v_lshlrev_b32 v2, s28, v9
  v_lshl_add_u32 v2, v8, 4, v2
  s_lshl_b32 s31, s31, s33
  s_mov_b32 s60, s34
  s_add_u32 s61, s60, s31
  s_add_u32 s62, s61, s31
  s_add_u32 s63, s62, s31
  s_add_u32 s64, s63, s31
  s_add_u32 s65, s64, s31
  s_add_u32 s66, s65, s31
  s_add_u32 s67, s66, s31
  v_lshrrev_b32 v3, 3, v8
  v_mul_lo_u32 v3, v3, s46
  v_lshl_add_u32 v3, v9, 9, v3
  v_and_b32 v4, 7, v8
  v_lshl_add_u32 v3, v4, 4, v3
  s_lshl_b32 s28, 0, s33
  s_add_u32 s28, s28, s60
  buffer_load_dwordx4 v[64:67], v2, s[4:7], s28 offen
  s_lshl_b32 s28, 1, s33
  s_add_u32 s28, s28, s60
  buffer_load_dwordx4 v[68:71], v2, s[4:7], s28 offen
  s_lshl_b32 s28, 2, s33
  s_add_u32 s28, s28, s60
  buffer_load_dwordx4 v[72:75], v2, s[4:7], s28 offen
  s_lshl_b32 s28, 3, s33
  s_add_u32 s28, s28, s60
  buffer_load_dwordx4 v[76:79], v2, s[4:7], s28 offen
  s_lshl_b32 s28, 0, s33
  s_add_u32 s28, s28, s61
  buffer_load_dwordx4 v[80:83], v2, s[4:7], s28 offen
  s_lshl_b32 s28, 1, s33
  s_add_u32 s28, s28, s61
  buffer_load_dwordx4 v[84:87], v2, s[4:7], s28 offen
  s_lshl_b32 s28, 2, s33
  s_add_u32 s28, s28, s61
  buffer_load_dwordx4 v[88:91], v2, s[4:7], s28 offen
  s_lshl_b32 s28, 3, s33
  s_add_u32 s28, s28, s61
  buffer_load_dwordx4 v[92:95], v2, s[4:7], s28 offen
  s_lshl_b32 s28, 0, s33
  s_add_u32 s28, s28, s62
  buffer_load_dwordx4 v[96:99], v2, s[4:7], s28 offen
  s_lshl_b32 s28, 1, s33
  s_add_u32 s28, s28, s62
  buffer_load_dwordx4 v[100:103], v2, s[4:7], s28 offen
  s_lshl_b32 s28, 2, s33
  s_add_u32 s28, s28, s62
  buffer_load_dwordx4 v[104:107], v2, s[4:7], s28 offen
  s_lshl_b32 s28, 3, s33
  s_add_u32 s28, s28, s62
  buffer_load_dwordx4 v[108:111], v2, s[4:7], s28 offen
  s_lshl_b32 s28, 0, s33
  s_add_u32 s28, s28, s63
  buffer_load_dwordx4 v[112:115], v2, s[4:7], s28 offen
  s_lshl_b32 s28, 1, s33
  s_add_u32 s28, s28, s63
  buffer_load_dwordx4 v[116:119], v2, s[4:7], s28 offen
  s_lshl_b32 s28, 2, s33
  s_add_u32 s28, s28, s63
  buffer_load_dwordx4 v[120:123], v2, s[4:7], s28 offen
  s_lshl_b32 s28, 3, s33
  s_add_u32 s28, s28, s63
  buffer_load_dwordx4 v[124:127], v2, s[4:7], s28 offen
  s_lshl_b32 s28, 0, s33
  s_add_u32 s28, s28, s64
  buffer_load_dwordx4 v[128:131], v2, s[4:7], s28 offen
  s_lshl_b32 s28, 1, s33
  s_add_u32 s28, s28, s64
  buffer_load_dwordx4 v[132:135], v2, s[4:7], s28 offen
  s_lshl_b32 s28, 2, s33
  s_add_u32 s28, s28, s64
  buffer_load_dwordx4 v[136:139], v2, s[4:7], s28 offen
  s_lshl_b32 s28, 3, s33
  s_add_u32 s28, s28, s64
  buffer_load_dwordx4 v[140:143], v2, s[4:7], s28 offen
  s_lshl_b32 s28, 0, s33
  s_add_u32 s28, s28, s65
  buffer_load_dwordx4 v[144:147], v2, s[4:7], s28 offen
  s_lshl_b32 s28, 1, s33
  s_add_u32 s28, s28, s65
  buffer_load_dwordx4 v[148:151], v2, s[4:7], s28 offen
  s_lshl_b32 s28, 2, s33
  s_add_u32 s28, s28, s65
  buffer_load_dwordx4 v[152:155], v2, s[4:7], s28 offen
  s_lshl_b32 s28, 3, s33
  s_add_u32 s28, s28, s65
  buffer_load_dwordx4 v[156:159], v2, s[4:7], s28 offen
  s_lshl_b32 s28, 0, s33
  s_add_u32 s28, s28, s66
  buffer_load_dwordx4 v[160:163], v2, s[4:7], s28 offen
  s_lshl_b32 s28, 1, s33
  s_add_u32 s28, s28, s66
  buffer_load_dwordx4 v[164:167], v2, s[4:7], s28 offen
  s_lshl_b32 s28, 2, s33
  s_add_u32 s28, s28, s66
  buffer_load_dwordx4 v[168:171], v2, s[4:7], s28 offen
  s_lshl_b32 s28, 3, s33
  s_add_u32 s28, s28, s66
  buffer_load_dwordx4 v[172:175], v2, s[4:7], s28 offen
  s_lshl_b32 s28, 0, s33
  s_add_u32 s28, s28, s67
  buffer_load_dwordx4 v[176:179], v2, s[4:7], s28 offen
  s_lshl_b32 s28, 1, s33
  s_add_u32 s28, s28, s67
  buffer_load_dwordx4 v[180:183], v2, s[4:7], s28 offen
  s_lshl_b32 s28, 2, s33
  s_add_u32 s28, s28, s67
  buffer_load_dwordx4 v[184:187], v2, s[4:7], s28 offen
  s_lshl_b32 s28, 3, s33
  s_add_u32 s28, s28, s67
  buffer_load_dwordx4 v[188:191], v2, s[4:7], s28 offen
  s_lshl_b32 s28, 64, s33
  s_add_u32 s28, s28, s60
  buffer_load_dwordx4 v[192:195], v2, s[4:7], s28 offen
  s_lshl_b32 s28, 65, s33
  s_add_u32 s28, s28, s60
  buffer_load_dwordx4 v[196:199], v2, s[4:7], s28 offen
  s_lshl_b32 s28, 66, s33
  s_add_u32 s28, s28, s60
  buffer_load_dwordx4 v[200:203], v2, s[4:7], s28 offen
  s_lshl_b32 s28, 67, s33
  s_add_u32 s28, s28, s60
  buffer_load_dwordx4 v[204:207], v2, s[4:7], s28 offen
  s_lshl_b32 s28, 64, s33
  s_add_u32 s28, s28, s61
  buffer_load_dwordx4 v[208:211], v2, s[4:7], s28 offen
  s_lshl_b32 s28, 65, s33
  s_add_u32 s28, s28, s61
  buffer_load_dwordx4 v[212:215], v2, s[4:7], s28 offen
  s_lshl_b32 s28, 66, s33
  s_add_u32 s28, s28, s61
  buffer_load_dwordx4 v[216:219], v2, s[4:7], s28 offen
  s_lshl_b32 s28, 67, s33
  s_add_u32 s28, s28, s61
  buffer_load_dwordx4 v[220:223], v2, s[4:7], s28 offen
  s_lshl_b32 s28, 64, s33
  s_add_u32 s28, s28, s62
  buffer_load_dwordx4 v[224:227], v2, s[4:7], s28 offen
  s_lshl_b32 s28, 65, s33
  s_add_u32 s28, s28, s62
  buffer_load_dwordx4 v[228:231], v2, s[4:7], s28 offen
  s_lshl_b32 s28, 66, s33
  s_add_u32 s28, s28, s62
  buffer_load_dwordx4 v[232:235], v2, s[4:7], s28 offen
  s_lshl_b32 s28, 67, s33
  s_add_u32 s28, s28, s62
  buffer_load_dwordx4 v[236:239], v2, s[4:7], s28 offen
  s_lshl_b32 s28, 64, s33
  s_add_u32 s28, s28, s63
  buffer_load_dwordx4 v[240:243], v2, s[4:7], s28 offen
  s_lshl_b32 s28, 65, s33
  s_add_u32 s28, s28, s63
  buffer_load_dwordx4 v[244:247], v2, s[4:7], s28 offen
  s_lshl_b32 s28, 66, s33
  s_add_u32 s28, s28, s63
  buffer_load_dwordx4 v[248:251], v2, s[4:7], s28 offen
  s_lshl_b32 s28, 67, s33
  s_add_u32 s28, s28, s63
  buffer_load_dwordx4 v[252:255], v2, s[4:7], s28 offen
  s_mov_b32 exec_hi, 0
  buffer_load_dword v58, v61, s[12:15], s52 offen
  s_mov_b32 exec_hi, -1
  s_mov_b32 exec_hi, 0
  buffer_load_dword v58, v61, s[16:19], s53 offen
  s_mov_b32 exec_hi, -1
  s_waitcnt vmcnt(42)
  v_perm_b32 v11, v92, v88, s25
  v_perm_b32 v10, v84, v80, s25
  v_perm_b32 v9, v76, v72, s25
  v_perm_b32 v8, v68, v64, s25
  s_add_u32 s29, s35, 0
  buffer_store_dwordx4 v[8:11], v3, s[20:23], s29 offen offset:0 sc1
  v_perm_b32 v15, v92, v88, s26
  v_perm_b32 v14, v84, v80, s26
  v_perm_b32 v13, v76, v72, s26
  v_perm_b32 v12, v68, v64, s26
  buffer_store_dwordx4 v[12:15], v3, s[20:23], s29 offen offset:128 sc1
  v_perm_b32 v19, v93, v89, s25
  v_perm_b32 v18, v85, v81, s25
  v_perm_b32 v17, v77, v73, s25
  v_perm_b32 v16, v69, v65, s25
  buffer_store_dwordx4 v[16:19], v3, s[20:23], s29 offen offset:256 sc1
  v_perm_b32 v23, v93, v89, s26
  v_perm_b32 v22, v85, v81, s26
  v_perm_b32 v21, v77, v73, s26
  v_perm_b32 v20, v69, v65, s26
  buffer_store_dwordx4 v[20:23], v3, s[20:23], s29 offen offset:384 sc1
  v_perm_b32 v27, v94, v90, s25
  v_perm_b32 v26, v86, v82, s25
  v_perm_b32 v25, v78, v74, s25
  v_perm_b32 v24, v70, v66, s25
  s_add_u32 s29, s29, s47
  buffer_store_dwordx4 v[24:27], v3, s[20:23], s29 offen offset:0 sc1
  v_perm_b32 v31, v94, v90, s26
  v_perm_b32 v30, v86, v82, s26
  v_perm_b32 v29, v78, v74, s26
  v_perm_b32 v28, v70, v66, s26
  buffer_store_dwordx4 v[28:31], v3, s[20:23], s29 offen offset:128 sc1
  v_perm_b32 v35, v95, v91, s25
  v_perm_b32 v34, v87, v83, s25
  v_perm_b32 v33, v79, v75, s25
  v_perm_b32 v32, v71, v67, s25
  buffer_store_dwordx4 v[32:35], v3, s[20:23], s29 offen offset:256 sc1
  v_perm_b32 v39, v95, v91, s26
  v_perm_b32 v38, v87, v83, s26
  v_perm_b32 v37, v79, v75, s26
  v_perm_b32 v36, v71, v67, s26
  buffer_store_dwordx4 v[36:39], v3, s[20:23], s29 offen offset:384 sc1
  s_lshl_b32 s28, 64, s33
  s_add_u32 s28, s28, s64
  buffer_load_dwordx4 v[64:67], v2, s[4:7], s28 offen
  s_lshl_b32 s28, 65, s33
  s_add_u32 s28, s28, s64
  buffer_load_dwordx4 v[68:71], v2, s[4:7], s28 offen
  s_lshl_b32 s28, 66, s33
  s_add_u32 s28, s28, s64
  buffer_load_dwordx4 v[72:75], v2, s[4:7], s28 offen
  s_lshl_b32 s28, 67, s33
  s_add_u32 s28, s28, s64
  buffer_load_dwordx4 v[76:79], v2, s[4:7], s28 offen
  s_lshl_b32 s28, 64, s33
  s_add_u32 s28, s28, s65
  buffer_load_dwordx4 v[80:83], v2, s[4:7], s28 offen
  s_lshl_b32 s28, 65, s33
  s_add_u32 s28, s28, s65
  buffer_load_dwordx4 v[84:87], v2, s[4:7], s28 offen
  s_lshl_b32 s28, 66, s33
  s_add_u32 s28, s28, s65
  buffer_load_dwordx4 v[88:91], v2, s[4:7], s28 offen
  s_lshl_b32 s28, 67, s33
  s_add_u32 s28, s28, s65
  buffer_load_dwordx4 v[92:95], v2, s[4:7], s28 offen
  s_waitcnt vmcnt(50)
  v_perm_b32 v11, v124, v120, s25
  v_perm_b32 v10, v116, v112, s25
  v_perm_b32 v9, v108, v104, s25
  v_perm_b32 v8, v100, v96, s25
  s_add_u32 s29, s35, 2048
  buffer_store_dwordx4 v[8:11], v3, s[20:23], s29 offen offset:0 sc1
  v_perm_b32 v15, v124, v120, s26
  v_perm_b32 v14, v116, v112, s26
  v_perm_b32 v13, v108, v104, s26
  v_perm_b32 v12, v100, v96, s26
  buffer_store_dwordx4 v[12:15], v3, s[20:23], s29 offen offset:128 sc1
  v_perm_b32 v19, v125, v121, s25
  v_perm_b32 v18, v117, v113, s25
  v_perm_b32 v17, v109, v105, s25
  v_perm_b32 v16, v101, v97, s25
  buffer_store_dwordx4 v[16:19], v3, s[20:23], s29 offen offset:256 sc1
  v_perm_b32 v23, v125, v121, s26
  v_perm_b32 v22, v117, v113, s26
  v_perm_b32 v21, v109, v105, s26
  v_perm_b32 v20, v101, v97, s26
  buffer_store_dwordx4 v[20:23], v3, s[20:23], s29 offen offset:384 sc1
  v_perm_b32 v27, v126, v122, s25
  v_perm_b32 v26, v118, v114, s25
  v_perm_b32 v25, v110, v106, s25
  v_perm_b32 v24, v102, v98, s25
  s_add_u32 s29, s29, s47
  buffer_store_dwordx4 v[24:27], v3, s[20:23], s29 offen offset:0 sc1
  v_perm_b32 v31, v126, v122, s26
  v_perm_b32 v30, v118, v114, s26
  v_perm_b32 v29, v110, v106, s26
  v_perm_b32 v28, v102, v98, s26
  buffer_store_dwordx4 v[28:31], v3, s[20:23], s29 offen offset:128 sc1
  v_perm_b32 v35, v127, v123, s25
  v_perm_b32 v34, v119, v115, s25
  v_perm_b32 v33, v111, v107, s25
  v_perm_b32 v32, v103, v99, s25
  buffer_store_dwordx4 v[32:35], v3, s[20:23], s29 offen offset:256 sc1
  v_perm_b32 v39, v127, v123, s26
  v_perm_b32 v38, v119, v115, s26
  v_perm_b32 v37, v111, v107, s26
  v_perm_b32 v36, v103, v99, s26
  buffer_store_dwordx4 v[36:39], v3, s[20:23], s29 offen offset:384 sc1
  s_lshl_b32 s28, 64, s33
  s_add_u32 s28, s28, s66
  buffer_load_dwordx4 v[96:99], v2, s[4:7], s28 offen
  s_lshl_b32 s28, 65, s33
  s_add_u32 s28, s28, s66
  buffer_load_dwordx4 v[100:103], v2, s[4:7], s28 offen
  s_lshl_b32 s28, 66, s33
  s_add_u32 s28, s28, s66
  buffer_load_dwordx4 v[104:107], v2, s[4:7], s28 offen
  s_lshl_b32 s28, 67, s33
  s_add_u32 s28, s28, s66
  buffer_load_dwordx4 v[108:111], v2, s[4:7], s28 offen
  s_lshl_b32 s28, 64, s33
  s_add_u32 s28, s28, s67
  buffer_load_dwordx4 v[112:115], v2, s[4:7], s28 offen
  s_lshl_b32 s28, 65, s33
  s_add_u32 s28, s28, s67
  buffer_load_dwordx4 v[116:119], v2, s[4:7], s28 offen
  s_lshl_b32 s28, 66, s33
  s_add_u32 s28, s28, s67
  buffer_load_dwordx4 v[120:123], v2, s[4:7], s28 offen
  s_lshl_b32 s28, 67, s33
  s_add_u32 s28, s28, s67
  buffer_load_dwordx4 v[124:127], v2, s[4:7], s28 offen
  s_waitcnt vmcnt(58)
  v_perm_b32 v11, v156, v152, s25
  v_perm_b32 v10, v148, v144, s25
  v_perm_b32 v9, v140, v136, s25
  v_perm_b32 v8, v132, v128, s25
  s_add_u32 s29, s35, 4096
  buffer_store_dwordx4 v[8:11], v3, s[20:23], s29 offen offset:0 sc1
  v_perm_b32 v15, v156, v152, s26
  v_perm_b32 v14, v148, v144, s26
  v_perm_b32 v13, v140, v136, s26
  v_perm_b32 v12, v132, v128, s26
  buffer_store_dwordx4 v[12:15], v3, s[20:23], s29 offen offset:128 sc1
  v_perm_b32 v19, v157, v153, s25
  v_perm_b32 v18, v149, v145, s25
  v_perm_b32 v17, v141, v137, s25
  v_perm_b32 v16, v133, v129, s25
  buffer_store_dwordx4 v[16:19], v3, s[20:23], s29 offen offset:256 sc1
  v_perm_b32 v23, v157, v153, s26
  v_perm_b32 v22, v149, v145, s26
  v_perm_b32 v21, v141, v137, s26
  v_perm_b32 v20, v133, v129, s26
  buffer_store_dwordx4 v[20:23], v3, s[20:23], s29 offen offset:384 sc1
  v_perm_b32 v27, v158, v154, s25
  v_perm_b32 v26, v150, v146, s25
  v_perm_b32 v25, v142, v138, s25
  v_perm_b32 v24, v134, v130, s25
  s_add_u32 s29, s29, s47
  buffer_store_dwordx4 v[24:27], v3, s[20:23], s29 offen offset:0 sc1
  v_perm_b32 v31, v158, v154, s26
  v_perm_b32 v30, v150, v146, s26
  v_perm_b32 v29, v142, v138, s26
  v_perm_b32 v28, v134, v130, s26
  buffer_store_dwordx4 v[28:31], v3, s[20:23], s29 offen offset:128 sc1
  v_perm_b32 v35, v159, v155, s25
  v_perm_b32 v34, v151, v147, s25
  v_perm_b32 v33, v143, v139, s25
  v_perm_b32 v32, v135, v131, s25
  buffer_store_dwordx4 v[32:35], v3, s[20:23], s29 offen offset:256 sc1
  v_perm_b32 v39, v159, v155, s26
  v_perm_b32 v38, v151, v147, s26
  v_perm_b32 v37, v143, v139, s26
  v_perm_b32 v36, v135, v131, s26
  buffer_store_dwordx4 v[36:39], v3, s[20:23], s29 offen offset:384 sc1
  s_waitcnt vmcnt(58)
  v_perm_b32 v11, v188, v184, s25
  v_perm_b32 v10, v180, v176, s25
  v_perm_b32 v9, v172, v168, s25
  v_perm_b32 v8, v164, v160, s25
  s_add_u32 s29, s35, 6144
  buffer_store_dwordx4 v[8:11], v3, s[20:23], s29 offen offset:0 sc1
  v_perm_b32 v15, v188, v184, s26
  v_perm_b32 v14, v180, v176, s26
  v_perm_b32 v13, v172, v168, s26
  v_perm_b32 v12, v164, v160, s26
  buffer_store_dwordx4 v[12:15], v3, s[20:23], s29 offen offset:128 sc1
  v_perm_b32 v19, v189, v185, s25
  v_perm_b32 v18, v181, v177, s25
  v_perm_b32 v17, v173, v169, s25
  v_perm_b32 v16, v165, v161, s25
  buffer_store_dwordx4 v[16:19], v3, s[20:23], s29 offen offset:256 sc1
  v_perm_b32 v23, v189, v185, s26
  v_perm_b32 v22, v181, v177, s26
  v_perm_b32 v21, v173, v169, s26
  v_perm_b32 v20, v165, v161, s26
  buffer_store_dwordx4 v[20:23], v3, s[20:23], s29 offen offset:384 sc1
  v_perm_b32 v27, v190, v186, s25
  v_perm_b32 v26, v182, v178, s25
  v_perm_b32 v25, v174, v170, s25
  v_perm_b32 v24, v166, v162, s25
  s_add_u32 s29, s29, s47
  buffer_store_dwordx4 v[24:27], v3, s[20:23], s29 offen offset:0 sc1
  v_perm_b32 v31, v190, v186, s26
  v_perm_b32 v30, v182, v178, s26
  v_perm_b32 v29, v174, v170, s26
  v_perm_b32 v28, v166, v162, s26
  buffer_store_dwordx4 v[28:31], v3, s[20:23], s29 offen offset:128 sc1
  v_perm_b32 v35, v191, v187, s25
  v_perm_b32 v34, v183, v179, s25
  v_perm_b32 v33, v175, v171, s25
  v_perm_b32 v32, v167, v163, s25
  buffer_store_dwordx4 v[32:35], v3, s[20:23], s29 offen offset:256 sc1
  v_perm_b32 v39, v191, v187, s26
  v_perm_b32 v38, v183, v179, s26
  v_perm_b32 v37, v175, v171, s26
  v_perm_b32 v36, v167, v163, s26
  buffer_store_dwordx4 v[36:39], v3, s[20:23], s29 offen offset:384 sc1
  s_waitcnt vmcnt(58)
  v_perm_b32 v11, v220, v216, s25
  v_perm_b32 v10, v212, v208, s25
  v_perm_b32 v9, v204, v200, s25
  v_perm_b32 v8, v196, v192, s25
  s_add_u32 s29, s35, 8192
  buffer_store_dwordx4 v[8:11], v3, s[20:23], s29 offen offset:0 sc1
  v_perm_b32 v15, v220, v216, s26
  v_perm_b32 v14, v212, v208, s26
  v_perm_b32 v13, v204, v200, s26
  v_perm_b32 v12, v196, v192, s26
  buffer_store_dwordx4 v[12:15], v3, s[20:23], s29 offen offset:128 sc1
  v_perm_b32 v19, v221, v217, s25
  v_perm_b32 v18, v213, v209, s25
  v_perm_b32 v17, v205, v201, s25
  v_perm_b32 v16, v197, v193, s25
  buffer_store_dwordx4 v[16:19], v3, s[20:23], s29 offen offset:256 sc1
  v_perm_b32 v23, v221, v217, s26
  v_perm_b32 v22, v213, v209, s26
  v_perm_b32 v21, v205, v201, s26
  v_perm_b32 v20, v197, v193, s26
  buffer_store_dwordx4 v[20:23], v3, s[20:23], s29 offen offset:384 sc1
  v_perm_b32 v27, v222, v218, s25
  v_perm_b32 v26, v214, v210, s25
  v_perm_b32 v25, v206, v202, s25
  v_perm_b32 v24, v198, v194, s25
  s_add_u32 s29, s29, s47
  buffer_store_dwordx4 v[24:27], v3, s[20:23], s29 offen offset:0 sc1
  v_perm_b32 v31, v222, v218, s26
  v_perm_b32 v30, v214, v210, s26
  v_perm_b32 v29, v206, v202, s26
  v_perm_b32 v28, v198, v194, s26
  buffer_store_dwordx4 v[28:31], v3, s[20:23], s29 offen offset:128 sc1
  v_perm_b32 v35, v223, v219, s25
  v_perm_b32 v34, v215, v211, s25
  v_perm_b32 v33, v207, v203, s25
  v_perm_b32 v32, v199, v195, s25
  buffer_store_dwordx4 v[32:35], v3, s[20:23], s29 offen offset:256 sc1
  v_perm_b32 v39, v223, v219, s26
  v_perm_b32 v38, v215, v211, s26
  v_perm_b32 v37, v207, v203, s26
  v_perm_b32 v36, v199, v195, s26
  buffer_store_dwordx4 v[36:39], v3, s[20:23], s29 offen offset:384 sc1
  s_waitcnt vmcnt(58)
  v_perm_b32 v11, v252, v248, s25
  v_perm_b32 v10, v244, v240, s25
  v_perm_b32 v9, v236, v232, s25
  v_perm_b32 v8, v228, v224, s25
  s_add_u32 s29, s35, 10240
  buffer_store_dwordx4 v[8:11], v3, s[20:23], s29 offen offset:0 sc1
  v_perm_b32 v15, v252, v248, s26
  v_perm_b32 v14, v244, v240, s26
  v_perm_b32 v13, v236, v232, s26
  v_perm_b32 v12, v228, v224, s26
  buffer_store_dwordx4 v[12:15], v3, s[20:23], s29 offen offset:128 sc1
  v_perm_b32 v19, v253, v249, s25
  v_perm_b32 v18, v245, v241, s25
  v_perm_b32 v17, v237, v233, s25
  v_perm_b32 v16, v229, v225, s25
  buffer_store_dwordx4 v[16:19], v3, s[20:23], s29 offen offset:256 sc1
  v_perm_b32 v23, v253, v249, s26
  v_perm_b32 v22, v245, v241, s26
  v_perm_b32 v21, v237, v233, s26
  v_perm_b32 v20, v229, v225, s26
  buffer_store_dwordx4 v[20:23], v3, s[20:23], s29 offen offset:384 sc1
  v_perm_b32 v27, v254, v250, s25
  v_perm_b32 v26, v246, v242, s25
  v_perm_b32 v25, v238, v234, s25
  v_perm_b32 v24, v230, v226, s25
  s_add_u32 s29, s29, s47
  buffer_store_dwordx4 v[24:27], v3, s[20:23], s29 offen offset:0 sc1
  v_perm_b32 v31, v254, v250, s26
  v_perm_b32 v30, v246, v242, s26
  v_perm_b32 v29, v238, v234, s26
  v_perm_b32 v28, v230, v226, s26
  buffer_store_dwordx4 v[28:31], v3, s[20:23], s29 offen offset:128 sc1
  v_perm_b32 v35, v255, v251, s25
  v_perm_b32 v34, v247, v243, s25
  v_perm_b32 v33, v239, v235, s25
  v_perm_b32 v32, v231, v227, s25
  buffer_store_dwordx4 v[32:35], v3, s[20:23], s29 offen offset:256 sc1
  v_perm_b32 v39, v255, v251, s26
  v_perm_b32 v38, v247, v243, s26
  v_perm_b32 v37, v239, v235, s26
  v_perm_b32 v36, v231, v227, s26
  buffer_store_dwordx4 v[36:39], v3, s[20:23], s29 offen offset:384 sc1
  s_waitcnt vmcnt(48)
  v_perm_b32 v11, v92, v88, s25
  v_perm_b32 v10, v84, v80, s25
  v_perm_b32 v9, v76, v72, s25
  v_perm_b32 v8, v68, v64, s25
  s_add_u32 s29, s35, 12288
  buffer_store_dwordx4 v[8:11], v3, s[20:23], s29 offen offset:0 sc1
  v_perm_b32 v15, v92, v88, s26
  v_perm_b32 v14, v84, v80, s26
  v_perm_b32 v13, v76, v72, s26
  v_perm_b32 v12, v68, v64, s26
  buffer_store_dwordx4 v[12:15], v3, s[20:23], s29 offen offset:128 sc1
  v_perm_b32 v19, v93, v89, s25
  v_perm_b32 v18, v85, v81, s25
  v_perm_b32 v17, v77, v73, s25
  v_perm_b32 v16, v69, v65, s25
  buffer_store_dwordx4 v[16:19], v3, s[20:23], s29 offen offset:256 sc1
  v_perm_b32 v23, v93, v89, s26
  v_perm_b32 v22, v85, v81, s26
  v_perm_b32 v21, v77, v73, s26
  v_perm_b32 v20, v69, v65, s26
  buffer_store_dwordx4 v[20:23], v3, s[20:23], s29 offen offset:384 sc1
  v_perm_b32 v27, v94, v90, s25
  v_perm_b32 v26, v86, v82, s25
  v_perm_b32 v25, v78, v74, s25
  v_perm_b32 v24, v70, v66, s25
  s_add_u32 s29, s29, s47
  buffer_store_dwordx4 v[24:27], v3, s[20:23], s29 offen offset:0 sc1
  v_perm_b32 v31, v94, v90, s26
  v_perm_b32 v30, v86, v82, s26
  v_perm_b32 v29, v78, v74, s26
  v_perm_b32 v28, v70, v66, s26
  buffer_store_dwordx4 v[28:31], v3, s[20:23], s29 offen offset:128 sc1
  v_perm_b32 v35, v95, v91, s25
  v_perm_b32 v34, v87, v83, s25
  v_perm_b32 v33, v79, v75, s25
  v_perm_b32 v32, v71, v67, s25
  buffer_store_dwordx4 v[32:35], v3, s[20:23], s29 offen offset:256 sc1
  v_perm_b32 v39, v95, v91, s26
  v_perm_b32 v38, v87, v83, s26
  v_perm_b32 v37, v79, v75, s26
  v_perm_b32 v36, v71, v67, s26
  buffer_store_dwordx4 v[36:39], v3, s[20:23], s29 offen offset:384 sc1
  s_waitcnt vmcnt(40)
  v_perm_b32 v11, v124, v120, s25
  v_perm_b32 v10, v116, v112, s25
  v_perm_b32 v9, v108, v104, s25
  v_perm_b32 v8, v100, v96, s25
  s_add_u32 s29, s35, 14336
  buffer_store_dwordx4 v[8:11], v3, s[20:23], s29 offen offset:0 sc1
  v_perm_b32 v15, v124, v120, s26
  v_perm_b32 v14, v116, v112, s26
  v_perm_b32 v13, v108, v104, s26
  v_perm_b32 v12, v100, v96, s26
  buffer_store_dwordx4 v[12:15], v3, s[20:23], s29 offen offset:128 sc1
  v_perm_b32 v19, v125, v121, s25
  v_perm_b32 v18, v117, v113, s25
  v_perm_b32 v17, v109, v105, s25
  v_perm_b32 v16, v101, v97, s25
  buffer_store_dwordx4 v[16:19], v3, s[20:23], s29 offen offset:256 sc1
  v_perm_b32 v23, v125, v121, s26
  v_perm_b32 v22, v117, v113, s26
  v_perm_b32 v21, v109, v105, s26
  v_perm_b32 v20, v101, v97, s26
  buffer_store_dwordx4 v[20:23], v3, s[20:23], s29 offen offset:384 sc1
  v_perm_b32 v27, v126, v122, s25
  v_perm_b32 v26, v118, v114, s25
  v_perm_b32 v25, v110, v106, s25
  v_perm_b32 v24, v102, v98, s25
  s_add_u32 s29, s29, s47
  buffer_store_dwordx4 v[24:27], v3, s[20:23], s29 offen offset:0 sc1
  v_perm_b32 v31, v126, v122, s26
  v_perm_b32 v30, v118, v114, s26
  v_perm_b32 v29, v110, v106, s26
  v_perm_b32 v28, v102, v98, s26
  buffer_store_dwordx4 v[28:31], v3, s[20:23], s29 offen offset:128 sc1
  v_perm_b32 v35, v127, v123, s25
  v_perm_b32 v34, v119, v115, s25
  v_perm_b32 v33, v111, v107, s25
  v_perm_b32 v32, v103, v99, s25
  buffer_store_dwordx4 v[32:35], v3, s[20:23], s29 offen offset:256 sc1
  v_perm_b32 v39, v127, v123, s26
  v_perm_b32 v38, v119, v115, s26
  v_perm_b32 v37, v111, v107, s26
  v_perm_b32 v36, v103, v99, s26
  buffer_store_dwordx4 v[36:39], v3, s[20:23], s29 offen offset:384 sc1
  s_endpgm
end_zf_a_kernel:
.globl standalone__conformer_family_zipformer__speech_kernel
.p2align 8
.type standalone__conformer_family_zipformer__speech_kernel,@function
standalone__conformer_family_zipformer__speech_kernel:
  s_cmp_ge_u32 s2, 256
  s_cbranch_scc1 B_exit
  s_load_dwordx2 s[44:45], s[0:1], 96
  v_lshrrev_b32 v1, 6, v0
  v_and_b32 v0, 63, v0
  v_readfirstlane_b32 s24, v1
  v_lshlrev_b32 v1, 4, v0
  v_add_u32 v2, 0x1000, v1
  s_and_b32 s25, s2, 7
  s_lshr_b32 s26, s2, 3
  s_mul_i32 s32, s25, 1024000
  s_lshl_b32 s36, s24, 13
  s_add_u32 s37, s36, 0x8000
  s_add_u32 s28, s36, 0x10000
  s_add_u32 s29, s36, 0x18000
  s_mov_b32 s30, s29
  s_mul_i32 s33, s25, 512000
  s_add_u32 s33, s33, 0x800000
  s_lshl_b32 s35, s26, 2
  s_add_u32 s34, s24, 0
  s_and_b32 s34, s34, 3
  s_lshl_b32 s31, s34, 10
  s_add_u32 s31, s31, 110592
  v_add_u32 v8, s31, v1
  s_add_u32 s34, s34, s35
  s_min_u32 s34, s34, 124
  s_lshl_b32 s34, s34, 12
  s_add_u32 s40, s34, s33
  s_add_u32 s34, s24, 1
  s_and_b32 s34, s34, 3
  s_mul_i32 s31, s34, 27648
  s_add_u32 s31, s31, 0
  v_add_u32 v3, s31, v1
  s_lshl_b32 s31, s34, 10
  s_add_u32 s31, s31, 110592
  v_add_u32 v9, s31, v1
  s_add_u32 s34, s34, s35
  s_min_u32 s34, s34, 124
  s_lshl_b32 s34, s34, 12
  s_add_u32 s41, s34, s33
  s_add_u32 s34, s24, 2
  s_and_b32 s34, s34, 3
  s_mul_i32 s31, s34, 27648
  s_add_u32 s31, s31, 9216
  v_add_u32 v4, s31, v1
  s_lshl_b32 s31, s34, 10
  s_add_u32 s31, s31, 110592
  v_add_u32 v10, s31, v1
  s_add_u32 s34, s34, s35
  s_min_u32 s34, s34, 124
  s_lshl_b32 s34, s34, 12
  s_add_u32 s42, s34, s33
  s_add_u32 s34, s24, 3
  s_and_b32 s34, s34, 3
  s_mul_i32 s31, s34, 27648
  s_add_u32 s31, s31, 18432
  v_add_u32 v5, s31, v1
  s_lshl_b32 s31, s34, 10
  s_add_u32 s31, s31, 110592
  v_add_u32 v11, s31, v1
  s_add_u32 s34, s34, s35
  s_min_u32 s34, s34, 124
  s_lshl_b32 s34, s34, 12
  s_add_u32 s43, s34, s33
  s_mul_i32 s31, s24, 27648
  v_add_u32 v6, s31, v1
  v_and_b32 v7, 4, v0
  v_cmp_eq_u32 vcc, 0, v7
  v_mov_b32 v7, 0x3f803f80
  s_nop 0
  v_cndmask_b32 v208, 0, v7, vcc
  v_cndmask_b32 v209, 0, v7, vcc
  v_sub_u32 v210, v7, v208
  v_sub_u32 v211, v7, v208
  v_and_b32 v7, 1, v0
  v_mul_u32_u24 v7, 0xaaaa, v7
  v_add_u32 v218, 0x4444, v7
  s_lshl_b32 s27, s26, 2
  s_and_b32 s39, s25, 3
  s_add_u32 s27, s27, s39
  s_cmp_gt_u32 s27, 124
  s_cselect_b32 s66, 0x80000000, 0
  s_min_u32 s27, s27, 124
  s_lshr_b32 s39, s25, 2
  s_mul_i32 s39, s39, 125
  s_add_u32 s38, s27, s39
  s_lshl_b32 s39, s38, 14
  s_lshl_b32 s20, s24, 12
  s_add_u32 s20, s20, s39
  s_add_u32 s55, s20, 0x1000000
  s_add_u32 s56, s20, 0xffc000
  s_add_u32 s57, s20, 0xc00000
  s_add_u32 s58, s20, 0xbfc000
  s_mul_i32 s47, s24, 393216
  s_add_u32 s47, s47, 0x1400000
  s_mov_b32 s59, 0
  s_mov_b32 s22, 0x80000000
  s_cmp_gt_u32 s27, 0
  s_cselect_b32 s20, 4092, s22
  s_cmp_lt_u32 s27, 124
  s_cselect_b32 s21, 36860, s22
  s_and_b32 s23, s25, 3
  s_lshl_b32 s23, s23, 2
  s_add_u32 s23, s23, s24
  s_cmp_eq_u32 s23, 3
  s_cselect_b32 s39, s20, s22
  s_cmp_eq_u32 s23, 12
  s_cselect_b32 s39, s21, s39
  v_mov_b32 v214, s39
  s_lshl_b32 s20, s26, 2
  s_add_u32 s20, s20, s24
  s_cmp_gt_u32 s20, 124
  s_cselect_b32 s21, s22, 0
  v_add_u32 v14, s21, v1
  s_mul_i32 s20, s20, 12288
  s_add_u32 s20, s20, 0x1400000
  v_lshl_add_u32 v15, v0, 7, s20
  s_sub_u32 s20, s57, 0x800
  v_lshl_add_u32 v7, v0, 7, s20
  v_cmp_gt_u32 vcc, 16, v0
  s_nop 1
  v_cndmask_b32 v15, v7, v15, vcc
  v_mov_b32 v7, 0x800
  v_cndmask_b32 v215, 0, v7, vcc
  s_lshl_b32 s20, s2, 15
  s_lshl_b32 s21, s24, 13
  s_add_u32 s20, s20, s21
  s_add_u32 s64, s20, 0x1f00000
  s_xor_b32 s20, s20, 0x8000
  s_add_u32 s65, s20, 0x1f00000
  s_and_b32 s20, s25, 1
  s_lshl_b32 s21, s20, 16
  s_add_u32 s62, s47, s21
  s_lshl_b32 s21, s20, 14
  s_add_u32 s63, s47, s21
  s_movk_i32 s23, 125
  s_lshl_b32 s20, s26, 2
  s_add_u32 s20, s20, s24
  s_lshr_b32 s21, s25, 2
  s_mul_i32 s21, s21, 125
  s_add_u32 s20, s20, s21
  s_lshl_b32 s20, s20, 14
  s_and_b32 s21, s25, 3
  s_lshl_b32 s21, s21, 12
  s_add_u32 s20, s20, s21
  s_add_u32 s67, s20, 0x1000000
  s_waitcnt lgkmcnt(0)
  s_add_u32 s4, s44, s32
  s_addc_u32 s5, s45, 0
  s_mov_b32 s6, 1024000
  s_mov_b32 s7, 0x20000
  buffer_load_dwordx4 a[192:195], v1, s[4:7], s36 offen offset:0
  buffer_load_dwordx4 a[196:199], v1, s[4:7], s36 offen offset:1024
  buffer_load_dwordx4 a[200:203], v1, s[4:7], s36 offen offset:2048
  buffer_load_dwordx4 a[204:207], v1, s[4:7], s36 offen offset:3072
  s_mov_b32 s8, s44
  s_mov_b32 s9, s45
  s_mov_b32 s10, 0x2b00000
  s_mov_b32 s11, 0x20000
  buffer_load_dwordx4 a[128:131], v1, s[8:11], s40 offen offset:0
  buffer_load_dwordx4 a[132:135], v1, s[8:11], s40 offen offset:1024
  buffer_load_dwordx4 a[136:139], v1, s[8:11], s40 offen offset:2048
  buffer_load_dwordx4 a[140:143], v1, s[8:11], s40 offen offset:3072
  s_barrier
  s_getpc_b64 s[52:53]
pc_standalone__conformer_family_zipformer__speech_kernel:
  s_sub_u32 s52, s52, pc_standalone__conformer_family_zipformer__speech_kernel-standalone__conformer_family_zipformer__speech_kernel
  s_subb_u32 s53, s53, 0
  s_lshr_b32 s54, s2, 3
  s_mul_i32 s54, s54, 1280
  v_lshlrev_b32 v12, 7, v0
  v_add_u32 v12, s54, v12
  v_min_u32 v12, end_standalone__conformer_family_zipformer__speech_kernel-standalone__conformer_family_zipformer__speech_kernel-4, v12
  s_cmp_eq_u32 s24, 0
  s_cselect_b32 s54, 0x3ff, 1
  s_mov_b32 exec_lo, s54
  s_mov_b32 exec_hi, 0
  global_load_dword v13, v12, s[52:53]
  s_mov_b64 exec, -1
  buffer_load_dwordx4 a[144:147], v1, s[8:11], s41 offen offset:0
  buffer_load_dwordx4 a[148:151], v1, s[8:11], s41 offen offset:1024
  buffer_load_dwordx4 a[152:155], v1, s[8:11], s41 offen offset:2048
  buffer_load_dwordx4 a[156:159], v1, s[8:11], s41 offen offset:3072
  v_mov_b32 v192, 0
  v_mov_b32 v193, 0
  v_mov_b32 v194, 0
  v_mov_b32 v195, 0
  v_mov_b32 v196, 0
  v_mov_b32 v197, 0
  v_mov_b32 v198, 0
  v_mov_b32 v199, 0
  v_mov_b32 v200, 0
  v_mov_b32 v201, 0
  v_mov_b32 v202, 0
  v_mov_b32 v203, 0
  v_mov_b32 v204, 0
  v_mov_b32 v205, 0
  v_mov_b32 v206, 0
  v_mov_b32 v207, 0
  buffer_load_dwordx4 a[160:163], v1, s[8:11], s42 offen offset:0
  buffer_load_dwordx4 a[164:167], v1, s[8:11], s42 offen offset:1024
  buffer_load_dwordx4 a[168:171], v1, s[8:11], s42 offen offset:2048
  buffer_load_dwordx4 a[172:175], v1, s[8:11], s42 offen offset:3072
  v_mov_b32 v252, -1
  v_mov_b32 v253, -1
  v_mov_b32 v254, -1
  v_mov_b32 v255, -1
  s_waitcnt vmcnt(12)
  v_mfma_f32_32x32x16_bf16 v[64:79], a[192:195], a[128:131], 0
  s_waitcnt vmcnt(11)
  v_mfma_f32_32x32x16_bf16 v[64:79], a[196:199], a[132:135], v[64:79]
  s_waitcnt vmcnt(10)
  v_mfma_f32_32x32x16_bf16 v[64:79], a[200:203], a[136:139], v[64:79]
  s_waitcnt vmcnt(9)
  v_mfma_f32_32x32x16_bf16 v[64:79], a[204:207], a[140:143], v[64:79]
  buffer_load_dwordx4 v[128:131], v2, s[4:7], s36 offen offset:0
  buffer_load_dwordx4 v[132:135], v2, s[4:7], s36 offen offset:1024
  buffer_load_dwordx4 v[136:139], v2, s[4:7], s36 offen offset:2048
  buffer_load_dwordx4 v[140:143], v2, s[4:7], s36 offen offset:3072
  s_nop 7
  v_max3_f32 v212, v64, v65, v66
  v_max3_f32 v213, v67, v68, v69
  v_max3_f32 v212, v212, v70, v71
  v_max3_f32 v213, v213, v72, v73
  v_max3_f32 v212, v212, v74, v75
  v_max3_f32 v213, v213, v76, v77
  v_max3_f32 v212, v212, v78, v79
  v_max_f32 v212, v212, v213
  v_mov_b32 v213, v212
  s_nop 1
  v_permlane32_swap_b32 v213, v212
  v_max_f32 v212, v212, v213
  v_pk_add_f32 v[64:65], v[212:213], 0 op_sel_hi:[0,0] neg_lo:[1,0] neg_hi:[1,0]
  v_pk_add_f32 v[66:67], v[212:213], 0 op_sel_hi:[0,0] neg_lo:[1,0] neg_hi:[1,0]
  ds_write_b128 v8, v[64:67]
  v_pk_add_f32 v[68:69], v[212:213], 0 op_sel_hi:[0,0] neg_lo:[1,0] neg_hi:[1,0]
  v_pk_add_f32 v[70:71], v[212:213], 0 op_sel_hi:[0,0] neg_lo:[1,0] neg_hi:[1,0]
  v_pk_add_f32 v[72:73], v[212:213], 0 op_sel_hi:[0,0] neg_lo:[1,0] neg_hi:[1,0]
  v_pk_add_f32 v[74:75], v[212:213], 0 op_sel_hi:[0,0] neg_lo:[1,0] neg_hi:[1,0]
  v_pk_add_f32 v[76:77], v[212:213], 0 op_sel_hi:[0,0] neg_lo:[1,0] neg_hi:[1,0]
  v_pk_add_f32 v[78:79], v[212:213], 0 op_sel_hi:[0,0] neg_lo:[1,0] neg_hi:[1,0]
  s_nop 1
  v_mfma_f32_32x32x16_bf16 v[16:31], a[192:195], a[128:131], v[64:79]
  buffer_load_dwordx4 a[176:179], v1, s[8:11], s43 offen offset:0
  v_mfma_f32_32x32x16_bf16 v[16:31], a[196:199], a[132:135], v[16:31]
  buffer_load_dwordx4 a[180:183], v1, s[8:11], s43 offen offset:1024
  v_mfma_f32_32x32x16_bf16 v[16:31], a[200:203], a[136:139], v[16:31]
  buffer_load_dwordx4 a[184:187], v1, s[8:11], s43 offen offset:2048
  v_mfma_f32_32x32x16_bf16 v[16:31], a[204:207], a[140:143], v[16:31]
  buffer_load_dwordx4 a[188:191], v1, s[8:11], s43 offen offset:3072
  s_waitcnt lgkmcnt(0)
  s_barrier
  ds_read_b128 v[80:83], v9
  ds_read_b128 v[84:87], v9
  ds_read_b128 v[88:91], v9
  ds_read_b128 v[92:95], v9
  ds_read_b128 v[96:99], v10
  ds_read_b128 v[100:103], v10
  ds_read_b128 v[104:107], v10
  ds_read_b128 v[108:111], v10
  ds_read_b128 v[112:115], v11
  ds_read_b128 v[116:119], v11
  ds_read_b128 v[120:123], v11
  ds_read_b128 v[124:127], v11
  buffer_load_dwordx4 a[208:211], v1, s[4:7], s37 offen offset:0
  buffer_load_dwordx4 a[212:215], v1, s[4:7], s37 offen offset:1024
  buffer_load_dwordx4 a[216:219], v1, s[4:7], s37 offen offset:2048
  buffer_load_dwordx4 a[220:223], v1, s[4:7], s37 offen offset:3072
  s_mov_b32 s31, 0
  s_waitcnt vmcnt(19) lgkmcnt(8)
  v_mfma_f32_32x32x16_bf16 v[32:47], a[192:195], a[144:147], v[80:95]
  v_exp_f32 v16, v16
  v_exp_f32 v17, v17
  v_exp_f32 v18, v18
  v_exp_f32 v19, v19
  v_cvt_pk_bf16_f32 v48, v16, v17
  s_waitcnt vmcnt(18)
  v_mfma_f32_32x32x16_bf16 v[32:47], a[196:199], a[148:151], v[32:47]
  v_exp_f32 v20, v20
  v_exp_f32 v21, v21
  v_cvt_pk_bf16_f32 v49, v18, v19
  v_exp_f32 v22, v22
  v_exp_f32 v23, v23
  v_cvt_pk_bf16_f32 v50, v20, v21
  s_waitcnt vmcnt(17)
  v_mfma_f32_32x32x16_bf16 v[32:47], a[200:203], a[152:155], v[32:47]
  buffer_load_dwordx4 v[144:147], v2, s[4:7], s37 offen offset:0
  v_exp_f32 v24, v24
  v_exp_f32 v25, v25
  v_cvt_pk_bf16_f32 v51, v22, v23
  v_exp_f32 v26, v26
  v_exp_f32 v27, v27
  v_cvt_pk_bf16_f32 v52, v24, v25
  s_waitcnt vmcnt(17)
  v_mfma_f32_32x32x16_bf16 v[32:47], a[204:207], a[156:159], v[32:47]
  buffer_load_dwordx4 v[148:151], v2, s[4:7], s37 offen offset:1024
  buffer_load_dwordx4 v[152:155], v2, s[4:7], s37 offen offset:2048
  v_exp_f32 v28, v28
  v_exp_f32 v29, v29
  v_cvt_pk_bf16_f32 v53, v26, v27
  v_exp_f32 v216, v30
  v_exp_f32 v217, v31
  v_cvt_pk_bf16_f32 v54, v28, v29
  s_waitcnt vmcnt(18) lgkmcnt(4)
  v_mfma_f32_32x32x16_bf16 v[16:31], a[192:195], a[160:163], v[96:111]
  v_cvt_pk_bf16_f32 v55, v216, v217
  s_nop 0
  v_exp_f32 v32, v32
  v_exp_f32 v33, v33
  s_waitcnt vmcnt(14)
  v_mfma_f32_32x32x16_bf16 v[220:235], v[128:131], v[48:51], 0
  v_exp_f32 v34, v34
  v_exp_f32 v35, v35
  v_cvt_pk_bf16_f32 v56, v32, v33
  v_mfma_f32_32x32x16_bf16 v[16:31], a[196:199], a[164:167], v[16:31]
  v_exp_f32 v36, v36
  v_exp_f32 v37, v37
  v_cvt_pk_bf16_f32 v57, v34, v35
  s_waitcnt vmcnt(12)
  v_mfma_f32_32x32x16_bf16 v[236:251], v[136:139], v[48:51], 0
  v_exp_f32 v38, v38
  v_exp_f32 v39, v39
  v_cvt_pk_bf16_f32 v58, v36, v37
  v_mfma_f32_32x32x16_bf16 v[16:31], a[200:203], a[168:171], v[16:31]
  buffer_load_dwordx4 v[156:159], v2, s[4:7], s37 offen offset:3072
  v_exp_f32 v40, v40
  v_exp_f32 v41, v41
  v_cvt_pk_bf16_f32 v59, v38, v39
  v_mfma_f32_32x32x16_bf16 v[220:235], v[132:135], v[52:55], v[220:235]
  v_exp_f32 v42, v42
  v_exp_f32 v43, v43
  v_cvt_pk_bf16_f32 v60, v40, v41
  v_mfma_f32_32x32x16_bf16 v[16:31], a[204:207], a[172:175], v[16:31]
  buffer_load_dwordx4 a[224:227], v1, s[4:7], s28 offen offset:0
  v_exp_f32 v44, v44
  v_exp_f32 v45, v45
  v_cvt_pk_bf16_f32 v61, v42, v43
  s_waitcnt vmcnt(13)
  v_mfma_f32_32x32x16_bf16 v[236:251], v[140:143], v[52:55], v[236:251]
  v_exp_f32 v216, v46
  v_exp_f32 v217, v47
  v_cvt_pk_bf16_f32 v62, v44, v45
  v_smfmac_f32_16x16x64_bf16 v[192:195], v[208:211], v[48:55], v218
  buffer_load_dwordx4 a[228:231], v1, s[4:7], s28 offen offset:1024
  s_waitcnt vmcnt(13) lgkmcnt(0)
  v_mfma_f32_32x32x16_bf16 v[32:47], a[192:195], a[176:179], v[112:127]
  v_cvt_pk_bf16_f32 v63, v216, v217
  v_exp_f32 v16, v16
  v_exp_f32 v17, v17
  v_mfma_f32_32x32x16_bf16 a[32:47], v[128:131], v[56:59], 0
  v_exp_f32 v18, v18
  v_exp_f32 v19, v19
  v_cvt_pk_bf16_f32 v48, v16, v17
  s_waitcnt vmcnt(12)
  v_mfma_f32_32x32x16_bf16 v[32:47], a[196:199], a[180:183], v[32:47]
  v_exp_f32 v20, v20
  v_exp_f32 v21, v21
  v_cvt_pk_bf16_f32 v49, v18, v19
  v_mfma_f32_32x32x16_bf16 a[48:63], v[136:139], v[56:59], 0
  v_exp_f32 v22, v22
  v_exp_f32 v23, v23
  v_cvt_pk_bf16_f32 v50, v20, v21
  s_waitcnt vmcnt(11)
  v_mfma_f32_32x32x16_bf16 v[32:47], a[200:203], a[184:187], v[32:47]
  buffer_load_dwordx4 a[232:235], v1, s[4:7], s28 offen offset:2048
  v_exp_f32 v24, v24
  v_exp_f32 v25, v25
  v_cvt_pk_bf16_f32 v51, v22, v23
  v_mfma_f32_32x32x16_bf16 a[32:47], v[132:135], v[60:63], a[32:47]
  v_exp_f32 v26, v26
  v_exp_f32 v27, v27
  v_cvt_pk_bf16_f32 v52, v24, v25
  s_waitcnt vmcnt(11)
  v_mfma_f32_32x32x16_bf16 v[32:47], a[204:207], a[188:191], v[32:47]
  buffer_load_dwordx4 a[236:239], v1, s[4:7], s28 offen offset:3072
  v_exp_f32 v28, v28
  v_exp_f32 v29, v29
  v_cvt_pk_bf16_f32 v53, v26, v27
  v_mfma_f32_32x32x16_bf16 a[48:63], v[140:143], v[60:63], a[48:63]
  v_exp_f32 v216, v30
  v_exp_f32 v217, v31
  v_cvt_pk_bf16_f32 v54, v28, v29
  v_smfmac_f32_16x16x64_bf16 v[196:199], v[208:211], v[56:63], v218
  buffer_load_dwordx4 v[160:163], v2, s[4:7], s28 offen offset:0
  s_waitcnt vmcnt(12)
  v_mfma_f32_32x32x16_bf16 v[16:31], a[208:211], a[128:131], v[64:79]
  v_cvt_pk_bf16_f32 v55, v216, v217
  v_exp_f32 v32, v32
  v_exp_f32 v33, v33
  v_mfma_f32_32x32x16_bf16 a[64:79], v[128:131], v[48:51], 0
  v_exp_f32 v34, v34
  v_exp_f32 v35, v35
  v_cvt_pk_bf16_f32 v56, v32, v33
  s_waitcnt vmcnt(11)
  v_mfma_f32_32x32x16_bf16 v[16:31], a[212:215], a[132:135], v[16:31]
  v_exp_f32 v36, v36
  v_exp_f32 v37, v37
  v_cvt_pk_bf16_f32 v57, v34, v35
  v_mfma_f32_32x32x16_bf16 a[80:95], v[136:139], v[48:51], 0
  v_exp_f32 v38, v38
  v_exp_f32 v39, v39
  v_cvt_pk_bf16_f32 v58, v36, v37
  s_waitcnt vmcnt(10)
  v_mfma_f32_32x32x16_bf16 v[16:31], a[216:219], a[136:139], v[16:31]
  buffer_load_dwordx4 v[164:167], v2, s[4:7], s28 offen offset:1024
  v_exp_f32 v40, v40
  v_exp_f32 v41, v41
  v_cvt_pk_bf16_f32 v59, v38, v39
  v_mfma_f32_32x32x16_bf16 a[64:79], v[132:135], v[52:55], a[64:79]
  v_exp_f32 v42, v42
  v_exp_f32 v43, v43
  v_cvt_pk_bf16_f32 v60, v40, v41
  s_waitcnt vmcnt(10)
  v_mfma_f32_32x32x16_bf16 v[16:31], a[220:223], a[140:143], v[16:31]
  buffer_load_dwordx4 v[168:171], v2, s[4:7], s28 offen offset:2048
  v_exp_f32 v44, v44
  v_exp_f32 v45, v45
  v_cvt_pk_bf16_f32 v61, v42, v43
  v_mfma_f32_32x32x16_bf16 a[80:95], v[140:143], v[52:55], a[80:95]
  v_exp_f32 v216, v46
  v_exp_f32 v217, v47
  v_cvt_pk_bf16_f32 v62, v44, v45
  v_smfmac_f32_16x16x64_bf16 v[200:203], v[208:211], v[48:55], v218
  buffer_load_dwordx4 v[172:175], v2, s[4:7], s28 offen offset:3072
  v_mfma_f32_32x32x16_bf16 v[32:47], a[208:211], a[144:147], v[80:95]
  v_cvt_pk_bf16_f32 v63, v216, v217
  v_exp_f32 v16, v16
  v_exp_f32 v17, v17
  v_mfma_f32_32x32x16_bf16 a[96:111], v[128:131], v[56:59], 0
  v_exp_f32 v18, v18
  v_exp_f32 v19, v19
  v_cvt_pk_bf16_f32 v48, v16, v17
  s_lshl_b32 s20, s25, 7
  v_mfma_f32_32x32x16_bf16 v[32:47], a[212:215], a[148:151], v[32:47]
  v_exp_f32 v20, v20
  v_exp_f32 v21, v21
  v_cvt_pk_bf16_f32 v49, v18, v19
  v_mfma_f32_32x32x16_bf16 a[112:127], v[136:139], v[56:59], 0
  v_exp_f32 v22, v22
  v_exp_f32 v23, v23
  v_cvt_pk_bf16_f32 v50, v20, v21
  s_lshl_b32 s21, s26, 2
  v_mfma_f32_32x32x16_bf16 v[32:47], a[216:219], a[152:155], v[32:47]
  buffer_load_dwordx4 a[240:243], v1, s[4:7], s29 offen offset:0
  v_exp_f32 v24, v24
  v_exp_f32 v25, v25
  v_cvt_pk_bf16_f32 v51, v22, v23
  v_mfma_f32_32x32x16_bf16 a[96:111], v[132:135], v[60:63], a[96:111]
  v_exp_f32 v26, v26
  v_exp_f32 v27, v27
  v_cvt_pk_bf16_f32 v52, v24, v25
  s_add_u32 s20, s20, s21
  v_mfma_f32_32x32x16_bf16 v[32:47], a[220:223], a[156:159], v[32:47]
  buffer_load_dwordx4 a[244:247], v1, s[4:7], s29 offen offset:1024
  v_exp_f32 v28, v28
  v_exp_f32 v29, v29
  v_cvt_pk_bf16_f32 v53, v26, v27
  v_mfma_f32_32x32x16_bf16 a[112:127], v[140:143], v[60:63], a[112:127]
  v_exp_f32 v216, v30
  v_exp_f32 v217, v31
  v_cvt_pk_bf16_f32 v54, v28, v29
  v_smfmac_f32_16x16x64_bf16 v[204:207], v[208:211], v[56:63], v218
  buffer_load_dwordx4 a[248:251], v1, s[4:7], s29 offen offset:2048
  v_mfma_f32_32x32x16_bf16 v[16:31], a[208:211], a[160:163], v[96:111]
  v_cvt_pk_bf16_f32 v55, v216, v217
  v_exp_f32 v32, v32
  v_exp_f32 v33, v33
  s_waitcnt vmcnt(14)
  v_mfma_f32_32x32x16_bf16 v[220:235], v[144:147], v[48:51], v[220:235]
  v_exp_f32 v34, v34
  v_exp_f32 v35, v35
  v_cvt_pk_bf16_f32 v56, v32, v33
  s_add_u32 s20, s20, s24
  v_mfma_f32_32x32x16_bf16 v[16:31], a[212:215], a[164:167], v[16:31]
  v_exp_f32 v36, v36
  v_exp_f32 v37, v37
  v_cvt_pk_bf16_f32 v57, v34, v35
  s_waitcnt vmcnt(12)
  v_mfma_f32_32x32x16_bf16 v[236:251], v[152:155], v[48:51], v[236:251]
  v_exp_f32 v38, v38
  v_exp_f32 v39, v39
  v_cvt_pk_bf16_f32 v58, v36, v37
  s_lshl_b32 s20, s20, 4
  v_mfma_f32_32x32x16_bf16 v[16:31], a[216:219], a[168:171], v[16:31]
  buffer_load_dwordx4 a[252:255], v1, s[4:7], s29 offen offset:3072
  v_exp_f32 v40, v40
  v_exp_f32 v41, v41
  v_cvt_pk_bf16_f32 v59, v38, v39
  v_mfma_f32_32x32x16_bf16 v[220:235], v[148:151], v[52:55], v[220:235]
  v_exp_f32 v42, v42
  v_exp_f32 v43, v43
  v_cvt_pk_bf16_f32 v60, v40, v41
  s_add_u32 s12, s20, 0x1e80000
  v_mfma_f32_32x32x16_bf16 v[16:31], a[220:223], a[172:175], v[16:31]
  buffer_load_dwordx4 v[176:179], v2, s[4:7], s29 offen offset:0
  v_exp_f32 v44, v44
  v_exp_f32 v45, v45
  v_cvt_pk_bf16_f32 v61, v42, v43
  s_waitcnt vmcnt(13)
  v_mfma_f32_32x32x16_bf16 v[236:251], v[156:159], v[52:55], v[236:251]
  v_exp_f32 v216, v46
  v_exp_f32 v217, v47
  v_cvt_pk_bf16_f32 v62, v44, v45
  v_smfmac_f32_16x16x64_bf16 v[192:195], v[208:211], v[48:55], v218
  buffer_load_dwordx4 v[180:183], v2, s[4:7], s29 offen offset:1024
  v_mfma_f32_32x32x16_bf16 v[32:47], a[208:211], a[176:179], v[112:127]
  v_cvt_pk_bf16_f32 v63, v216, v217
  v_exp_f32 v16, v16
  v_exp_f32 v17, v17
  v_mfma_f32_32x32x16_bf16 a[32:47], v[144:147], v[56:59], a[32:47]
  v_exp_f32 v18, v18
  v_exp_f32 v19, v19
  v_cvt_pk_bf16_f32 v48, v16, v17
  s_xor_b32 s20, s20, 0
  v_mfma_f32_32x32x16_bf16 v[32:47], a[212:215], a[180:183], v[32:47]
  buffer_store_dwordx4 v[252:255], v14, s[8:11], s67 offen offset:0 sc1
  v_exp_f32 v20, v20
  v_exp_f32 v21, v21
  v_cvt_pk_bf16_f32 v49, v18, v19
  v_mfma_f32_32x32x16_bf16 a[48:63], v[152:155], v[56:59], a[48:63]
  v_exp_f32 v22, v22
  v_exp_f32 v23, v23
  v_cvt_pk_bf16_f32 v50, v20, v21
  s_and_b32 s21, s25, 4
  v_mfma_f32_32x32x16_bf16 v[32:47], a[216:219], a[184:187], v[32:47]
  buffer_load_dwordx4 v[184:187], v2, s[4:7], s29 offen offset:2048
  v_exp_f32 v24, v24
  v_exp_f32 v25, v25
  v_cvt_pk_bf16_f32 v51, v22, v23
  v_mfma_f32_32x32x16_bf16 a[32:47], v[148:151], v[60:63], a[32:47]
  v_exp_f32 v26, v26
  v_exp_f32 v27, v27
  v_cvt_pk_bf16_f32 v52, v24, v25
  s_add_u32 s21, s21, s24
  v_mfma_f32_32x32x16_bf16 v[32:47], a[220:223], a[188:191], v[32:47]
  buffer_load_dwordx4 v[188:191], v2, s[4:7], s29 offen offset:3072
  v_exp_f32 v28, v28
  v_exp_f32 v29, v29
  v_cvt_pk_bf16_f32 v53, v26, v27
  s_add_u32 s30, s30, 0x8000
  v_mfma_f32_32x32x16_bf16 a[48:63], v[156:159], v[60:63], a[48:63]
  v_exp_f32 v216, v30
  v_exp_f32 v217, v31
  v_cvt_pk_bf16_f32 v54, v28, v29
  s_min_u32 s28, s30, 0xf8000
  v_smfmac_f32_16x16x64_bf16 v[196:199], v[208:211], v[56:63], v218
  buffer_load_dwordx4 a[192:195], v1, s[4:7], s28 offen offset:0
  s_waitcnt vmcnt(17)
  v_mfma_f32_32x32x16_bf16 v[16:31], a[224:227], a[128:131], v[64:79]
  v_cvt_pk_bf16_f32 v55, v216, v217
  v_exp_f32 v32, v32
  v_exp_f32 v33, v33
  v_mfma_f32_32x32x16_bf16 a[64:79], v[144:147], v[48:51], a[64:79]
  v_exp_f32 v34, v34
  v_exp_f32 v35, v35
  v_cvt_pk_bf16_f32 v56, v32, v33
  s_lshl_b32 s21, s21, 7
  s_waitcnt vmcnt(16)
  v_mfma_f32_32x32x16_bf16 v[16:31], a[228:231], a[132:135], v[16:31]
  buffer_store_dwordx4 v[252:255], v14, s[8:11], s67 offen offset:1024 sc1
  v_exp_f32 v36, v36
  v_exp_f32 v37, v37
  v_cvt_pk_bf16_f32 v57, v34, v35
  v_mfma_f32_32x32x16_bf16 a[80:95], v[152:155], v[48:51], a[80:95]
  v_exp_f32 v38, v38
  v_exp_f32 v39, v39
  v_cvt_pk_bf16_f32 v58, v36, v37
  s_sub_u32 s21, s21, 1
  s_waitcnt vmcnt(16)
  v_mfma_f32_32x32x16_bf16 v[16:31], a[232:235], a[136:139], v[16:31]
  buffer_load_dwordx4 a[196:199], v1, s[4:7], s28 offen offset:1024
  v_exp_f32 v40, v40
  v_exp_f32 v41, v41
  v_cvt_pk_bf16_f32 v59, v38, v39
  v_mfma_f32_32x32x16_bf16 a[64:79], v[148:151], v[52:55], a[64:79]
  v_exp_f32 v42, v42
  v_exp_f32 v43, v43
  v_cvt_pk_bf16_f32 v60, v40, v41
  v_add_u32 v7, s27, v0
  s_waitcnt vmcnt(16)
  v_mfma_f32_32x32x16_bf16 v[16:31], a[236:239], a[140:143], v[16:31]
  buffer_load_dwordx4 a[200:203], v1, s[4:7], s28 offen offset:2048
  v_exp_f32 v44, v44
  v_exp_f32 v45, v45
  v_cvt_pk_bf16_f32 v61, v42, v43
  v_mfma_f32_32x32x16_bf16 a[80:95], v[156:159], v[52:55], a[80:95]
  v_exp_f32 v216, v46
  v_exp_f32 v217, v47
  v_cvt_pk_bf16_f32 v62, v44, v45
  v_smfmac_f32_16x16x64_bf16 v[200:203], v[208:211], v[48:55], v218
  buffer_load_dwordx4 a[204:207], v1, s[4:7], s28 offen offset:3072
  v_mfma_f32_32x32x16_bf16 v[32:47], a[224:227], a[144:147], v[80:95]
  v_cvt_pk_bf16_f32 v63, v216, v217
  v_exp_f32 v16, v16
  v_exp_f32 v17, v17
  v_mfma_f32_32x32x16_bf16 a[96:111], v[144:147], v[56:59], a[96:111]
  v_exp_f32 v18, v18
  v_exp_f32 v19, v19
  v_cvt_pk_bf16_f32 v48, v16, v17
  v_med3_u32 v7, v7, 1, s23
  v_mfma_f32_32x32x16_bf16 v[32:47], a[228:231], a[148:151], v[32:47]
  buffer_store_dwordx4 v[252:255], v14, s[8:11], s67 offen offset:2048 sc1
  v_exp_f32 v20, v20
  v_exp_f32 v21, v21
  v_cvt_pk_bf16_f32 v49, v18, v19
  v_mfma_f32_32x32x16_bf16 a[112:127], v[152:155], v[56:59], a[112:127]
  v_exp_f32 v22, v22
  v_exp_f32 v23, v23
  v_cvt_pk_bf16_f32 v50, v20, v21
  v_add_lshl_u32 v7, v7, s21, 4
  v_mfma_f32_32x32x16_bf16 v[32:47], a[232:235], a[152:155], v[32:47]
  buffer_load_dwordx4 v[128:131], v2, s[4:7], s28 offen offset:0
  v_exp_f32 v24, v24
  v_exp_f32 v25, v25
  v_cvt_pk_bf16_f32 v51, v22, v23
  v_mfma_f32_32x32x16_bf16 a[96:111], v[148:151], v[60:63], a[96:111]
  v_exp_f32 v26, v26
  v_exp_f32 v27, v27
  v_cvt_pk_bf16_f32 v52, v24, v25
  v_cmp_gt_u32 vcc, 3, v0
  v_mfma_f32_32x32x16_bf16 v[32:47], a[236:239], a[156:159], v[32:47]
  buffer_load_dwordx4 v[132:135], v2, s[4:7], s28 offen offset:1024
  v_exp_f32 v28, v28
  v_exp_f32 v29, v29
  v_cvt_pk_bf16_f32 v53, v26, v27
  v_mfma_f32_32x32x16_bf16 a[112:127], v[156:159], v[60:63], a[112:127]
  v_exp_f32 v216, v30
  v_exp_f32 v217, v31
  v_cvt_pk_bf16_f32 v54, v28, v29
  v_smfmac_f32_16x16x64_bf16 v[204:207], v[208:211], v[56:63], v218
  buffer_load_dwordx4 v[136:139], v2, s[4:7], s28 offen offset:2048
  v_mfma_f32_32x32x16_bf16 v[16:31], a[224:227], a[160:163], v[96:111]
  v_cvt_pk_bf16_f32 v55, v216, v217
  v_exp_f32 v32, v32
  v_exp_f32 v33, v33
  s_waitcnt vmcnt(21)
  v_mfma_f32_32x32x16_bf16 v[220:235], v[160:163], v[48:51], v[220:235]
  v_exp_f32 v34, v34
  v_exp_f32 v35, v35
  v_cvt_pk_bf16_f32 v56, v32, v33
  v_mov_b32 v9, s20
  v_mfma_f32_32x32x16_bf16 v[16:31], a[228:231], a[164:167], v[16:31]
  buffer_store_dwordx4 v[252:255], v14, s[8:11], s67 offen offset:3072 sc1
  v_exp_f32 v36, v36
  v_exp_f32 v37, v37
  v_cvt_pk_bf16_f32 v57, v34, v35
  s_waitcnt vmcnt(20)
  v_mfma_f32_32x32x16_bf16 v[236:251], v[168:171], v[48:51], v[236:251]
  v_exp_f32 v38, v38
  v_exp_f32 v39, v39
  v_cvt_pk_bf16_f32 v58, v36, v37
  v_cndmask_b32 v7, v9, v7, vcc
  v_mfma_f32_32x32x16_bf16 v[16:31], a[232:235], a[168:171], v[16:31]
  buffer_load_dwordx4 v[140:143], v2, s[4:7], s28 offen offset:3072
  v_exp_f32 v40, v40
  v_exp_f32 v41, v41
  v_cvt_pk_bf16_f32 v59, v38, v39
  s_add_u32 s30, s30, 0x8000
  v_mfma_f32_32x32x16_bf16 v[220:235], v[164:167], v[52:55], v[220:235]
  v_exp_f32 v42, v42
  v_exp_f32 v43, v43
  v_cvt_pk_bf16_f32 v60, v40, v41
  s_min_u32 s29, s30, 0xf8000
  s_mov_b32 s13, 0x1e80000
  v_mfma_f32_32x32x16_bf16 v[16:31], a[236:239], a[172:175], v[16:31]
  buffer_load_dwordx4 a[208:211], v1, s[4:7], s29 offen offset:0
  v_exp_f32 v44, v44
  v_exp_f32 v45, v45
  v_cvt_pk_bf16_f32 v61, v42, v43
  s_waitcnt vmcnt(21)
  v_mfma_f32_32x32x16_bf16 v[236:251], v[172:175], v[52:55], v[236:251]
  v_exp_f32 v216, v46
  v_exp_f32 v217, v47
  v_cvt_pk_bf16_f32 v62, v44, v45
  v_smfmac_f32_16x16x64_bf16 v[192:195], v[208:211], v[48:55], v218
  buffer_load_dwordx4 a[212:215], v1, s[4:7], s29 offen offset:1024
  v_mfma_f32_32x32x16_bf16 v[32:47], a[224:227], a[176:179], v[112:127]
  v_cvt_pk_bf16_f32 v63, v216, v217
  v_exp_f32 v16, v16
  v_exp_f32 v17, v17
  v_mfma_f32_32x32x16_bf16 a[32:47], v[160:163], v[56:59], a[32:47]
  v_exp_f32 v18, v18
  v_exp_f32 v19, v19
  v_cvt_pk_bf16_f32 v48, v16, v17
  v_lshlrev_b32 v9, 26, v0
  v_mfma_f32_32x32x16_bf16 v[32:47], a[228:231], a[180:183], v[32:47]
  v_exp_f32 v20, v20
  v_exp_f32 v21, v21
  v_cvt_pk_bf16_f32 v49, v18, v19
  v_mfma_f32_32x32x16_bf16 a[48:63], v[168:171], v[56:59], a[48:63]
  v_exp_f32 v22, v22
  v_exp_f32 v23, v23
  v_cvt_pk_bf16_f32 v50, v20, v21
  s_lshr_b32 s20, s25, 2
  v_mfma_f32_32x32x16_bf16 v[32:47], a[232:235], a[184:187], v[32:47]
  buffer_load_dwordx4 a[216:219], v1, s[4:7], s29 offen offset:2048
  v_exp_f32 v24, v24
  v_exp_f32 v25, v25
  v_cvt_pk_bf16_f32 v51, v22, v23
  v_mfma_f32_32x32x16_bf16 a[32:47], v[164:167], v[60:63], a[32:47]
  v_exp_f32 v26, v26
  v_exp_f32 v27, v27
  v_cvt_pk_bf16_f32 v52, v24, v25
  s_lshl_b32 s20, s20, 5
  v_mfma_f32_32x32x16_bf16 v[32:47], a[236:239], a[188:191], v[32:47]
  buffer_load_dwordx4 a[220:223], v1, s[4:7], s29 offen offset:3072
  v_exp_f32 v28, v28
  v_exp_f32 v29, v29
  v_cvt_pk_bf16_f32 v53, v26, v27
  v_mfma_f32_32x32x16_bf16 a[48:63], v[172:175], v[60:63], a[48:63]
  v_exp_f32 v216, v30
  v_exp_f32 v217, v31
  v_cvt_pk_bf16_f32 v54, v28, v29
  v_smfmac_f32_16x16x64_bf16 v[196:199], v[208:211], v[56:63], v218
  buffer_load_dwordx4 v[144:147], v2, s[4:7], s29 offen offset:0
  s_waitcnt vmcnt(24)
  v_mfma_f32_32x32x16_bf16 v[16:31], a[240:243], a[128:131], v[64:79]
  v_cvt_pk_bf16_f32 v55, v216, v217
  v_exp_f32 v32, v32
  v_exp_f32 v33, v33
  v_mfma_f32_32x32x16_bf16 a[64:79], v[160:163], v[48:51], a[64:79]
  v_exp_f32 v34, v34
  v_exp_f32 v35, v35
  v_cvt_pk_bf16_f32 v56, v32, v33
  s_add_u32 s20, s20, s26
  s_waitcnt vmcnt(23)
  v_mfma_f32_32x32x16_bf16 v[16:31], a[244:247], a[132:135], v[16:31]
  v_exp_f32 v36, v36
  v_exp_f32 v37, v37
  v_cvt_pk_bf16_f32 v57, v34, v35
  v_mfma_f32_32x32x16_bf16 a[80:95], v[168:171], v[48:51], a[80:95]
  v_exp_f32 v38, v38
  v_exp_f32 v39, v39
  v_cvt_pk_bf16_f32 v58, v36, v37
  s_lshl_b32 s20, s20, 2
  s_waitcnt vmcnt(22)
  v_mfma_f32_32x32x16_bf16 v[16:31], a[248:251], a[136:139], v[16:31]
  buffer_load_dwordx4 v[148:151], v2, s[4:7], s29 offen offset:1024
  v_exp_f32 v40, v40
  v_exp_f32 v41, v41
  v_cvt_pk_bf16_f32 v59, v38, v39
  v_mfma_f32_32x32x16_bf16 a[64:79], v[164:167], v[52:55], a[64:79]
  v_exp_f32 v42, v42
  v_exp_f32 v43, v43
  v_cvt_pk_bf16_f32 v60, v40, v41
  s_and_b32 s21, s25, 3
  s_waitcnt vmcnt(22)
  v_mfma_f32_32x32x16_bf16 v[16:31], a[252:255], a[140:143], v[16:31]
  buffer_load_dwordx4 v[152:155], v2, s[4:7], s29 offen offset:2048
  v_exp_f32 v44, v44
  v_exp_f32 v45, v45
  v_cvt_pk_bf16_f32 v61, v42, v43
  v_mfma_f32_32x32x16_bf16 a[80:95], v[172:175], v[52:55], a[80:95]
  v_exp_f32 v216, v46
  v_exp_f32 v217, v47
  v_cvt_pk_bf16_f32 v62, v44, v45
  v_smfmac_f32_16x16x64_bf16 v[200:203], v[208:211], v[48:55], v218
  buffer_load_dwordx4 v[156:159], v2, s[4:7], s29 offen offset:3072
  v_mfma_f32_32x32x16_bf16 v[32:47], a[240:243], a[144:147], v[80:95]
  v_cvt_pk_bf16_f32 v63, v216, v217
  v_exp_f32 v16, v16
  v_exp_f32 v17, v17
  v_mfma_f32_32x32x16_bf16 a[96:111], v[160:163], v[56:59], a[96:111]
  v_exp_f32 v18, v18
  v_exp_f32 v19, v19
  v_cvt_pk_bf16_f32 v48, v16, v17
  s_add_u32 s20, s20, s21
  v_mfma_f32_32x32x16_bf16 v[32:47], a[244:247], a[148:151], v[32:47]
  v_exp_f32 v20, v20
  v_exp_f32 v21, v21
  v_cvt_pk_bf16_f32 v49, v18, v19
  s_add_u32 s30, s30, 0x8000
  v_mfma_f32_32x32x16_bf16 a[112:127], v[168:171], v[56:59], a[112:127]
  v_exp_f32 v22, v22
  v_exp_f32 v23, v23
  v_cvt_pk_bf16_f32 v50, v20, v21
  s_min_u32 s28, s30, 0xf8000
  s_lshl_b32 s20, s20, 2
  v_mfma_f32_32x32x16_bf16 v[32:47], a[248:251], a[152:155], v[32:47]
  buffer_load_dwordx4 a[224:227], v1, s[4:7], s28 offen offset:0
  v_exp_f32 v24, v24
  v_exp_f32 v25, v25
  v_cvt_pk_bf16_f32 v51, v22, v23
  v_mfma_f32_32x32x16_bf16 a[96:111], v[164:167], v[60:63], a[96:111]
  v_exp_f32 v26, v26
  v_exp_f32 v27, v27
  v_cvt_pk_bf16_f32 v52, v24, v25
  s_add_u32 s20, s20, s24
  v_mfma_f32_32x32x16_bf16 v[32:47], a[252:255], a[156:159], v[32:47]
  buffer_load_dwordx4 a[228:231], v1, s[4:7], s28 offen offset:1024
  v_exp_f32 v28, v28
  v_exp_f32 v29, v29
  v_cvt_pk_bf16_f32 v53, v26, v27
  v_mfma_f32_32x32x16_bf16 a[112:127], v[172:175], v[60:63], a[112:127]
  v_exp_f32 v216, v30
  v_exp_f32 v217, v31
  v_cvt_pk_bf16_f32 v54, v28, v29
  v_smfmac_f32_16x16x64_bf16 v[204:207], v[208:211], v[56:63], v218
  buffer_load_dwordx4 a[232:235], v1, s[4:7], s28 offen offset:2048
  v_mfma_f32_32x32x16_bf16 v[16:31], a[240:243], a[160:163], v[96:111]
  v_cvt_pk_bf16_f32 v55, v216, v217
  v_exp_f32 v32, v32
  v_exp_f32 v33, v33
  s_waitcnt vmcnt(26)
  v_mfma_f32_32x32x16_bf16 v[220:235], v[176:179], v[48:51], v[220:235]
  v_exp_f32 v34, v34
  v_exp_f32 v35, v35
  v_cvt_pk_bf16_f32 v56, v32, v33
  s_lshl_b32 s20, s20, 12
  v_mfma_f32_32x32x16_bf16 v[16:31], a[244:247], a[164:167], v[16:31]
  v_exp_f32 v36, v36
  v_exp_f32 v37, v37
  v_cvt_pk_bf16_f32 v57, v34, v35
  s_waitcnt vmcnt(23)
  v_mfma_f32_32x32x16_bf16 v[236:251], v[184:187], v[48:51], v[236:251]
  v_exp_f32 v38, v38
  v_exp_f32 v39, v39
  v_cvt_pk_bf16_f32 v58, v36, v37
  s_add_u32 s58, s20, 0x2700000
  v_mfma_f32_32x32x16_bf16 v[16:31], a[248:251], a[168:171], v[16:31]
  buffer_load_dwordx4 a[236:239], v1, s[4:7], s28 offen offset:3072
  v_exp_f32 v40, v40
  v_exp_f32 v41, v41
  v_cvt_pk_bf16_f32 v59, v38, v39
  v_mfma_f32_32x32x16_bf16 v[220:235], v[180:183], v[52:55], v[220:235]
  v_exp_f32 v42, v42
  v_exp_f32 v43, v43
  v_cvt_pk_bf16_f32 v60, v40, v41
  s_add_u32 s60, s20, 0x26fc000
  v_mfma_f32_32x32x16_bf16 v[16:31], a[252:255], a[172:175], v[16:31]
  buffer_load_dwordx4 v[160:163], v2, s[4:7], s28 offen offset:0
  v_exp_f32 v44, v44
  v_exp_f32 v45, v45
  v_cvt_pk_bf16_f32 v61, v42, v43
  s_waitcnt vmcnt(24)
  v_mfma_f32_32x32x16_bf16 v[236:251], v[188:191], v[52:55], v[236:251]
  v_exp_f32 v216, v46
  v_exp_f32 v217, v47
  v_cvt_pk_bf16_f32 v62, v44, v45
  v_smfmac_f32_16x16x64_bf16 v[192:195], v[208:211], v[48:55], v218
  buffer_load_dwordx4 v[164:167], v2, s[4:7], s28 offen offset:1024
  v_mfma_f32_32x32x16_bf16 v[32:47], a[240:243], a[176:179], v[112:127]
  v_cvt_pk_bf16_f32 v63, v216, v217
  v_exp_f32 v16, v16
  v_exp_f32 v17, v17
  v_mfma_f32_32x32x16_bf16 a[32:47], v[176:179], v[56:59], a[32:47]
  v_exp_f32 v18, v18
  v_exp_f32 v19, v19
  v_cvt_pk_bf16_f32 v48, v16, v17
  v_mfma_f32_32x32x16_bf16 v[32:47], a[244:247], a[180:183], v[32:47]
  v_exp_f32 v20, v20
  v_exp_f32 v21, v21
  v_cvt_pk_bf16_f32 v49, v18, v19
  v_mfma_f32_32x32x16_bf16 a[48:63], v[184:187], v[56:59], a[48:63]
  v_exp_f32 v22, v22
  v_exp_f32 v23, v23
  v_cvt_pk_bf16_f32 v50, v20, v21
  v_mfma_f32_32x32x16_bf16 v[32:47], a[248:251], a[184:187], v[32:47]
  v_exp_f32 v24, v24
  v_exp_f32 v25, v25
  v_cvt_pk_bf16_f32 v51, v22, v23
  v_mfma_f32_32x32x16_bf16 a[32:47], v[180:183], v[60:63], a[32:47]
  v_exp_f32 v26, v26
  v_exp_f32 v27, v27
  v_cvt_pk_bf16_f32 v52, v24, v25
  v_mfma_f32_32x32x16_bf16 v[32:47], a[252:255], a[188:191], v[32:47]
  v_exp_f32 v28, v28
  v_exp_f32 v29, v29
  v_cvt_pk_bf16_f32 v53, v26, v27
  v_mfma_f32_32x32x16_bf16 a[48:63], v[188:191], v[60:63], a[48:63]
  v_exp_f32 v216, v30
  v_exp_f32 v217, v31
  v_cvt_pk_bf16_f32 v54, v28, v29
  v_smfmac_f32_16x16x64_bf16 v[196:199], v[208:211], v[56:63], v218
  buffer_load_dwordx4 v[168:171], v2, s[4:7], s28 offen offset:2048
  s_waitcnt vmcnt(25)
  v_mfma_f32_32x32x16_bf16 v[16:31], a[192:195], a[128:131], v[64:79]
  v_cvt_pk_bf16_f32 v55, v216, v217
  v_exp_f32 v32, v32
  v_exp_f32 v33, v33
  v_mfma_f32_32x32x16_bf16 a[64:79], v[176:179], v[48:51], a[64:79]
  v_exp_f32 v34, v34
  v_exp_f32 v35, v35
  v_cvt_pk_bf16_f32 v56, v32, v33
  s_add_u32 s30, s30, 0x8000
  s_load_dwordx2 s[48:49], s[0:1], 48
  s_load_dwordx2 s[50:51], s[0:1], 80
  s_waitcnt vmcnt(23)
  v_mfma_f32_32x32x16_bf16 v[16:31], a[196:199], a[132:135], v[16:31]
  s_waitcnt vmcnt(16)
  buffer_store_dword v252, v9, s[8:11], s12 offen sc1
  v_exp_f32 v36, v36
  v_exp_f32 v37, v37
  v_cvt_pk_bf16_f32 v57, v34, v35
  s_min_u32 s29, s30, 0xf8000
  v_mfma_f32_32x32x16_bf16 a[80:95], v[184:187], v[48:51], a[80:95]
  v_exp_f32 v38, v38
  v_exp_f32 v39, v39
  v_cvt_pk_bf16_f32 v58, v36, v37
  v_mfma_f32_32x32x16_bf16 v[16:31], a[200:203], a[136:139], v[16:31]
  v_exp_f32 v40, v40
  v_exp_f32 v41, v41
  v_cvt_pk_bf16_f32 v59, v38, v39
  v_mfma_f32_32x32x16_bf16 a[64:79], v[180:183], v[52:55], a[64:79]
  v_exp_f32 v42, v42
  v_exp_f32 v43, v43
  v_cvt_pk_bf16_f32 v60, v40, v41
  v_mfma_f32_32x32x16_bf16 v[16:31], a[204:207], a[140:143], v[16:31]
  v_exp_f32 v44, v44
  v_exp_f32 v45, v45
  v_cvt_pk_bf16_f32 v61, v42, v43
  v_mfma_f32_32x32x16_bf16 a[80:95], v[188:191], v[52:55], a[80:95]
  v_exp_f32 v216, v46
  v_exp_f32 v217, v47
  v_cvt_pk_bf16_f32 v62, v44, v45
  v_smfmac_f32_16x16x64_bf16 v[200:203], v[208:211], v[48:55], v218
  buffer_load_dwordx4 a[240:243], v1, s[4:7], s29 offen offset:0
B_loop:
  v_mfma_f32_32x32x16_bf16 v[32:47], a[192:195], a[144:147], v[80:95]
  v_cvt_pk_bf16_f32 v63, v216, v217
  s_nop 0
  v_exp_f32 v16, v16
  v_exp_f32 v17, v17
  v_mfma_f32_32x32x16_bf16 a[96:111], v[176:179], v[56:59], a[96:111]
  v_exp_f32 v18, v18
  v_exp_f32 v19, v19
  v_cvt_pk_bf16_f32 v48, v16, v17
  v_mfma_f32_32x32x16_bf16 v[32:47], a[196:199], a[148:151], v[32:47]
  v_exp_f32 v20, v20
  v_exp_f32 v21, v21
  v_cvt_pk_bf16_f32 v49, v18, v19
  v_mfma_f32_32x32x16_bf16 a[112:127], v[184:187], v[56:59], a[112:127]
  v_exp_f32 v22, v22
  v_exp_f32 v23, v23
  v_cvt_pk_bf16_f32 v50, v20, v21
  v_mfma_f32_32x32x16_bf16 v[32:47], a[200:203], a[152:155], v[32:47]
  v_exp_f32 v24, v24
  v_exp_f32 v25, v25
  v_cvt_pk_bf16_f32 v51, v22, v23
  v_mfma_f32_32x32x16_bf16 a[96:111], v[180:183], v[60:63], a[96:111]
  v_exp_f32 v26, v26
  v_exp_f32 v27, v27
  v_cvt_pk_bf16_f32 v52, v24, v25
  v_mfma_f32_32x32x16_bf16 v[32:47], a[204:207], a[156:159], v[32:47]
  buffer_load_dwordx4 a[244:247], v1, s[4:7], s29 offen offset:1024
  v_exp_f32 v28, v28
  v_exp_f32 v29, v29
  v_cvt_pk_bf16_f32 v53, v26, v27
  v_mfma_f32_32x32x16_bf16 a[112:127], v[188:191], v[60:63], a[112:127]
  v_exp_f32 v216, v30
  v_exp_f32 v217, v31
  v_cvt_pk_bf16_f32 v54, v28, v29
  v_smfmac_f32_16x16x64_bf16 v[204:207], v[208:211], v[56:63], v218
  buffer_load_dwordx4 v[172:175], v2, s[4:7], s28 offen offset:3072
  v_mfma_f32_32x32x16_bf16 v[16:31], a[192:195], a[160:163], v[96:111]
  v_cvt_pk_bf16_f32 v55, v216, v217
  v_exp_f32 v32, v32
  v_exp_f32 v33, v33
  v_mfma_f32_32x32x16_bf16 v[220:235], v[128:131], v[48:51], v[220:235]
  v_exp_f32 v34, v34
  v_exp_f32 v35, v35
  v_cvt_pk_bf16_f32 v56, v32, v33
  v_mfma_f32_32x32x16_bf16 v[16:31], a[196:199], a[164:167], v[16:31]
  buffer_load_dword v219, v15, s[8:11], 0 offen
  v_exp_f32 v36, v36
  v_exp_f32 v37, v37
  v_cvt_pk_bf16_f32 v57, v34, v35
  s_waitcnt vmcnt(19)
  v_mfma_f32_32x32x16_bf16 v[236:251], v[136:139], v[48:51], v[236:251]
  v_exp_f32 v38, v38
  v_exp_f32 v39, v39
  v_cvt_pk_bf16_f32 v58, v36, v37
  v_mfma_f32_32x32x16_bf16 v[16:31], a[200:203], a[168:171], v[16:31]
  v_exp_f32 v40, v40
  v_exp_f32 v41, v41
  v_cvt_pk_bf16_f32 v59, v38, v39
  v_add_u32 v15, v15, v215
  v_mfma_f32_32x32x16_bf16 v[220:235], v[132:135], v[52:55], v[220:235]
  v_exp_f32 v42, v42
  v_exp_f32 v43, v43
  v_cvt_pk_bf16_f32 v60, v40, v41
  v_mfma_f32_32x32x16_bf16 v[16:31], a[204:207], a[172:175], v[16:31]
  buffer_load_dwordx4 a[248:251], v1, s[4:7], s29 offen offset:2048
  v_exp_f32 v44, v44
  v_exp_f32 v45, v45
  v_cvt_pk_bf16_f32 v61, v42, v43
  s_waitcnt vmcnt(18)
  v_mfma_f32_32x32x16_bf16 v[236:251], v[140:143], v[52:55], v[236:251]
  v_exp_f32 v216, v46
  v_exp_f32 v217, v47
  v_cvt_pk_bf16_f32 v62, v44, v45
  v_smfmac_f32_16x16x64_bf16 v[192:195], v[208:211], v[48:55], v218
  buffer_load_dwordx4 v[176:179], v2, s[4:7], s29 offen offset:0
  v_mfma_f32_32x32x16_bf16 v[32:47], a[192:195], a[176:179], v[112:127]
  v_cvt_pk_bf16_f32 v63, v216, v217
  v_exp_f32 v16, v16
  v_exp_f32 v17, v17
  v_mfma_f32_32x32x16_bf16 a[32:47], v[128:131], v[56:59], a[32:47]
  v_exp_f32 v18, v18
  v_exp_f32 v19, v19
  v_cvt_pk_bf16_f32 v48, v16, v17
  v_mfma_f32_32x32x16_bf16 v[32:47], a[196:199], a[180:183], v[32:47]
  v_exp_f32 v20, v20
  v_exp_f32 v21, v21
  v_cvt_pk_bf16_f32 v49, v18, v19
  v_mfma_f32_32x32x16_bf16 a[48:63], v[136:139], v[56:59], a[48:63]
  v_exp_f32 v22, v22
  v_exp_f32 v23, v23
  v_cvt_pk_bf16_f32 v50, v20, v21
  v_mfma_f32_32x32x16_bf16 v[32:47], a[200:203], a[184:187], v[32:47]
  v_exp_f32 v24, v24
  v_exp_f32 v25, v25
  v_cvt_pk_bf16_f32 v51, v22, v23
  v_mfma_f32_32x32x16_bf16 a[32:47], v[132:135], v[60:63], a[32:47]
  v_exp_f32 v26, v26
  v_exp_f32 v27, v27
  v_cvt_pk_bf16_f32 v52, v24, v25
  v_mfma_f32_32x32x16_bf16 v[32:47], a[204:207], a[188:191], v[32:47]
  buffer_load_dwordx4 a[252:255], v1, s[4:7], s29 offen offset:3072
  v_exp_f32 v28, v28
  v_exp_f32 v29, v29
  v_cvt_pk_bf16_f32 v53, v26, v27
  v_mfma_f32_32x32x16_bf16 a[48:63], v[140:143], v[60:63], a[48:63]
  v_exp_f32 v216, v30
  v_exp_f32 v217, v31
  v_cvt_pk_bf16_f32 v54, v28, v29
  v_smfmac_f32_16x16x64_bf16 v[196:199], v[208:211], v[56:63], v218
  buffer_load_dwordx4 v[180:183], v2, s[4:7], s29 offen offset:1024
  s_waitcnt vmcnt(23)
  v_mfma_f32_32x32x16_bf16 v[16:31], a[208:211], a[128:131], v[64:79]
  v_cvt_pk_bf16_f32 v55, v216, v217
  v_exp_f32 v32, v32
  v_exp_f32 v33, v33
  v_mfma_f32_32x32x16_bf16 a[64:79], v[128:131], v[48:51], a[64:79]
  v_exp_f32 v34, v34
  v_exp_f32 v35, v35
  v_cvt_pk_bf16_f32 v56, v32, v33
  s_add_u32 s30, s30, 0x8000
  s_waitcnt vmcnt(22)
  v_mfma_f32_32x32x16_bf16 v[16:31], a[212:215], a[132:135], v[16:31]
  v_exp_f32 v36, v36
  v_exp_f32 v37, v37
  v_cvt_pk_bf16_f32 v57, v34, v35
  s_min_u32 s28, s30, 0xf8000
  v_mfma_f32_32x32x16_bf16 a[80:95], v[136:139], v[48:51], a[80:95]
  v_exp_f32 v38, v38
  v_exp_f32 v39, v39
  v_cvt_pk_bf16_f32 v58, v36, v37
  s_waitcnt vmcnt(20)
  v_mfma_f32_32x32x16_bf16 v[16:31], a[216:219], a[136:139], v[16:31]
  v_exp_f32 v40, v40
  v_exp_f32 v41, v41
  v_cvt_pk_bf16_f32 v59, v38, v39
  v_mfma_f32_32x32x16_bf16 a[64:79], v[132:135], v[52:55], a[64:79]
  v_exp_f32 v42, v42
  v_exp_f32 v43, v43
  v_cvt_pk_bf16_f32 v60, v40, v41
  s_waitcnt vmcnt(18)
  v_mfma_f32_32x32x16_bf16 v[16:31], a[220:223], a[140:143], v[16:31]
  buffer_load_dwordx4 a[192:195], v1, s[4:7], s28 offen offset:0
  v_exp_f32 v44, v44
  v_exp_f32 v45, v45
  v_cvt_pk_bf16_f32 v61, v42, v43
  v_mfma_f32_32x32x16_bf16 a[80:95], v[140:143], v[52:55], a[80:95]
  v_exp_f32 v216, v46
  v_exp_f32 v217, v47
  v_cvt_pk_bf16_f32 v62, v44, v45
  v_smfmac_f32_16x16x64_bf16 v[200:203], v[208:211], v[48:55], v218
  buffer_load_dwordx4 v[184:187], v2, s[4:7], s29 offen offset:2048
  v_mfma_f32_32x32x16_bf16 v[32:47], a[208:211], a[144:147], v[80:95]
  v_cvt_pk_bf16_f32 v63, v216, v217
  v_exp_f32 v16, v16
  v_exp_f32 v17, v17
  v_mfma_f32_32x32x16_bf16 a[96:111], v[128:131], v[56:59], a[96:111]
  v_exp_f32 v18, v18
  v_exp_f32 v19, v19
  v_cvt_pk_bf16_f32 v48, v16, v17
  v_mfma_f32_32x32x16_bf16 v[32:47], a[212:215], a[148:151], v[32:47]
  v_exp_f32 v20, v20
  v_exp_f32 v21, v21
  v_cvt_pk_bf16_f32 v49, v18, v19
  v_mfma_f32_32x32x16_bf16 a[112:127], v[136:139], v[56:59], a[112:127]
  v_exp_f32 v22, v22
  v_exp_f32 v23, v23
  v_cvt_pk_bf16_f32 v50, v20, v21
  v_mfma_f32_32x32x16_bf16 v[32:47], a[216:219], a[152:155], v[32:47]
  v_exp_f32 v24, v24
  v_exp_f32 v25, v25
  v_cvt_pk_bf16_f32 v51, v22, v23
  v_mfma_f32_32x32x16_bf16 a[96:111], v[132:135], v[60:63], a[96:111]
  v_exp_f32 v26, v26
  v_exp_f32 v27, v27
  v_cvt_pk_bf16_f32 v52, v24, v25
  v_mfma_f32_32x32x16_bf16 v[32:47], a[220:223], a[156:159], v[32:47]
  buffer_load_dwordx4 a[196:199], v1, s[4:7], s28 offen offset:1024
  v_exp_f32 v28, v28
  v_exp_f32 v29, v29
  v_cvt_pk_bf16_f32 v53, v26, v27
  v_mfma_f32_32x32x16_bf16 a[112:127], v[140:143], v[60:63], a[112:127]
  v_exp_f32 v216, v30
  v_exp_f32 v217, v31
  v_cvt_pk_bf16_f32 v54, v28, v29
  v_smfmac_f32_16x16x64_bf16 v[204:207], v[208:211], v[56:63], v218
  buffer_load_dwordx4 v[188:191], v2, s[4:7], s29 offen offset:3072
  v_mfma_f32_32x32x16_bf16 v[16:31], a[208:211], a[160:163], v[96:111]
  v_cvt_pk_bf16_f32 v55, v216, v217
  v_exp_f32 v32, v32
  v_exp_f32 v33, v33
  s_waitcnt vmcnt(23)
  v_mfma_f32_32x32x16_bf16 v[220:235], v[144:147], v[48:51], v[220:235]
  v_exp_f32 v34, v34
  v_exp_f32 v35, v35
  v_cvt_pk_bf16_f32 v56, v32, v33
  v_mfma_f32_32x32x16_bf16 v[16:31], a[212:215], a[164:167], v[16:31]
  v_exp_f32 v36, v36
  v_exp_f32 v37, v37
  v_cvt_pk_bf16_f32 v57, v34, v35
  s_waitcnt vmcnt(19)
  v_mfma_f32_32x32x16_bf16 v[236:251], v[152:155], v[48:51], v[236:251]
  v_exp_f32 v38, v38
  v_exp_f32 v39, v39
  v_cvt_pk_bf16_f32 v58, v36, v37
  v_mfma_f32_32x32x16_bf16 v[16:31], a[216:219], a[168:171], v[16:31]
  v_exp_f32 v40, v40
  v_exp_f32 v41, v41
  v_cvt_pk_bf16_f32 v59, v38, v39
  v_mfma_f32_32x32x16_bf16 v[220:235], v[148:151], v[52:55], v[220:235]
  v_exp_f32 v42, v42
  v_exp_f32 v43, v43
  v_cvt_pk_bf16_f32 v60, v40, v41
  v_mfma_f32_32x32x16_bf16 v[16:31], a[220:223], a[172:175], v[16:31]
  buffer_load_dwordx4 a[200:203], v1, s[4:7], s28 offen offset:2048
  v_exp_f32 v44, v44
  v_exp_f32 v45, v45
  v_cvt_pk_bf16_f32 v61, v42, v43
  s_waitcnt vmcnt(18)
  v_mfma_f32_32x32x16_bf16 v[236:251], v[156:159], v[52:55], v[236:251]
  v_exp_f32 v216, v46
  v_exp_f32 v217, v47
  v_cvt_pk_bf16_f32 v62, v44, v45
  v_smfmac_f32_16x16x64_bf16 v[192:195], v[208:211], v[48:55], v218
  buffer_load_dwordx4 v[128:131], v2, s[4:7], s28 offen offset:0
  v_mfma_f32_32x32x16_bf16 v[32:47], a[208:211], a[176:179], v[112:127]
  v_cvt_pk_bf16_f32 v63, v216, v217
  v_exp_f32 v16, v16
  v_exp_f32 v17, v17
  v_mfma_f32_32x32x16_bf16 a[32:47], v[144:147], v[56:59], a[32:47]
  v_exp_f32 v18, v18
  v_exp_f32 v19, v19
  v_cvt_pk_bf16_f32 v48, v16, v17
  v_mfma_f32_32x32x16_bf16 v[32:47], a[212:215], a[180:183], v[32:47]
  v_exp_f32 v20, v20
  v_exp_f32 v21, v21
  v_cvt_pk_bf16_f32 v49, v18, v19
  v_mfma_f32_32x32x16_bf16 a[48:63], v[152:155], v[56:59], a[48:63]
  v_exp_f32 v22, v22
  v_exp_f32 v23, v23
  v_cvt_pk_bf16_f32 v50, v20, v21
  v_mfma_f32_32x32x16_bf16 v[32:47], a[216:219], a[184:187], v[32:47]
  v_exp_f32 v24, v24
  v_exp_f32 v25, v25
  v_cvt_pk_bf16_f32 v51, v22, v23
  v_mfma_f32_32x32x16_bf16 a[32:47], v[148:151], v[60:63], a[32:47]
  v_exp_f32 v26, v26
  v_exp_f32 v27, v27
  v_cvt_pk_bf16_f32 v52, v24, v25
  v_mfma_f32_32x32x16_bf16 v[32:47], a[220:223], a[188:191], v[32:47]
  buffer_load_dwordx4 a[204:207], v1, s[4:7], s28 offen offset:3072
  v_exp_f32 v28, v28
  v_exp_f32 v29, v29
  v_cvt_pk_bf16_f32 v53, v26, v27
  v_mfma_f32_32x32x16_bf16 a[48:63], v[156:159], v[60:63], a[48:63]
  v_exp_f32 v216, v30
  v_exp_f32 v217, v31
  v_cvt_pk_bf16_f32 v54, v28, v29
  v_smfmac_f32_16x16x64_bf16 v[196:199], v[208:211], v[56:63], v218
  buffer_load_dwordx4 v[132:135], v2, s[4:7], s28 offen offset:1024
  s_waitcnt vmcnt(23)
  v_mfma_f32_32x32x16_bf16 v[16:31], a[224:227], a[128:131], v[64:79]
  v_cvt_pk_bf16_f32 v55, v216, v217
  v_exp_f32 v32, v32
  v_exp_f32 v33, v33
  v_mfma_f32_32x32x16_bf16 a[64:79], v[144:147], v[48:51], a[64:79]
  v_exp_f32 v34, v34
  v_exp_f32 v35, v35
  v_cvt_pk_bf16_f32 v56, v32, v33
  s_add_u32 s30, s30, 0x8000
  s_waitcnt vmcnt(22)
  v_mfma_f32_32x32x16_bf16 v[16:31], a[228:231], a[132:135], v[16:31]
  v_exp_f32 v36, v36
  v_exp_f32 v37, v37
  v_cvt_pk_bf16_f32 v57, v34, v35
  s_min_u32 s29, s30, 0xf8000
  v_mfma_f32_32x32x16_bf16 a[80:95], v[152:155], v[48:51], a[80:95]
  v_exp_f32 v38, v38
  v_exp_f32 v39, v39
  v_cvt_pk_bf16_f32 v58, v36, v37
  s_waitcnt vmcnt(20)
  v_mfma_f32_32x32x16_bf16 v[16:31], a[232:235], a[136:139], v[16:31]
  v_exp_f32 v40, v40
  v_exp_f32 v41, v41
  v_cvt_pk_bf16_f32 v59, v38, v39
  v_mfma_f32_32x32x16_bf16 a[64:79], v[148:151], v[52:55], a[64:79]
  v_exp_f32 v42, v42
  v_exp_f32 v43, v43
  v_cvt_pk_bf16_f32 v60, v40, v41
  s_waitcnt vmcnt(18)
  v_mfma_f32_32x32x16_bf16 v[16:31], a[236:239], a[140:143], v[16:31]
  buffer_load_dwordx4 a[208:211], v1, s[4:7], s29 offen offset:0
  v_exp_f32 v44, v44
  v_exp_f32 v45, v45
  v_cvt_pk_bf16_f32 v61, v42, v43
  v_mfma_f32_32x32x16_bf16 a[80:95], v[156:159], v[52:55], a[80:95]
  v_exp_f32 v216, v46
  v_exp_f32 v217, v47
  v_cvt_pk_bf16_f32 v62, v44, v45
  v_smfmac_f32_16x16x64_bf16 v[200:203], v[208:211], v[48:55], v218
  buffer_load_dwordx4 v[136:139], v2, s[4:7], s28 offen offset:2048
  v_mfma_f32_32x32x16_bf16 v[32:47], a[224:227], a[144:147], v[80:95]
  v_cvt_pk_bf16_f32 v63, v216, v217
  v_exp_f32 v16, v16
  v_exp_f32 v17, v17
  v_mfma_f32_32x32x16_bf16 a[96:111], v[144:147], v[56:59], a[96:111]
  v_exp_f32 v18, v18
  v_exp_f32 v19, v19
  v_cvt_pk_bf16_f32 v48, v16, v17
  v_mfma_f32_32x32x16_bf16 v[32:47], a[228:231], a[148:151], v[32:47]
  v_exp_f32 v20, v20
  v_exp_f32 v21, v21
  v_cvt_pk_bf16_f32 v49, v18, v19
  v_mfma_f32_32x32x16_bf16 a[112:127], v[152:155], v[56:59], a[112:127]
  v_exp_f32 v22, v22
  v_exp_f32 v23, v23
  v_cvt_pk_bf16_f32 v50, v20, v21
  v_mfma_f32_32x32x16_bf16 v[32:47], a[232:235], a[152:155], v[32:47]
  v_exp_f32 v24, v24
  v_exp_f32 v25, v25
  v_cvt_pk_bf16_f32 v51, v22, v23
  v_mfma_f32_32x32x16_bf16 a[96:111], v[148:151], v[60:63], a[96:111]
  v_exp_f32 v26, v26
  v_exp_f32 v27, v27
  v_cvt_pk_bf16_f32 v52, v24, v25
  v_mfma_f32_32x32x16_bf16 v[32:47], a[236:239], a[156:159], v[32:47]
  buffer_load_dwordx4 a[212:215], v1, s[4:7], s29 offen offset:1024
  v_exp_f32 v28, v28
  v_exp_f32 v29, v29
  v_cvt_pk_bf16_f32 v53, v26, v27
  v_mfma_f32_32x32x16_bf16 a[112:127], v[156:159], v[60:63], a[112:127]
  v_exp_f32 v216, v30
  v_exp_f32 v217, v31
  v_cvt_pk_bf16_f32 v54, v28, v29
  v_smfmac_f32_16x16x64_bf16 v[204:207], v[208:211], v[56:63], v218
  buffer_load_dwordx4 v[140:143], v2, s[4:7], s28 offen offset:3072
  v_mfma_f32_32x32x16_bf16 v[16:31], a[224:227], a[160:163], v[96:111]
  v_cvt_pk_bf16_f32 v55, v216, v217
  v_exp_f32 v32, v32
  v_exp_f32 v33, v33
  s_waitcnt vmcnt(23)
  v_mfma_f32_32x32x16_bf16 v[220:235], v[160:163], v[48:51], v[220:235]
  v_exp_f32 v34, v34
  v_exp_f32 v35, v35
  v_cvt_pk_bf16_f32 v56, v32, v33
  v_mfma_f32_32x32x16_bf16 v[16:31], a[228:231], a[164:167], v[16:31]
  v_exp_f32 v36, v36
  v_exp_f32 v37, v37
  v_cvt_pk_bf16_f32 v57, v34, v35
  s_waitcnt vmcnt(19)
  v_mfma_f32_32x32x16_bf16 v[236:251], v[168:171], v[48:51], v[236:251]
  v_exp_f32 v38, v38
  v_exp_f32 v39, v39
  v_cvt_pk_bf16_f32 v58, v36, v37
  v_mfma_f32_32x32x16_bf16 v[16:31], a[232:235], a[168:171], v[16:31]
  v_exp_f32 v40, v40
  v_exp_f32 v41, v41
  v_cvt_pk_bf16_f32 v59, v38, v39
  v_mfma_f32_32x32x16_bf16 v[220:235], v[164:167], v[52:55], v[220:235]
  v_exp_f32 v42, v42
  v_exp_f32 v43, v43
  v_cvt_pk_bf16_f32 v60, v40, v41
  v_mfma_f32_32x32x16_bf16 v[16:31], a[236:239], a[172:175], v[16:31]
  buffer_load_dwordx4 a[216:219], v1, s[4:7], s29 offen offset:2048
  v_exp_f32 v44, v44
  v_exp_f32 v45, v45
  v_cvt_pk_bf16_f32 v61, v42, v43
  s_waitcnt vmcnt(18)
  v_mfma_f32_32x32x16_bf16 v[236:251], v[172:175], v[52:55], v[236:251]
  v_exp_f32 v216, v46
  v_exp_f32 v217, v47
  v_cvt_pk_bf16_f32 v62, v44, v45
  v_smfmac_f32_16x16x64_bf16 v[192:195], v[208:211], v[48:55], v218
  buffer_load_dwordx4 v[144:147], v2, s[4:7], s29 offen offset:0
  v_mfma_f32_32x32x16_bf16 v[32:47], a[224:227], a[176:179], v[112:127]
  v_cvt_pk_bf16_f32 v63, v216, v217
  v_exp_f32 v16, v16
  v_exp_f32 v17, v17
  v_mfma_f32_32x32x16_bf16 a[32:47], v[160:163], v[56:59], a[32:47]
  v_exp_f32 v18, v18
  v_exp_f32 v19, v19
  v_cvt_pk_bf16_f32 v48, v16, v17
  v_mfma_f32_32x32x16_bf16 v[32:47], a[228:231], a[180:183], v[32:47]
  v_exp_f32 v20, v20
  v_exp_f32 v21, v21
  v_cvt_pk_bf16_f32 v49, v18, v19
  v_mfma_f32_32x32x16_bf16 a[48:63], v[168:171], v[56:59], a[48:63]
  v_exp_f32 v22, v22
  v_exp_f32 v23, v23
  v_cvt_pk_bf16_f32 v50, v20, v21
  v_mfma_f32_32x32x16_bf16 v[32:47], a[232:235], a[184:187], v[32:47]
  v_exp_f32 v24, v24
  v_exp_f32 v25, v25
  v_cvt_pk_bf16_f32 v51, v22, v23
  v_mfma_f32_32x32x16_bf16 a[32:47], v[164:167], v[60:63], a[32:47]
  v_exp_f32 v26, v26
  v_exp_f32 v27, v27
  v_cvt_pk_bf16_f32 v52, v24, v25
  v_mfma_f32_32x32x16_bf16 v[32:47], a[236:239], a[188:191], v[32:47]
  buffer_load_dwordx4 a[220:223], v1, s[4:7], s29 offen offset:3072
  v_exp_f32 v28, v28
  v_exp_f32 v29, v29
  v_cvt_pk_bf16_f32 v53, v26, v27
  v_mfma_f32_32x32x16_bf16 a[48:63], v[172:175], v[60:63], a[48:63]
  v_exp_f32 v216, v30
  v_exp_f32 v217, v31
  v_cvt_pk_bf16_f32 v54, v28, v29
  v_smfmac_f32_16x16x64_bf16 v[196:199], v[208:211], v[56:63], v218
  buffer_load_dwordx4 v[148:151], v2, s[4:7], s29 offen offset:1024
  v_mfma_f32_32x32x16_bf16 v[16:31], a[240:243], a[128:131], v[64:79]
  v_cvt_pk_bf16_f32 v55, v216, v217
  v_exp_f32 v32, v32
  v_exp_f32 v33, v33
  v_mfma_f32_32x32x16_bf16 a[64:79], v[160:163], v[48:51], a[64:79]
  v_exp_f32 v34, v34
  v_exp_f32 v35, v35
  v_cvt_pk_bf16_f32 v56, v32, v33
  s_add_u32 s30, s30, 0x8000
  v_mfma_f32_32x32x16_bf16 v[16:31], a[244:247], a[132:135], v[16:31]
  v_exp_f32 v36, v36
  v_exp_f32 v37, v37
  v_cvt_pk_bf16_f32 v57, v34, v35
  s_min_u32 s28, s30, 0xf8000
  v_mfma_f32_32x32x16_bf16 a[80:95], v[168:171], v[48:51], a[80:95]
  v_exp_f32 v38, v38
  v_exp_f32 v39, v39
  v_cvt_pk_bf16_f32 v58, v36, v37
  s_waitcnt vmcnt(19)
  v_mfma_f32_32x32x16_bf16 v[16:31], a[248:251], a[136:139], v[16:31]
  v_exp_f32 v40, v40
  v_exp_f32 v41, v41
  v_cvt_pk_bf16_f32 v59, v38, v39
  v_mfma_f32_32x32x16_bf16 a[64:79], v[164:167], v[52:55], a[64:79]
  v_exp_f32 v42, v42
  v_exp_f32 v43, v43
  v_cvt_pk_bf16_f32 v60, v40, v41
  s_waitcnt vmcnt(17)
  v_mfma_f32_32x32x16_bf16 v[16:31], a[252:255], a[140:143], v[16:31]
  buffer_load_dwordx4 a[224:227], v1, s[4:7], s28 offen offset:0
  v_exp_f32 v44, v44
  v_exp_f32 v45, v45
  v_cvt_pk_bf16_f32 v61, v42, v43
  v_mfma_f32_32x32x16_bf16 a[80:95], v[172:175], v[52:55], a[80:95]
  v_exp_f32 v216, v46
  v_exp_f32 v217, v47
  v_cvt_pk_bf16_f32 v62, v44, v45
  v_smfmac_f32_16x16x64_bf16 v[200:203], v[208:211], v[48:55], v218
  buffer_load_dwordx4 v[152:155], v2, s[4:7], s29 offen offset:2048
  v_mfma_f32_32x32x16_bf16 v[32:47], a[240:243], a[144:147], v[80:95]
  v_cvt_pk_bf16_f32 v63, v216, v217
  v_exp_f32 v16, v16
  v_exp_f32 v17, v17
  v_mfma_f32_32x32x16_bf16 a[96:111], v[160:163], v[56:59], a[96:111]
  v_exp_f32 v18, v18
  v_exp_f32 v19, v19
  v_cvt_pk_bf16_f32 v48, v16, v17
  v_mfma_f32_32x32x16_bf16 v[32:47], a[244:247], a[148:151], v[32:47]
  v_exp_f32 v20, v20
  v_exp_f32 v21, v21
  v_cvt_pk_bf16_f32 v49, v18, v19
  v_mfma_f32_32x32x16_bf16 a[112:127], v[168:171], v[56:59], a[112:127]
  v_exp_f32 v22, v22
  v_exp_f32 v23, v23
  v_cvt_pk_bf16_f32 v50, v20, v21
  v_mfma_f32_32x32x16_bf16 v[32:47], a[248:251], a[152:155], v[32:47]
  v_exp_f32 v24, v24
  v_exp_f32 v25, v25
  v_cvt_pk_bf16_f32 v51, v22, v23
  v_mfma_f32_32x32x16_bf16 a[96:111], v[164:167], v[60:63], a[96:111]
  v_exp_f32 v26, v26
  v_exp_f32 v27, v27
  v_cvt_pk_bf16_f32 v52, v24, v25
  v_mfma_f32_32x32x16_bf16 v[32:47], a[252:255], a[156:159], v[32:47]
  buffer_load_dwordx4 a[228:231], v1, s[4:7], s28 offen offset:1024
  v_exp_f32 v28, v28
  v_exp_f32 v29, v29
  v_cvt_pk_bf16_f32 v53, v26, v27
  v_mfma_f32_32x32x16_bf16 a[112:127], v[172:175], v[60:63], a[112:127]
  v_exp_f32 v216, v30
  v_exp_f32 v217, v31
  v_cvt_pk_bf16_f32 v54, v28, v29
  v_smfmac_f32_16x16x64_bf16 v[204:207], v[208:211], v[56:63], v218
  buffer_load_dwordx4 v[156:159], v2, s[4:7], s29 offen offset:3072
  v_mfma_f32_32x32x16_bf16 v[16:31], a[240:243], a[160:163], v[96:111]
  v_cvt_pk_bf16_f32 v55, v216, v217
  v_exp_f32 v32, v32
  v_exp_f32 v33, v33
  v_mfma_f32_32x32x16_bf16 v[220:235], v[176:179], v[48:51], v[220:235]
  v_exp_f32 v34, v34
  v_exp_f32 v35, v35
  v_cvt_pk_bf16_f32 v56, v32, v33
  v_mfma_f32_32x32x16_bf16 v[16:31], a[244:247], a[164:167], v[16:31]
  v_exp_f32 v36, v36
  v_exp_f32 v37, v37
  v_cvt_pk_bf16_f32 v57, v34, v35
  s_waitcnt vmcnt(18)
  v_mfma_f32_32x32x16_bf16 v[236:251], v[184:187], v[48:51], v[236:251]
  v_exp_f32 v38, v38
  v_exp_f32 v39, v39
  v_cvt_pk_bf16_f32 v58, v36, v37
  v_mfma_f32_32x32x16_bf16 v[16:31], a[248:251], a[168:171], v[16:31]
  v_exp_f32 v40, v40
  v_exp_f32 v41, v41
  v_cvt_pk_bf16_f32 v59, v38, v39
  v_mfma_f32_32x32x16_bf16 v[220:235], v[180:183], v[52:55], v[220:235]
  v_exp_f32 v42, v42
  v_exp_f32 v43, v43
  v_cvt_pk_bf16_f32 v60, v40, v41
  v_mfma_f32_32x32x16_bf16 v[16:31], a[252:255], a[172:175], v[16:31]
  buffer_load_dwordx4 a[232:235], v1, s[4:7], s28 offen offset:2048
  v_exp_f32 v44, v44
  v_exp_f32 v45, v45
  v_cvt_pk_bf16_f32 v61, v42, v43
  s_waitcnt vmcnt(17)
  v_mfma_f32_32x32x16_bf16 v[236:251], v[188:191], v[52:55], v[236:251]
  v_exp_f32 v216, v46
  v_exp_f32 v217, v47
  v_cvt_pk_bf16_f32 v62, v44, v45
  v_smfmac_f32_16x16x64_bf16 v[192:195], v[208:211], v[48:55], v218
  buffer_load_dwordx4 v[160:163], v2, s[4:7], s28 offen offset:0
  v_mfma_f32_32x32x16_bf16 v[32:47], a[240:243], a[176:179], v[112:127]
  v_cvt_pk_bf16_f32 v63, v216, v217
  v_exp_f32 v16, v16
  v_exp_f32 v17, v17
  v_mfma_f32_32x32x16_bf16 a[32:47], v[176:179], v[56:59], a[32:47]
  v_exp_f32 v18, v18
  v_exp_f32 v19, v19
  v_cvt_pk_bf16_f32 v48, v16, v17
  v_mfma_f32_32x32x16_bf16 v[32:47], a[244:247], a[180:183], v[32:47]
  v_exp_f32 v20, v20
  v_exp_f32 v21, v21
  v_cvt_pk_bf16_f32 v49, v18, v19
  v_mfma_f32_32x32x16_bf16 a[48:63], v[184:187], v[56:59], a[48:63]
  v_exp_f32 v22, v22
  v_exp_f32 v23, v23
  v_cvt_pk_bf16_f32 v50, v20, v21
  v_mfma_f32_32x32x16_bf16 v[32:47], a[248:251], a[184:187], v[32:47]
  v_exp_f32 v24, v24
  v_exp_f32 v25, v25
  v_cvt_pk_bf16_f32 v51, v22, v23
  s_cmp_eq_u32 s31, 5
  v_mfma_f32_32x32x16_bf16 a[32:47], v[180:183], v[60:63], a[32:47]
  v_exp_f32 v26, v26
  v_exp_f32 v27, v27
  v_cvt_pk_bf16_f32 v52, v24, v25
  v_mfma_f32_32x32x16_bf16 v[32:47], a[252:255], a[188:191], v[32:47]
  buffer_load_dwordx4 a[236:239], v1, s[4:7], s28 offen offset:3072
  v_exp_f32 v28, v28
  v_exp_f32 v29, v29
  v_cvt_pk_bf16_f32 v53, v26, v27
  v_mfma_f32_32x32x16_bf16 a[48:63], v[188:191], v[60:63], a[48:63]
  v_exp_f32 v216, v30
  v_exp_f32 v217, v31
  v_cvt_pk_bf16_f32 v54, v28, v29
  v_smfmac_f32_16x16x64_bf16 v[196:199], v[208:211], v[56:63], v218
  buffer_load_dwordx4 v[164:167], v2, s[4:7], s28 offen offset:1024
  s_cbranch_scc1 B_tail
  v_mfma_f32_32x32x16_bf16 v[16:31], a[192:195], a[128:131], v[64:79]
  v_cvt_pk_bf16_f32 v55, v216, v217
  v_exp_f32 v32, v32
  v_exp_f32 v33, v33
  v_mfma_f32_32x32x16_bf16 a[64:79], v[176:179], v[48:51], a[64:79]
  v_exp_f32 v34, v34
  v_exp_f32 v35, v35
  v_cvt_pk_bf16_f32 v56, v32, v33
  s_add_u32 s30, s30, 0x8000
  v_mfma_f32_32x32x16_bf16 v[16:31], a[196:199], a[132:135], v[16:31]
  v_exp_f32 v36, v36
  v_exp_f32 v37, v37
  v_cvt_pk_bf16_f32 v57, v34, v35
  s_min_u32 s29, s30, 0xf8000
  v_mfma_f32_32x32x16_bf16 a[80:95], v[184:187], v[48:51], a[80:95]
  v_exp_f32 v38, v38
  v_exp_f32 v39, v39
  v_cvt_pk_bf16_f32 v58, v36, v37
  s_waitcnt vmcnt(19)
  v_mfma_f32_32x32x16_bf16 v[16:31], a[200:203], a[136:139], v[16:31]
  v_exp_f32 v40, v40
  v_exp_f32 v41, v41
  v_cvt_pk_bf16_f32 v59, v38, v39
  s_add_u32 s31, s31, 1
  v_mfma_f32_32x32x16_bf16 a[64:79], v[180:183], v[52:55], a[64:79]
  v_exp_f32 v42, v42
  v_exp_f32 v43, v43
  v_cvt_pk_bf16_f32 v60, v40, v41
  s_waitcnt vmcnt(17)
  v_mfma_f32_32x32x16_bf16 v[16:31], a[204:207], a[140:143], v[16:31]
  buffer_load_dwordx4 a[240:243], v1, s[4:7], s29 offen offset:0
  v_exp_f32 v44, v44
  v_exp_f32 v45, v45
  v_cvt_pk_bf16_f32 v61, v42, v43
  v_mfma_f32_32x32x16_bf16 a[80:95], v[188:191], v[52:55], a[80:95]
  v_exp_f32 v216, v46
  v_exp_f32 v217, v47
  v_cvt_pk_bf16_f32 v62, v44, v45
  v_smfmac_f32_16x16x64_bf16 v[200:203], v[208:211], v[48:55], v218
  buffer_load_dwordx4 v[168:171], v2, s[4:7], s28 offen offset:2048
  s_branch B_loop
B_tail:
  s_add_u32 s46, s47, 0x0
  v_mfma_f32_32x32x16_bf16 v[16:31], a[192:195], a[144:147], v[80:95]
  buffer_load_dwordx4 a[0:3], v1, s[8:11], s46 offen offset:0
  v_cvt_pk_bf16_f32 v55, v216, v217
  v_exp_f32 v32, v32
  v_exp_f32 v33, v33
  v_mfma_f32_32x32x16_bf16 a[64:79], v[176:179], v[48:51], a[64:79]
  v_exp_f32 v34, v34
  v_exp_f32 v35, v35
  v_cvt_pk_bf16_f32 v56, v32, v33
  s_add_u32 s30, s30, 0x8000
  v_mfma_f32_32x32x16_bf16 v[16:31], a[196:199], a[148:151], v[16:31]
  buffer_load_dwordx4 a[4:7], v1, s[8:11], s46 offen offset:1024
  v_exp_f32 v36, v36
  v_exp_f32 v37, v37
  v_cvt_pk_bf16_f32 v57, v34, v35
  s_min_u32 s29, s30, 0xf8000
  v_mfma_f32_32x32x16_bf16 a[80:95], v[184:187], v[48:51], a[80:95]
  v_exp_f32 v38, v38
  v_exp_f32 v39, v39
  v_cvt_pk_bf16_f32 v58, v36, v37
  s_waitcnt vmcnt(21)
  v_mfma_f32_32x32x16_bf16 v[16:31], a[200:203], a[152:155], v[16:31]
  v_exp_f32 v40, v40
  v_exp_f32 v41, v41
  v_cvt_pk_bf16_f32 v59, v38, v39
  v_mfma_f32_32x32x16_bf16 a[64:79], v[180:183], v[52:55], a[64:79]
  v_exp_f32 v42, v42
  v_exp_f32 v43, v43
  v_cvt_pk_bf16_f32 v60, v40, v41
  s_waitcnt vmcnt(19)
  v_mfma_f32_32x32x16_bf16 v[16:31], a[204:207], a[156:159], v[16:31]
  buffer_load_dwordx4 a[240:243], v1, s[4:7], s29 offen offset:0
  v_exp_f32 v44, v44
  v_exp_f32 v45, v45
  v_cvt_pk_bf16_f32 v61, v42, v43
  v_mfma_f32_32x32x16_bf16 a[80:95], v[188:191], v[52:55], a[80:95]
  v_exp_f32 v216, v46
  v_exp_f32 v217, v47
  v_cvt_pk_bf16_f32 v62, v44, v45
  v_smfmac_f32_16x16x64_bf16 v[200:203], v[208:211], v[48:55], v218
  buffer_load_dwordx4 v[168:171], v2, s[4:7], s28 offen offset:2048
  s_waitcnt vmcnt(19)
  v_mfma_f32_32x32x16_bf16 v[32:47], a[208:211], a[144:147], v[80:95]
  buffer_load_dwordx4 a[8:11], v1, s[8:11], s46 offen offset:2048
  v_cvt_pk_bf16_f32 v63, v216, v217
  v_exp_f32 v16, v16
  v_exp_f32 v17, v17
  v_mfma_f32_32x32x16_bf16 a[96:111], v[176:179], v[56:59], a[96:111]
  v_exp_f32 v18, v18
  v_exp_f32 v19, v19
  v_cvt_pk_bf16_f32 v48, v16, v17
  s_waitcnt vmcnt(18)
  v_mfma_f32_32x32x16_bf16 v[32:47], a[212:215], a[148:151], v[32:47]
  buffer_load_dwordx4 a[12:15], v1, s[8:11], s46 offen offset:3072
  v_exp_f32 v20, v20
  v_exp_f32 v21, v21
  v_cvt_pk_bf16_f32 v49, v18, v19
  v_mfma_f32_32x32x16_bf16 a[112:127], v[184:187], v[56:59], a[112:127]
  v_exp_f32 v22, v22
  v_exp_f32 v23, v23
  v_cvt_pk_bf16_f32 v50, v20, v21
  s_waitcnt vmcnt(17)
  v_mfma_f32_32x32x16_bf16 v[32:47], a[216:219], a[152:155], v[32:47]
  v_exp_f32 v24, v24
  v_exp_f32 v25, v25
  v_cvt_pk_bf16_f32 v51, v22, v23
  v_mfma_f32_32x32x16_bf16 a[96:111], v[180:183], v[60:63], a[96:111]
  v_exp_f32 v26, v26
  v_exp_f32 v27, v27
  v_cvt_pk_bf16_f32 v52, v24, v25
  s_waitcnt vmcnt(15)
  v_mfma_f32_32x32x16_bf16 v[32:47], a[220:223], a[156:159], v[32:47]
  buffer_load_dwordx4 a[244:247], v1, s[4:7], s29 offen offset:1024
  v_exp_f32 v28, v28
  v_exp_f32 v29, v29
  v_cvt_pk_bf16_f32 v53, v26, v27
  v_mfma_f32_32x32x16_bf16 a[112:127], v[188:191], v[60:63], a[112:127]
  v_exp_f32 v216, v30
  v_exp_f32 v217, v31
  v_cvt_pk_bf16_f32 v54, v28, v29
  v_smfmac_f32_16x16x64_bf16 v[204:207], v[208:211], v[56:63], v218
  buffer_load_dwordx4 v[172:175], v2, s[4:7], s28 offen offset:3072
  s_addk_i32 s46, 0x1000
  v_mfma_f32_32x32x16_bf16 v[16:31], a[192:195], a[160:163], v[96:111]
  buffer_load_dwordx4 a[16:19], v1, s[8:11], s46 offen offset:0
  v_cvt_pk_bf16_f32 v55, v216, v217
  v_exp_f32 v32, v32
  v_exp_f32 v33, v33
  v_mfma_f32_32x32x16_bf16 a[32:47], v[128:131], v[48:51], a[32:47]
  v_exp_f32 v34, v34
  v_exp_f32 v35, v35
  v_cvt_pk_bf16_f32 v56, v32, v33
  v_mfma_f32_32x32x16_bf16 v[16:31], a[196:199], a[164:167], v[16:31]
  buffer_load_dwordx4 a[20:23], v1, s[8:11], s46 offen offset:1024
  v_exp_f32 v36, v36
  v_exp_f32 v37, v37
  v_cvt_pk_bf16_f32 v57, v34, v35
  v_mfma_f32_32x32x16_bf16 a[48:63], v[136:139], v[48:51], a[48:63]
  buffer_store_dwordx4 v[252:255], v1, s[8:11], s58 offen offset:0 sc1
  v_exp_f32 v38, v38
  v_exp_f32 v39, v39
  v_cvt_pk_bf16_f32 v58, v36, v37
  v_mfma_f32_32x32x16_bf16 v[16:31], a[200:203], a[168:171], v[16:31]
  v_exp_f32 v40, v40
  v_exp_f32 v41, v41
  v_cvt_pk_bf16_f32 v59, v38, v39
  v_mfma_f32_32x32x16_bf16 a[32:47], v[132:135], v[52:55], a[32:47]
  v_exp_f32 v42, v42
  v_exp_f32 v43, v43
  v_cvt_pk_bf16_f32 v60, v40, v41
  v_mfma_f32_32x32x16_bf16 v[16:31], a[204:207], a[172:175], v[16:31]
  buffer_load_dwordx4 a[248:251], v1, s[4:7], s29 offen offset:2048
  v_exp_f32 v44, v44
  v_exp_f32 v45, v45
  v_cvt_pk_bf16_f32 v61, v42, v43
  v_mfma_f32_32x32x16_bf16 a[48:63], v[140:143], v[52:55], a[48:63]
  v_exp_f32 v216, v46
  v_exp_f32 v217, v47
  v_cvt_pk_bf16_f32 v62, v44, v45
  v_smfmac_f32_16x16x64_bf16 v[196:199], v[208:211], v[48:55], v218
  buffer_load_dwordx4 v[176:179], v2, s[4:7], s29 offen offset:0
  s_waitcnt vmcnt(20)
  v_mfma_f32_32x32x16_bf16 v[32:47], a[224:227], a[144:147], v[80:95]
  buffer_load_dwordx4 a[24:27], v1, s[8:11], s46 offen offset:2048
  v_cvt_pk_bf16_f32 v63, v216, v217
  v_exp_f32 v16, v16
  v_exp_f32 v17, v17
  v_mfma_f32_32x32x16_bf16 a[32:47], v[144:147], v[56:59], a[32:47]
  v_exp_f32 v18, v18
  v_exp_f32 v19, v19
  v_cvt_pk_bf16_f32 v48, v16, v17
  s_waitcnt vmcnt(19)
  v_mfma_f32_32x32x16_bf16 v[32:47], a[228:231], a[148:151], v[32:47]
  buffer_load_dwordx4 a[28:31], v1, s[8:11], s46 offen offset:3072
  v_exp_f32 v20, v20
  v_exp_f32 v21, v21
  v_cvt_pk_bf16_f32 v49, v18, v19
  v_mfma_f32_32x32x16_bf16 a[48:63], v[152:155], v[56:59], a[48:63]
  buffer_store_dwordx4 v[252:255], v1, s[8:11], s58 offen offset:1024 sc1
  v_exp_f32 v22, v22
  v_exp_f32 v23, v23
  v_cvt_pk_bf16_f32 v50, v20, v21
  s_waitcnt vmcnt(19)
  v_mfma_f32_32x32x16_bf16 v[32:47], a[232:235], a[152:155], v[32:47]
  v_exp_f32 v24, v24
  v_exp_f32 v25, v25
  v_cvt_pk_bf16_f32 v51, v22, v23
  v_mfma_f32_32x32x16_bf16 a[32:47], v[148:151], v[60:63], a[32:47]
  v_exp_f32 v26, v26
  v_exp_f32 v27, v27
  v_cvt_pk_bf16_f32 v52, v24, v25
  s_waitcnt vmcnt(17)
  v_mfma_f32_32x32x16_bf16 v[32:47], a[236:239], a[156:159], v[32:47]
  buffer_load_dwordx4 a[252:255], v1, s[4:7], s29 offen offset:3072
  v_exp_f32 v28, v28
  v_exp_f32 v29, v29
  v_cvt_pk_bf16_f32 v53, v26, v27
  v_mfma_f32_32x32x16_bf16 a[48:63], v[156:159], v[60:63], a[48:63]
  v_exp_f32 v216, v30
  v_exp_f32 v217, v31
  v_cvt_pk_bf16_f32 v54, v28, v29
  v_smfmac_f32_16x16x64_bf16 v[196:199], v[208:211], v[56:63], v218
  buffer_load_dwordx4 v[180:183], v2, s[4:7], s29 offen offset:1024
  s_addk_i32 s46, 0x1000
  v_mfma_f32_32x32x16_bf16 v[16:31], a[208:211], a[160:163], v[96:111]
  buffer_load_dwordx4 a[144:147], v1, s[8:11], s46 offen offset:0
  v_cvt_pk_bf16_f32 v55, v216, v217
  v_exp_f32 v32, v32
  v_exp_f32 v33, v33
  v_mfma_f32_32x32x16_bf16 a[64:79], v[128:131], v[48:51], a[64:79]
  v_exp_f32 v34, v34
  v_exp_f32 v35, v35
  v_cvt_pk_bf16_f32 v56, v32, v33
  v_mfma_f32_32x32x16_bf16 v[16:31], a[212:215], a[164:167], v[16:31]
  buffer_load_dwordx4 a[148:151], v1, s[8:11], s46 offen offset:1024
  v_exp_f32 v36, v36
  v_exp_f32 v37, v37
  v_cvt_pk_bf16_f32 v57, v34, v35
  v_mfma_f32_32x32x16_bf16 a[80:95], v[136:139], v[48:51], a[80:95]
  buffer_store_dwordx4 v[252:255], v1, s[8:11], s58 offen offset:2048 sc1
  v_exp_f32 v38, v38
  v_exp_f32 v39, v39
  v_cvt_pk_bf16_f32 v58, v36, v37
  v_mfma_f32_32x32x16_bf16 v[16:31], a[216:219], a[168:171], v[16:31]
  buffer_load_dwordx4 a[152:155], v1, s[8:11], s46 offen offset:2048
  v_exp_f32 v40, v40
  v_exp_f32 v41, v41
  v_cvt_pk_bf16_f32 v59, v38, v39
  v_mfma_f32_32x32x16_bf16 a[64:79], v[132:135], v[52:55], a[64:79]
  v_exp_f32 v42, v42
  v_exp_f32 v43, v43
  v_cvt_pk_bf16_f32 v60, v40, v41
  v_mfma_f32_32x32x16_bf16 v[16:31], a[220:223], a[172:175], v[16:31]
  v_exp_f32 v44, v44
  v_exp_f32 v45, v45
  v_cvt_pk_bf16_f32 v61, v42, v43
  v_mfma_f32_32x32x16_bf16 a[80:95], v[140:143], v[52:55], a[80:95]
  v_exp_f32 v216, v46
  v_exp_f32 v217, v47
  v_cvt_pk_bf16_f32 v62, v44, v45
  v_smfmac_f32_16x16x64_bf16 v[200:203], v[208:211], v[48:55], v218
  buffer_load_dwordx4 v[184:187], v2, s[4:7], s29 offen offset:2048
  v_mfma_f32_32x32x16_bf16 v[32:47], a[192:195], a[176:179], v[112:127]
  buffer_load_dwordx4 a[156:159], v1, s[8:11], s46 offen offset:3072
  v_cvt_pk_bf16_f32 v63, v216, v217
  v_exp_f32 v16, v16
  v_exp_f32 v17, v17
  v_mfma_f32_32x32x16_bf16 a[32:47], v[160:163], v[56:59], a[32:47]
  v_exp_f32 v18, v18
  v_exp_f32 v19, v19
  v_cvt_pk_bf16_f32 v48, v16, v17
  v_mfma_f32_32x32x16_bf16 v[32:47], a[196:199], a[180:183], v[32:47]
  v_exp_f32 v20, v20
  v_exp_f32 v21, v21
  v_cvt_pk_bf16_f32 v49, v18, v19
  s_waitcnt vmcnt(20)
  v_mfma_f32_32x32x16_bf16 a[48:63], v[168:171], v[56:59], a[48:63]
  buffer_store_dwordx4 v[252:255], v1, s[8:11], s58 offen offset:3072 sc1
  v_exp_f32 v22, v22
  v_exp_f32 v23, v23
  v_cvt_pk_bf16_f32 v50, v20, v21
  v_mfma_f32_32x32x16_bf16 v[32:47], a[200:203], a[184:187], v[32:47]
  v_exp_f32 v24, v24
  v_exp_f32 v25, v25
  v_cvt_pk_bf16_f32 v51, v22, v23
  v_mfma_f32_32x32x16_bf16 a[32:47], v[164:167], v[60:63], a[32:47]
  v_exp_f32 v26, v26
  v_exp_f32 v27, v27
  v_cvt_pk_bf16_f32 v52, v24, v25
  v_mfma_f32_32x32x16_bf16 v[32:47], a[204:207], a[188:191], v[32:47]
  v_exp_f32 v28, v28
  v_exp_f32 v29, v29
  v_cvt_pk_bf16_f32 v53, v26, v27
  s_waitcnt vmcnt(17)
  v_mfma_f32_32x32x16_bf16 a[48:63], v[172:175], v[60:63], a[48:63]
  v_exp_f32 v216, v30
  v_exp_f32 v217, v31
  v_cvt_pk_bf16_f32 v54, v28, v29
  v_smfmac_f32_16x16x64_bf16 v[196:199], v[208:211], v[56:63], v218
  buffer_load_dwordx4 v[188:191], v2, s[4:7], s29 offen offset:3072
  buffer_load_dword v219, v7, s[8:11], s13 offen sc1
  v_mfma_f32_32x32x16_bf16 v[16:31], a[224:227], a[160:163], v[96:111]
  v_cvt_pk_bf16_f32 v55, v216, v217
  v_exp_f32 v32, v32
  v_exp_f32 v33, v33
  v_mfma_f32_32x32x16_bf16 a[64:79], v[144:147], v[48:51], a[64:79]
  ds_write_b128 v3, a[32:35] offset:0
  v_exp_f32 v34, v34
  v_exp_f32 v35, v35
  v_cvt_pk_bf16_f32 v56, v32, v33
  v_mfma_f32_32x32x16_bf16 v[16:31], a[228:231], a[164:167], v[16:31]
  v_exp_f32 v36, v36
  v_exp_f32 v37, v37
  v_cvt_pk_bf16_f32 v57, v34, v35
  v_mfma_f32_32x32x16_bf16 a[80:95], v[152:155], v[48:51], a[80:95]
  v_exp_f32 v38, v38
  v_exp_f32 v39, v39
  v_cvt_pk_bf16_f32 v58, v36, v37
  v_mfma_f32_32x32x16_bf16 v[16:31], a[232:235], a[168:171], v[16:31]
  ds_write_b128 v3, a[36:39] offset:1024
  v_exp_f32 v40, v40
  v_exp_f32 v41, v41
  v_cvt_pk_bf16_f32 v59, v38, v39
  v_mfma_f32_32x32x16_bf16 a[64:79], v[148:151], v[52:55], a[64:79]
  v_exp_f32 v42, v42
  v_exp_f32 v43, v43
  v_cvt_pk_bf16_f32 v60, v40, v41
  v_mfma_f32_32x32x16_bf16 v[16:31], a[236:239], a[172:175], v[16:31]
  v_exp_f32 v44, v44
  v_exp_f32 v45, v45
  v_cvt_pk_bf16_f32 v61, v42, v43
  v_mfma_f32_32x32x16_bf16 a[80:95], v[156:159], v[52:55], a[80:95]
  ds_write_b128 v3, a[40:43] offset:2048
  v_exp_f32 v216, v46
  v_exp_f32 v217, v47
  v_cvt_pk_bf16_f32 v62, v44, v45
  v_smfmac_f32_16x16x64_bf16 v[200:203], v[208:211], v[48:55], v218
  s_addk_i32 s46, 0x1000
  v_mfma_f32_32x32x16_bf16 v[32:47], a[208:211], a[176:179], v[112:127]
  buffer_load_dwordx4 a[32:35], v1, s[8:11], s46 offen offset:0
  v_cvt_pk_bf16_f32 v63, v216, v217
  v_exp_f32 v16, v16
  v_exp_f32 v17, v17
  v_mfma_f32_32x32x16_bf16 a[96:111], v[128:131], v[56:59], a[96:111]
  ds_write_b128 v3, a[44:47] offset:3072
  v_exp_f32 v18, v18
  v_exp_f32 v19, v19
  v_cvt_pk_bf16_f32 v48, v16, v17
  v_mfma_f32_32x32x16_bf16 v[32:47], a[212:215], a[180:183], v[32:47]
  buffer_load_dwordx4 a[36:39], v1, s[8:11], s46 offen offset:1024
  v_exp_f32 v20, v20
  v_exp_f32 v21, v21
  v_cvt_pk_bf16_f32 v49, v18, v19
  v_mfma_f32_32x32x16_bf16 a[112:127], v[136:139], v[56:59], a[112:127]
  v_exp_f32 v22, v22
  v_exp_f32 v23, v23
  v_cvt_pk_bf16_f32 v50, v20, v21
  v_mfma_f32_32x32x16_bf16 v[32:47], a[216:219], a[184:187], v[32:47]
  ds_write_b128 v3, a[48:51] offset:4096
  buffer_load_dwordx4 a[40:43], v1, s[8:11], s46 offen offset:2048
  v_exp_f32 v24, v24
  v_exp_f32 v25, v25
  v_cvt_pk_bf16_f32 v51, v22, v23
  v_mfma_f32_32x32x16_bf16 a[96:111], v[132:135], v[60:63], a[96:111]
  v_exp_f32 v26, v26
  v_exp_f32 v27, v27
  v_cvt_pk_bf16_f32 v52, v24, v25
  v_mfma_f32_32x32x16_bf16 v[32:47], a[220:223], a[188:191], v[32:47]
  v_exp_f32 v28, v28
  v_exp_f32 v29, v29
  v_cvt_pk_bf16_f32 v53, v26, v27
  v_mfma_f32_32x32x16_bf16 a[112:127], v[140:143], v[60:63], a[112:127]
  ds_write_b128 v3, a[52:55] offset:5120
  v_exp_f32 v216, v30
  v_exp_f32 v217, v31
  v_cvt_pk_bf16_f32 v54, v28, v29
  v_smfmac_f32_16x16x64_bf16 v[204:207], v[208:211], v[56:63], v218
  v_mfma_f32_32x32x16_bf16 v[16:31], a[224:227], a[176:179], v[112:127]
  buffer_load_dwordx4 a[160:163], v1, s[8:11], s46 offen offset:3072
  v_cvt_pk_bf16_f32 v55, v216, v217
  v_exp_f32 v32, v32
  v_exp_f32 v33, v33
  v_mfma_f32_32x32x16_bf16 a[64:79], v[160:163], v[48:51], a[64:79]
  ds_write_b128 v3, a[56:59] offset:6144
  v_exp_f32 v34, v34
  v_exp_f32 v35, v35
  v_cvt_pk_bf16_f32 v56, v32, v33
  s_addk_i32 s46, 0x1000
  v_mfma_f32_32x32x16_bf16 v[16:31], a[228:231], a[180:183], v[16:31]
  buffer_load_dwordx4 a[164:167], v1, s[8:11], s46 offen offset:0
  v_exp_f32 v36, v36
  v_exp_f32 v37, v37
  v_cvt_pk_bf16_f32 v57, v34, v35
  v_mfma_f32_32x32x16_bf16 a[80:95], v[168:171], v[48:51], a[80:95]
  v_exp_f32 v38, v38
  v_exp_f32 v39, v39
  v_cvt_pk_bf16_f32 v58, v36, v37
  v_mfma_f32_32x32x16_bf16 v[16:31], a[232:235], a[184:187], v[16:31]
  ds_write_b128 v3, a[60:63] offset:7168
  buffer_load_dwordx4 a[168:171], v1, s[8:11], s46 offen offset:1024
  v_exp_f32 v40, v40
  v_exp_f32 v41, v41
  v_cvt_pk_bf16_f32 v59, v38, v39
  v_mfma_f32_32x32x16_bf16 a[64:79], v[164:167], v[52:55], a[64:79]
  v_exp_f32 v42, v42
  v_exp_f32 v43, v43
  v_cvt_pk_bf16_f32 v60, v40, v41
  v_mfma_f32_32x32x16_bf16 v[16:31], a[236:239], a[188:191], v[16:31]
  v_exp_f32 v44, v44
  v_exp_f32 v45, v45
  v_cvt_pk_bf16_f32 v61, v42, v43
  v_mfma_f32_32x32x16_bf16 a[80:95], v[172:175], v[52:55], a[80:95]
  ds_write_b64 v3, v[196:197] offset:8192
  v_exp_f32 v216, v46
  v_exp_f32 v217, v47
  v_cvt_pk_bf16_f32 v62, v44, v45
  v_smfmac_f32_16x16x64_bf16 v[200:203], v[208:211], v[48:55], v218
  v_mfma_f32_32x32x16_bf16 v[32:47], a[192:195], a[128:131], v[64:79]
  buffer_load_dwordx4 a[172:175], v1, s[8:11], s46 offen offset:2048
  v_cvt_pk_bf16_f32 v63, v216, v217
  v_exp_f32 v16, v16
  v_exp_f32 v17, v17
  v_mfma_f32_32x32x16_bf16 a[96:111], v[144:147], v[56:59], a[96:111]
  ds_write_b128 v4, a[64:67] offset:0
  v_exp_f32 v18, v18
  v_exp_f32 v19, v19
  v_cvt_pk_bf16_f32 v48, v16, v17
  v_mfma_f32_32x32x16_bf16 v[32:47], a[196:199], a[132:135], v[32:47]
  buffer_load_dwordx4 a[44:47], v1, s[8:11], s46 offen offset:3072
  v_exp_f32 v20, v20
  v_exp_f32 v21, v21
  v_cvt_pk_bf16_f32 v49, v18, v19
  v_mfma_f32_32x32x16_bf16 a[112:127], v[152:155], v[56:59], a[112:127]
  ds_write_b128 v4, a[68:71] offset:1024
  v_exp_f32 v22, v22
  v_exp_f32 v23, v23
  v_cvt_pk_bf16_f32 v50, v20, v21
  s_addk_i32 s46, 0x1000
  v_mfma_f32_32x32x16_bf16 v[32:47], a[200:203], a[136:139], v[32:47]
  buffer_load_dwordx4 a[48:51], v1, s[8:11], s46 offen offset:0
  v_exp_f32 v24, v24
  v_exp_f32 v25, v25
  v_cvt_pk_bf16_f32 v51, v22, v23
  v_mfma_f32_32x32x16_bf16 a[96:111], v[148:151], v[60:63], a[96:111]
  ds_write_b128 v4, a[72:75] offset:2048
  v_exp_f32 v26, v26
  v_exp_f32 v27, v27
  v_cvt_pk_bf16_f32 v52, v24, v25
  v_mfma_f32_32x32x16_bf16 v[32:47], a[204:207], a[140:143], v[32:47]
  ds_write_b128 v4, a[76:79] offset:3072
  v_exp_f32 v28, v28
  v_exp_f32 v29, v29
  v_cvt_pk_bf16_f32 v53, v26, v27
  v_mfma_f32_32x32x16_bf16 a[112:127], v[156:159], v[60:63], a[112:127]
  v_exp_f32 v216, v30
  v_exp_f32 v217, v31
  v_cvt_pk_bf16_f32 v54, v28, v29
  v_smfmac_f32_16x16x64_bf16 v[204:207], v[208:211], v[56:63], v218
  ds_write_b128 v4, a[80:83] offset:4096
  v_mfma_f32_32x32x16_bf16 v[16:31], a[208:211], a[128:131], v[64:79]
  ds_write_b128 v4, a[84:87] offset:5120
  buffer_load_dwordx4 a[52:55], v1, s[8:11], s46 offen offset:1024
  v_cvt_pk_bf16_f32 v55, v216, v217
  v_exp_f32 v32, v32
  v_exp_f32 v33, v33
  v_mfma_f32_32x32x16_bf16 a[96:111], v[160:163], v[48:51], a[96:111]
  v_exp_f32 v34, v34
  v_exp_f32 v35, v35
  v_cvt_pk_bf16_f32 v56, v32, v33
  v_mfma_f32_32x32x16_bf16 v[16:31], a[212:215], a[132:135], v[16:31]
  ds_write_b128 v4, a[88:91] offset:6144
  buffer_load_dwordx4 a[56:59], v1, s[8:11], s46 offen offset:2048
  v_exp_f32 v36, v36
  v_exp_f32 v37, v37
  v_cvt_pk_bf16_f32 v57, v34, v35
  v_mfma_f32_32x32x16_bf16 a[112:127], v[168:171], v[48:51], a[112:127]
  v_exp_f32 v38, v38
  v_exp_f32 v39, v39
  v_cvt_pk_bf16_f32 v58, v36, v37
  v_mfma_f32_32x32x16_bf16 v[16:31], a[216:219], a[136:139], v[16:31]
  ds_write_b128 v4, a[92:95] offset:7168
  buffer_load_dwordx4 a[60:63], v1, s[8:11], s46 offen offset:3072
  v_exp_f32 v40, v40
  v_exp_f32 v41, v41
  v_cvt_pk_bf16_f32 v59, v38, v39
  v_mfma_f32_32x32x16_bf16 a[96:111], v[164:167], v[52:55], a[96:111]
  v_exp_f32 v42, v42
  v_exp_f32 v43, v43
  v_cvt_pk_bf16_f32 v60, v40, v41
  v_mfma_f32_32x32x16_bf16 v[16:31], a[220:223], a[140:143], v[16:31]
  ds_write_b64 v4, v[200:201] offset:8192
  v_exp_f32 v44, v44
  v_exp_f32 v45, v45
  v_cvt_pk_bf16_f32 v61, v42, v43
  v_mfma_f32_32x32x16_bf16 a[112:127], v[172:175], v[52:55], a[112:127]
  v_exp_f32 v216, v46
  v_exp_f32 v217, v47
  v_cvt_pk_bf16_f32 v62, v44, v45
  v_smfmac_f32_16x16x64_bf16 v[204:207], v[208:211], v[48:55], v218
  s_addk_i32 s46, 0x1000
  v_mfma_f32_32x32x16_bf16 v[32:47], a[224:227], a[128:131], v[64:79]
  buffer_load_dwordx4 a[176:179], v1, s[8:11], s46 offen offset:0
  v_cvt_pk_bf16_f32 v63, v216, v217
  v_exp_f32 v16, v16
  v_exp_f32 v17, v17
  v_mfma_f32_32x32x16_bf16 v[220:235], v[128:131], v[56:59], v[220:235]
  ds_write_b128 v5, a[96:99] offset:0
  v_exp_f32 v18, v18
  v_exp_f32 v19, v19
  v_cvt_pk_bf16_f32 v48, v16, v17
  v_mfma_f32_32x32x16_bf16 v[32:47], a[228:231], a[132:135], v[32:47]
  buffer_load_dwordx4 a[180:183], v1, s[8:11], s46 offen offset:1024
  v_exp_f32 v20, v20
  v_exp_f32 v21, v21
  v_cvt_pk_bf16_f32 v49, v18, v19
  v_mfma_f32_32x32x16_bf16 v[236:251], v[136:139], v[56:59], v[236:251]
  ds_write_b128 v5, a[100:103] offset:1024
  v_exp_f32 v22, v22
  v_exp_f32 v23, v23
  v_cvt_pk_bf16_f32 v50, v20, v21
  v_mfma_f32_32x32x16_bf16 v[32:47], a[232:235], a[136:139], v[32:47]
  buffer_load_dwordx4 a[184:187], v1, s[8:11], s46 offen offset:2048
  v_exp_f32 v24, v24
  v_exp_f32 v25, v25
  v_cvt_pk_bf16_f32 v51, v22, v23
  v_mfma_f32_32x32x16_bf16 v[220:235], v[132:135], v[60:63], v[220:235]
  ds_write_b128 v5, a[104:107] offset:2048
  v_exp_f32 v26, v26
  v_exp_f32 v27, v27
  v_cvt_pk_bf16_f32 v52, v24, v25
  v_mfma_f32_32x32x16_bf16 v[32:47], a[236:239], a[140:143], v[32:47]
  ds_write_b128 v5, a[108:111] offset:3072
  v_exp_f32 v28, v28
  v_exp_f32 v29, v29
  v_cvt_pk_bf16_f32 v53, v26, v27
  v_mfma_f32_32x32x16_bf16 v[236:251], v[140:143], v[60:63], v[236:251]
  v_exp_f32 v216, v30
  v_exp_f32 v217, v31
  v_cvt_pk_bf16_f32 v54, v28, v29
  v_smfmac_f32_16x16x64_bf16 v[192:195], v[208:211], v[56:63], v218
  ds_write_b128 v5, a[112:115] offset:4096
  v_mfma_f32_32x32x16_bf16 v[16:31], a[240:243], a[128:131], v[64:79]
  ds_write_b128 v5, a[116:119] offset:5120
  buffer_load_dwordx4 a[188:191], v1, s[8:11], s46 offen offset:3072
  v_cvt_pk_bf16_f32 v55, v216, v217
  v_exp_f32 v32, v32
  v_exp_f32 v33, v33
  v_mfma_f32_32x32x16_bf16 v[220:235], v[144:147], v[48:51], v[220:235]
  v_exp_f32 v34, v34
  v_exp_f32 v35, v35
  v_cvt_pk_bf16_f32 v56, v32, v33
  s_addk_i32 s46, 0x1000
  v_mfma_f32_32x32x16_bf16 v[16:31], a[244:247], a[132:135], v[16:31]
  ds_write_b128 v5, a[120:123] offset:6144
  buffer_load_dwordx4 a[64:67], v1, s[8:11], s46 offen offset:0
  v_exp_f32 v36, v36
  v_exp_f32 v37, v37
  v_cvt_pk_bf16_f32 v57, v34, v35
  v_mfma_f32_32x32x16_bf16 v[236:251], v[152:155], v[48:51], v[236:251]
  v_exp_f32 v38, v38
  v_exp_f32 v39, v39
  v_cvt_pk_bf16_f32 v58, v36, v37
  s_waitcnt vmcnt(32)
  v_mfma_f32_32x32x16_bf16 v[16:31], a[248:251], a[136:139], v[16:31]
  ds_write_b128 v5, a[124:127] offset:7168
  buffer_load_dwordx4 a[68:71], v1, s[8:11], s46 offen offset:1024
  v_exp_f32 v40, v40
  v_exp_f32 v41, v41
  v_cvt_pk_bf16_f32 v59, v38, v39
  v_mfma_f32_32x32x16_bf16 v[220:235], v[148:151], v[52:55], v[220:235]
  v_exp_f32 v42, v42
  v_exp_f32 v43, v43
  v_cvt_pk_bf16_f32 v60, v40, v41
  s_waitcnt vmcnt(28)
  v_mfma_f32_32x32x16_bf16 v[16:31], a[252:255], a[140:143], v[16:31]
  ds_write_b64 v5, v[204:205] offset:8192
  v_exp_f32 v44, v44
  v_exp_f32 v45, v45
  v_cvt_pk_bf16_f32 v61, v42, v43
  v_mfma_f32_32x32x16_bf16 v[236:251], v[156:159], v[52:55], v[236:251]
  v_exp_f32 v216, v46
  v_exp_f32 v217, v47
  v_cvt_pk_bf16_f32 v62, v44, v45
  v_smfmac_f32_16x16x64_bf16 v[192:195], v[208:211], v[48:55], v218
  buffer_load_dwordx4 a[72:75], v1, s[8:11], s46 offen offset:2048
  v_cvt_pk_bf16_f32 v63, v216, v217
  s_nop 0
  v_exp_f32 v16, v16
  v_exp_f32 v17, v17
  v_mfma_f32_32x32x16_bf16 v[220:235], v[160:163], v[56:59], v[220:235]
  v_exp_f32 v18, v18
  v_exp_f32 v19, v19
  v_cvt_pk_bf16_f32 v48, v16, v17
  s_waitcnt lgkmcnt(0)
  s_waitcnt vmcnt(21)
  s_barrier
  ds_read_b64 v[8:9], v6 offset:8192
  ds_read_b64 v[10:11], v6 offset:17408
  ds_read_b64 v[12:13], v6 offset:26624
  ds_read_b128 v[80:83], v6 offset:0
  v_exp_f32 v20, v20
  v_exp_f32 v21, v21
  v_cvt_pk_bf16_f32 v49, v18, v19
  ds_read_b128 v[112:115], v6 offset:9216
  ds_read_b128 v[144:147], v6 offset:18432
  ds_read_b128 v[84:87], v6 offset:1024
  ds_read_b128 v[116:119], v6 offset:10240
  buffer_load_dwordx4 a[76:79], v1, s[8:11], s46 offen offset:3072
  v_mfma_f32_32x32x16_bf16 v[236:251], v[168:171], v[56:59], v[236:251]
  ds_read_b128 v[148:151], v6 offset:19456
  ds_read_b128 v[88:91], v6 offset:2048
  ds_read_b128 v[120:123], v6 offset:11264
  ds_read_b128 v[152:155], v6 offset:20480
  ds_read_b128 v[92:95], v6 offset:3072
  ds_read_b128 v[124:127], v6 offset:12288
  ds_read_b128 v[156:159], v6 offset:21504
  ds_read_b128 v[96:99], v6 offset:4096
  v_exp_f32 v22, v22
  v_exp_f32 v23, v23
  v_cvt_pk_bf16_f32 v50, v20, v21
  v_exp_f32 v24, v24
  v_exp_f32 v25, v25
  v_cvt_pk_bf16_f32 v51, v22, v23
  v_mfma_f32_32x32x16_bf16 v[220:235], v[164:167], v[60:63], v[220:235]
  ds_read_b128 v[128:131], v6 offset:13312
  ds_read_b128 v[196:199], v6 offset:22528
  ds_read_b128 v[100:103], v6 offset:5120
  ds_read_b128 v[132:135], v6 offset:14336
  ds_read_b128 v[200:203], v6 offset:23552
  ds_read_b128 v[104:107], v6 offset:6144
  ds_read_b128 v[136:139], v6 offset:15360
  ds_read_b128 v[204:207], v6 offset:24576
  v_exp_f32 v26, v26
  v_exp_f32 v27, v27
  v_cvt_pk_bf16_f32 v52, v24, v25
  v_exp_f32 v28, v28
  v_exp_f32 v29, v29
  v_cvt_pk_bf16_f32 v53, v26, v27
  v_mfma_f32_32x32x16_bf16 v[236:251], v[172:175], v[60:63], v[236:251]
  ds_read_b128 v[108:111], v6 offset:7168
  ds_read_b128 v[140:143], v6 offset:16384
  ds_read_b128 v[252:255], v6 offset:25600
  v_exp_f32 v216, v30
  v_exp_f32 v217, v31
  v_cvt_pk_bf16_f32 v54, v28, v29
  v_smfmac_f32_16x16x64_bf16 v[192:195], v[208:211], v[56:63], v218
  buffer_load_dwordx4 v[160:163], v1, s[8:11], s57 offen offset:0
  buffer_load_dwordx4 v[164:167], v1, s[8:11], s57 offen offset:1024
  buffer_load_dwordx4 v[168:171], v1, s[8:11], s57 offen offset:2048
  buffer_load_dwordx4 v[172:175], v1, s[8:11], s57 offen offset:3072
  v_cvt_pk_bf16_f32 v55, v216, v217
  v_mfma_f32_32x32x16_bf16 v[220:235], v[176:179], v[48:51], v[220:235]
  s_waitcnt lgkmcnt(15)
  v_pk_add_f32 v[8:9], v[8:9], v[10:11]
  s_waitcnt lgkmcnt(15)
  v_pk_add_f32 v[8:9], v[8:9], v[12:13]
  s_waitcnt lgkmcnt(15)
  v_pk_add_f32 v[80:81], v[80:81], v[112:113]
  v_pk_add_f32 v[82:83], v[82:83], v[114:115]
  s_waitcnt lgkmcnt(15)
  v_pk_add_f32 v[80:81], v[80:81], v[144:145]
  v_pk_add_f32 v[82:83], v[82:83], v[146:147]
  v_mfma_f32_32x32x16_bf16 v[236:251], v[184:187], v[48:51], v[236:251]
  s_waitcnt lgkmcnt(15)
  v_pk_add_f32 v[84:85], v[84:85], v[116:117]
  v_pk_add_f32 v[86:87], v[86:87], v[118:119]
  s_waitcnt lgkmcnt(15)
  v_pk_add_f32 v[84:85], v[84:85], v[148:149]
  v_pk_add_f32 v[86:87], v[86:87], v[150:151]
  s_waitcnt lgkmcnt(15)
  v_pk_add_f32 v[88:89], v[88:89], v[120:121]
  v_pk_add_f32 v[90:91], v[90:91], v[122:123]
  s_waitcnt lgkmcnt(15)
  v_pk_add_f32 v[88:89], v[88:89], v[152:153]
  v_pk_add_f32 v[90:91], v[90:91], v[154:155]
  v_mfma_f32_32x32x16_bf16 v[220:235], v[180:183], v[52:55], v[220:235]
  s_waitcnt lgkmcnt(13)
  v_pk_add_f32 v[92:93], v[92:93], v[124:125]
  v_pk_add_f32 v[94:95], v[94:95], v[126:127]
  s_waitcnt lgkmcnt(12)
  v_pk_add_f32 v[92:93], v[92:93], v[156:157]
  v_pk_add_f32 v[94:95], v[94:95], v[158:159]
  s_waitcnt lgkmcnt(10)
  v_pk_add_f32 v[96:97], v[96:97], v[128:129]
  v_pk_add_f32 v[98:99], v[98:99], v[130:131]
  s_waitcnt lgkmcnt(9)
  v_pk_add_f32 v[96:97], v[96:97], v[196:197]
  v_pk_add_f32 v[98:99], v[98:99], v[198:199]
  s_waitcnt vmcnt(25)
  v_mfma_f32_32x32x16_bf16 v[236:251], v[188:191], v[52:55], v[236:251]
  s_waitcnt lgkmcnt(7)
  v_pk_add_f32 v[100:101], v[100:101], v[132:133]
  v_pk_add_f32 v[102:103], v[102:103], v[134:135]
  s_waitcnt lgkmcnt(6)
  v_pk_add_f32 v[100:101], v[100:101], v[200:201]
  v_pk_add_f32 v[102:103], v[102:103], v[202:203]
  v_smfmac_f32_16x16x64_bf16 v[192:195], v[208:211], v[48:55], v218
  s_waitcnt lgkmcnt(4)
  v_pk_add_f32 v[104:105], v[104:105], v[136:137]
  v_pk_add_f32 v[106:107], v[106:107], v[138:139]
  s_waitcnt lgkmcnt(3)
  v_pk_add_f32 v[104:105], v[104:105], v[204:205]
  v_pk_add_f32 v[106:107], v[106:107], v[206:207]
  s_waitcnt lgkmcnt(1)
  v_pk_add_f32 v[108:109], v[108:109], v[140:141]
  v_pk_add_f32 v[110:111], v[110:111], v[142:143]
  s_waitcnt lgkmcnt(0)
  v_pk_add_f32 v[108:109], v[108:109], v[252:253]
  v_pk_add_f32 v[110:111], v[110:111], v[254:255]
  s_mov_b32 s32, 0x4e800000
  s_lshl_b32 s34, s26, 2
  s_add_u32 s34, s34, s24
  s_lshr_b32 s33, s25, 2
  s_mul_i32 s33, s33, 125
  s_add_u32 s33, s34, s33
  s_lshl_b32 s33, s33, 14
  s_and_b32 s35, s25, 3
  s_lshl_b32 s35, s35, 12
  s_add_u32 s33, s33, s35
  s_add_u32 s33, s33, 0x1000000
  v_pk_add_f32 v[220:221], v[220:221], v[80:81]
  v_pk_add_f32 v[222:223], v[222:223], v[82:83]
  v_pk_add_f32 v[224:225], v[224:225], v[84:85]
  v_pk_add_f32 v[226:227], v[226:227], v[86:87]
  v_pk_add_f32 v[228:229], v[228:229], v[88:89]
  v_pk_add_f32 v[230:231], v[230:231], v[90:91]
  v_pk_add_f32 v[232:233], v[232:233], v[92:93]
  v_pk_add_f32 v[234:235], v[234:235], v[94:95]
  v_pk_add_f32 v[8:9], v[8:9], v[192:193]
  v_pk_add_f32 v[236:237], v[236:237], v[96:97]
  v_pk_add_f32 v[238:239], v[238:239], v[98:99]
  v_add_f32 v8, v8, v9
  v_pk_add_f32 v[240:241], v[240:241], v[100:101]
  v_pk_add_f32 v[242:243], v[242:243], v[102:103]
  v_cmp_nle_f32 vcc, v8, s32
  v_pk_add_f32 v[244:245], v[244:245], v[104:105]
  v_pk_add_f32 v[246:247], v[246:247], v[106:107]
  v_pk_add_f32 v[248:249], v[248:249], v[108:109]
  v_pk_add_f32 v[250:251], v[250:251], v[110:111]
  s_cbranch_vccnz B_fallback
B_fin:
  v_rcp_f32 v8, v8
  s_waitcnt vmcnt(24)
  v_cmp_ne_u32 vcc, -1, v219
  s_nop 3
  s_cbranch_vccnz B_gate
B_open:
  v_mul_f32 v8, 0xc0596d27, v8
  v_pk_mul_f32 v[220:221], v[220:221], v[8:9] op_sel_hi:[1,0]
  v_pk_mul_f32 v[224:225], v[224:225], v[8:9] op_sel_hi:[1,0]
  v_pk_mul_f32 v[228:229], v[228:229], v[8:9] op_sel_hi:[1,0]
  v_pk_mul_f32 v[232:233], v[232:233], v[8:9] op_sel_hi:[1,0]
  v_pk_mul_f32 v[236:237], v[236:237], v[8:9] op_sel_hi:[1,0]
  v_pk_mul_f32 v[240:241], v[240:241], v[8:9] op_sel_hi:[1,0]
  v_pk_mul_f32 v[244:245], v[244:245], v[8:9] op_sel_hi:[1,0]
  v_pk_mul_f32 v[248:249], v[248:249], v[8:9] op_sel_hi:[1,0]
  v_cvt_pk_bf16_f32 v16, v220, v224
  v_cvt_pk_bf16_f32 v17, v228, v232
  v_cvt_pk_bf16_f32 v18, v236, v240
  v_cvt_pk_bf16_f32 v19, v244, v248
  buffer_store_dwordx4 v[16:19], v14, s[8:11], s33 offen offset:0 sc1
  v_cvt_pk_bf16_f32 v20, v221, v225
  v_cvt_pk_bf16_f32 v21, v229, v233
  v_cvt_pk_bf16_f32 v22, v237, v241
  v_cvt_pk_bf16_f32 v23, v245, v249
  buffer_store_dwordx4 v[20:23], v14, s[8:11], s33 offen offset:1024 sc1
  v_pk_mul_f32 v[222:223], v[222:223], v[8:9] op_sel_hi:[1,0]
  v_pk_mul_f32 v[226:227], v[226:227], v[8:9] op_sel_hi:[1,0]
  v_pk_mul_f32 v[230:231], v[230:231], v[8:9] op_sel_hi:[1,0]
  v_pk_mul_f32 v[234:235], v[234:235], v[8:9] op_sel_hi:[1,0]
  v_pk_mul_f32 v[238:239], v[238:239], v[8:9] op_sel_hi:[1,0]
  v_pk_mul_f32 v[242:243], v[242:243], v[8:9] op_sel_hi:[1,0]
  v_pk_mul_f32 v[246:247], v[246:247], v[8:9] op_sel_hi:[1,0]
  v_pk_mul_f32 v[250:251], v[250:251], v[8:9] op_sel_hi:[1,0]
  v_cvt_pk_bf16_f32 v24, v222, v226
  v_cvt_pk_bf16_f32 v25, v230, v234
  v_cvt_pk_bf16_f32 v26, v238, v242
  v_cvt_pk_bf16_f32 v27, v246, v250
  buffer_store_dwordx4 v[24:27], v14, s[8:11], s33 offen offset:2048 sc1
  v_cvt_pk_bf16_f32 v28, v223, v227
  v_cvt_pk_bf16_f32 v29, v231, v235
  v_cvt_pk_bf16_f32 v30, v239, v243
  v_cvt_pk_bf16_f32 v31, v247, v251
  buffer_store_dwordx4 v[28:31], v14, s[8:11], s33 offen offset:3072 sc1
B_done:
  s_barrier
  v_and_b32 v32, 31, v0
  v_lshrrev_b32 v33, 5, v0
  s_lshl_b32 s28, s26, 2
  s_and_b32 s29, s25, 3
  s_add_u32 s28, s28, s29
  s_mov_b32 s35, 0x80000000
  s_cmp_eq_u32 s28, 0
  s_cselect_b32 s30, s35, 0
  s_cmp_eq_u32 s28, 127
  s_cselect_b32 s31, s35, 0
  s_cmp_eq_u32 s28, 124
  s_cselect_b32 s61, 0, -1
  v_add_u32 v62, s30, v1
  v_add_u32 v60, s31, v1
  s_add_u32 s30, s30, 0x400
  s_add_u32 s31, s31, 32384
  v_mov_b32 v61, s35
  v_mov_b32 v36, s31
  v_cmp_lt_u32 vcc, 23, v32
  s_nop 1
  v_cndmask_b32 v61, v61, v36, vcc
  v_mov_b32 v36, s30
  v_cmp_gt_u32 vcc, 8, v32
  s_nop 1
  v_cndmask_b32 v61, v61, v36, vcc
  v_lshl_add_u32 v61, v32, 4, v61
  v_lshl_add_u32 v61, v33, 7, v61
  v_mov_b32 v56, -1
  v_mov_b32 v57, -1
  v_mov_b32 v58, -1
  v_mov_b32 v59, -1
  s_mov_b32 s25, 0xffff0000
  s_lshl_b32 s28, s24, 12
  v_add_u32 v5, s28, v1
  v_cmp_gt_u32 vcc, 8, v32
  s_mov_b32 s12, s48
  s_mov_b32 s13, s49
  s_mov_b32 s14, 0x1e00
  s_mov_b32 s15, 0x20000
  s_mov_b32 s16, s50
  s_mov_b32 s17, s51
  s_mov_b32 s18, 0x3e8000
  s_mov_b32 s19, 0x20000
  v_mul_u32_u24 v4, 48, v32
  v_add_u32 v4, 102656, v4
  s_lshl_b32 s28, s24, 3
  v_lshl_add_u32 v3, v33, 2, v4
  v_add_u32 v3, s28, v3
  s_mul_i32 s28, s24, 13056
  s_add_u32 s28, s28, 32768
  v_mul_u32_u24 v36, 272, v32
  v_lshl_add_u32 v36, v33, 7, v36
  v_add_u32 v36, s28, v36
  v_add_u32 v6, 2176, v36
  v_and_b32 v36, 7, v0
  v_mul_u32_u24 v36, 272, v36
  v_bfe_u32 v37, v0, 3, 1
  v_lshl_add_u32 v36, v37, 7, v36
  v_lshrrev_b32 v37, 4, v0
  v_lshl_add_u32 v36, v37, 5, v36
  v_add_u32 v7, s28, v36
  v_bfe_u32 v36, v0, 1, 3
  v_lshlrev_b32 v36, 5, v36
  v_and_b32 v38, 1, v0
  v_lshl_add_u32 v36, v38, 3, v36
  v_lshrrev_b32 v37, 4, v0
  v_mul_u32_u24 v8, 2176, v37
  v_add_u32 v8, v8, v36
  s_add_u32 s28, s28, 272
  v_add_u32 v8, s28, v8
  s_lshl_b32 s28, s24, 12
  s_add_u32 s28, s28, 108800
  v_add_u32 v63, s28, v36
  v_lshl_add_u32 v39, v0, 5, s28
  v_bfe_u32 v36, v0, 1, 2
  v_mul_u32_u24 v36, 1104, v36
  v_lshl_add_u32 v36, v37, 7, v36
  v_lshl_add_u32 v36, v38, 2, v36
  v_bfe_u32 v37, v0, 3, 1
  v_mul_u32_u24 v37, 576, v37
  v_add_u32 v36, v36, v37
  s_mul_i32 s28, s24, 4416
  s_add_u32 s28, s28, 84992
  v_add_u32 v9, s28, v36
  v_lshlrev_b32 v36, 6, v33
  v_add_u32 v10, v36, v1
  v_add_u32 v10, 84992, v10
  v_add_u32 v15, 32768, v1
  s_lshl_b32 s28, s24, 14
  v_add_u32 v11, s28, v15
  s_lshl_b32 s28, s24, 12
  v_and_b32 v36, 7, v0
  v_lshlrev_b32 v37, 2, v33
  v_xor_b32 v37, v37, v36
  v_lshlrev_b32 v37, 4, v37
  v_lshl_add_u32 v37, v32, 7, v37
  v_add_u32 v12, s28, v37
  v_lshrrev_b32 v37, 3, v0
  v_xor_b32 v38, v36, v37
  v_lshlrev_b32 v38, 4, v38
  v_lshl_add_u32 v38, v37, 7, v38
  v_add_u32 v13, s28, v38
  s_mov_b32 s36, 0xbfb8aa3b
  s_mov_b32 s39, 0x3727c5ac
  s_lshl_b32 s28, s24, 7
  v_lshlrev_b32 v38, 9, v37
  v_lshl_add_u32 v38, v36, 4, v38
  v_add_u32 v14, s28, v38
  v_add_u32 v24, 0x1000, v14
  s_waitcnt vmcnt(7)
  v_lshlrev_b32 v64, 16, v160
  v_and_b32 v68, s25, v160
  v_lshlrev_b32 v72, 16, v161
  v_and_b32 v76, s25, v161
  v_lshlrev_b32 v80, 16, v162
  v_and_b32 v84, s25, v162
  v_lshlrev_b32 v88, 16, v163
  v_and_b32 v92, s25, v163
  v_mul_f32 v64, s36, v64
  v_mul_f32 v68, s36, v68
  v_mul_f32 v72, s36, v72
  v_mul_f32 v76, s36, v76
  v_mul_f32 v80, s36, v80
  v_mul_f32 v84, s36, v84
  v_mul_f32 v88, s36, v88
  v_mul_f32 v92, s36, v92
  s_waitcnt vmcnt(6)
  v_lshlrev_b32 v65, 16, v164
  v_and_b32 v69, s25, v164
  v_lshlrev_b32 v73, 16, v165
  v_and_b32 v77, s25, v165
  v_lshlrev_b32 v81, 16, v166
  v_and_b32 v85, s25, v166
  v_lshlrev_b32 v89, 16, v167
  v_and_b32 v93, s25, v167
  v_mul_f32 v65, s36, v65
  v_mul_f32 v69, s36, v69
  v_mul_f32 v73, s36, v73
  v_mul_f32 v77, s36, v77
  v_mul_f32 v81, s36, v81
  v_mul_f32 v85, s36, v85
  v_mul_f32 v89, s36, v89
  v_mul_f32 v93, s36, v93
  s_waitcnt vmcnt(5)
  v_lshlrev_b32 v66, 16, v168
  v_and_b32 v70, s25, v168
  v_lshlrev_b32 v74, 16, v169
  v_and_b32 v78, s25, v169
  v_lshlrev_b32 v82, 16, v170
  v_and_b32 v86, s25, v170
  v_lshlrev_b32 v90, 16, v171
  v_and_b32 v94, s25, v171
  v_mul_f32 v66, s36, v66
  v_mul_f32 v70, s36, v70
  v_mul_f32 v74, s36, v74
  v_mul_f32 v78, s36, v78
  v_mul_f32 v82, s36, v82
  v_mul_f32 v86, s36, v86
  v_mul_f32 v90, s36, v90
  v_mul_f32 v94, s36, v94
  s_waitcnt vmcnt(4)
  v_lshlrev_b32 v67, 16, v172
  v_and_b32 v71, s25, v172
  v_lshlrev_b32 v75, 16, v173
  v_and_b32 v79, s25, v173
  v_lshlrev_b32 v83, 16, v174
  v_and_b32 v87, s25, v174
  v_lshlrev_b32 v91, 16, v175
  v_and_b32 v95, s25, v175
  v_mul_f32 v67, s36, v67
  v_mul_f32 v71, s36, v71
  v_mul_f32 v75, s36, v75
  v_mul_f32 v79, s36, v79
  v_mul_f32 v83, s36, v83
  v_mul_f32 v87, s36, v87
  v_mul_f32 v91, s36, v91
  v_mul_f32 v95, s36, v95
  s_waitcnt vmcnt(0)
  buffer_load_dword v144, v214, s[8:11], s56 offen sc1
  buffer_load_dwordx4 v[128:131], v1, s[8:11], s55 offen offset:0 sc1
  buffer_load_dwordx4 v[132:135], v1, s[8:11], s55 offen offset:1024 sc1
  buffer_load_dwordx4 v[136:139], v1, s[8:11], s55 offen offset:2048 sc1
  buffer_load_dwordx4 v[140:143], v1, s[8:11], s55 offen offset:3072 sc1
  s_addk_i32 s46, 0x1000
  buffer_load_dwordx4 a[80:83], v1, s[8:11], s46 offen offset:0
  buffer_load_dwordx4 a[84:87], v1, s[8:11], s46 offen offset:1024
  buffer_load_dwordx4 a[88:91], v1, s[8:11], s46 offen offset:2048
  buffer_load_dwordx4 a[92:95], v1, s[8:11], s46 offen offset:3072
  s_addk_i32 s46, 0x1000
  buffer_load_dwordx4 a[208:211], v1, s[8:11], s46 offen offset:0
  buffer_load_dwordx4 a[212:215], v1, s[8:11], s46 offen offset:1024
  buffer_load_dwordx4 a[216:219], v1, s[8:11], s46 offen offset:2048
  buffer_load_dwordx4 a[220:223], v1, s[8:11], s46 offen offset:3072
  s_addk_i32 s46, 0x1000
  buffer_load_dwordx4 a[96:99], v1, s[8:11], s46 offen offset:0
  buffer_load_dwordx4 a[100:103], v1, s[8:11], s46 offen offset:1024
  buffer_load_dwordx4 a[104:107], v1, s[8:11], s46 offen offset:2048
  buffer_load_dwordx4 a[108:111], v1, s[8:11], s46 offen offset:3072
  s_addk_i32 s46, 0x1000
  buffer_load_dwordx4 a[112:115], v1, s[8:11], s46 offen offset:0
  buffer_load_dwordx4 a[224:227], v1, s[8:11], s46 offen offset:1024
  buffer_load_dwordx4 a[228:231], v1, s[8:11], s46 offen offset:2048
  buffer_load_dwordx4 a[232:235], v1, s[8:11], s46 offen offset:3072
  s_addk_i32 s46, 0x1000
  buffer_load_dwordx4 a[236:239], v1, s[8:11], s46 offen offset:0
  buffer_load_dwordx4 a[116:119], v1, s[8:11], s46 offen offset:1024
  s_waitcnt vmcnt(21)
  v_max3_u32 v34, v144, v128, v129
  v_max3_u32 v34, v34, v130, v131
  s_waitcnt vmcnt(20)
  v_max3_u32 v34, v34, v132, v133
  v_max3_u32 v34, v34, v134, v135
  s_waitcnt vmcnt(19)
  v_max3_u32 v34, v34, v136, v137
  v_max3_u32 v34, v34, v138, v139
  s_waitcnt vmcnt(18)
  v_max3_u32 v34, v34, v140, v141
  v_max3_u32 v34, v34, v142, v143
  v_cmp_eq_u32 vcc, -1, v34
  s_nop 3
  s_cbranch_vccz C_go
C_retry:
  buffer_load_dword v144, v214, s[8:11], s56 offen sc1
  buffer_load_dwordx4 v[128:131], v1, s[8:11], s55 offen offset:0 sc1
  buffer_load_dwordx4 v[132:135], v1, s[8:11], s55 offen offset:1024 sc1
  buffer_load_dwordx4 v[136:139], v1, s[8:11], s55 offen offset:2048 sc1
  buffer_load_dwordx4 v[140:143], v1, s[8:11], s55 offen offset:3072 sc1
  s_add_u32 s59, s59, 1
  s_waitcnt vmcnt(3)
  v_max3_u32 v34, v144, v128, v129
  v_max3_u32 v34, v34, v130, v131
  s_waitcnt vmcnt(2)
  v_max3_u32 v34, v34, v132, v133
  v_max3_u32 v34, v34, v134, v135
  s_waitcnt vmcnt(1)
  v_max3_u32 v34, v34, v136, v137
  v_max3_u32 v34, v34, v138, v139
  s_waitcnt vmcnt(0)
  v_max3_u32 v34, v34, v140, v141
  v_max3_u32 v34, v34, v142, v143
  v_cmp_eq_u32 vcc, -1, v34
  s_nop 3
  s_cbranch_vccz C_go
  s_cmp_lt_u32 s59, 16384
  s_cbranch_scc1 C_retry
C_go:
  buffer_load_dwordx4 a[120:123], v1, s[8:11], s46 offen offset:2048
  ds_write_b128 v5, v[128:131] offset:0
  buffer_load_dwordx4 a[124:127], v1, s[8:11], s46 offen offset:3072
  ds_write_b128 v5, v[132:135] offset:1024
  ds_write_b128 v5, v[136:139] offset:2048
  s_addk_i32 s46, 0x1000
  buffer_load_dwordx4 a[240:243], v1, s[8:11], s46 offen offset:0
  ds_write_b128 v5, v[140:143] offset:3072
  s_waitcnt lgkmcnt(0)
  buffer_load_dwordx4 a[244:247], v1, s[8:11], s46 offen offset:1024
  s_barrier
  buffer_load_dwordx4 a[248:251], v1, s[8:11], s46 offen offset:2048
  ds_read_b128 v[192:195], v1 offset:0
  s_waitcnt lgkmcnt(0)
  v_mfma_f32_32x32x16_bf16 v[64:79], a[0:3], v[192:195], v[64:79]
  buffer_load_dwordx4 v[16:19], v14, s[12:15], 0 offen
  buffer_load_dwordx4 v[20:23], v24, s[12:15], 0 offen
  ds_read_b128 v[196:199], v1 offset:1024
  ds_read_b128 v[200:203], v1 offset:2048
  ds_read_b128 v[204:207], v1 offset:3072
  ds_read_b128 v[208:211], v1 offset:4096
  ds_read_b128 v[212:215], v1 offset:5120
  ds_read_b128 v[216:219], v1 offset:6144
  v_mfma_f32_32x32x16_bf16 v[80:95], a[4:7], v[192:195], v[80:95]
  s_waitcnt lgkmcnt(5)
  v_mfma_f32_32x32x16_bf16 v[64:79], a[8:11], v[196:199], v[64:79]
  ds_read_b128 v[220:223], v1 offset:7168
  buffer_load_dwordx4 a[252:255], v1, s[8:11], s46 offen offset:3072
  v_mfma_f32_32x32x16_bf16 v[80:95], a[12:15], v[196:199], v[80:95]
  buffer_store_dwordx4 v[56:59], v1, s[8:11], s64 offen offset:0 sc1
  s_waitcnt lgkmcnt(4)
  v_mfma_f32_32x32x16_bf16 v[64:79], a[16:19], v[200:203], v[64:79]
  ds_read_b128 v[224:227], v1 offset:8192
  v_mfma_f32_32x32x16_bf16 v[80:95], a[20:23], v[200:203], v[80:95]
  buffer_store_dwordx4 v[56:59], v1, s[8:11], s64 offen offset:1024 sc1
  v_mfma_f32_32x32x16_bf16 v[64:79], a[24:27], v[204:207], v[64:79]
  ds_read_b128 v[228:231], v1 offset:9216
  v_mfma_f32_32x32x16_bf16 v[80:95], a[28:31], v[204:207], v[80:95]
  buffer_store_dwordx4 v[56:59], v1, s[8:11], s64 offen offset:2048 sc1
  s_waitcnt lgkmcnt(4)
  v_mfma_f32_32x32x16_bf16 v[64:79], a[144:147], v[208:211], v[64:79]
  ds_read_b128 v[232:235], v1 offset:10240
  v_mfma_f32_32x32x16_bf16 v[80:95], a[148:151], v[208:211], v[80:95]
  buffer_store_dwordx4 v[56:59], v1, s[8:11], s64 offen offset:3072 sc1
  v_mfma_f32_32x32x16_bf16 v[64:79], a[152:155], v[212:215], v[64:79]
  ds_read_b128 v[236:239], v1 offset:11264
  v_mfma_f32_32x32x16_bf16 v[80:95], a[156:159], v[212:215], v[80:95]
  s_addk_i32 s46, 0x1000
  s_waitcnt lgkmcnt(4)
  v_mfma_f32_32x32x16_bf16 v[64:79], a[32:35], v[216:219], v[64:79]
  ds_read_b128 v[240:243], v1 offset:12288
  buffer_load_dwordx4 a[128:131], v1, s[8:11], s46 offen offset:0
  v_mfma_f32_32x32x16_bf16 v[80:95], a[36:39], v[216:219], v[80:95]
  v_mfma_f32_32x32x16_bf16 v[64:79], a[40:43], v[220:223], v[64:79]
  ds_read_b128 v[244:247], v1 offset:13312
  buffer_load_dwordx4 a[132:135], v1, s[8:11], s46 offen offset:1024
  v_mfma_f32_32x32x16_bf16 v[80:95], a[160:163], v[220:223], v[80:95]
  s_waitcnt lgkmcnt(4)
  v_mfma_f32_32x32x16_bf16 v[64:79], a[164:167], v[224:227], v[64:79]
  ds_read_b128 v[248:251], v1 offset:14336
  buffer_load_dwordx4 a[136:139], v1, s[8:11], s46 offen offset:2048
  v_mfma_f32_32x32x16_bf16 v[80:95], a[168:171], v[224:227], v[80:95]
  v_mfma_f32_32x32x16_bf16 v[64:79], a[172:175], v[228:231], v[64:79]
  ds_read_b128 v[252:255], v1 offset:15360
  buffer_load_dwordx4 a[140:143], v1, s[8:11], s46 offen offset:3072
  v_mfma_f32_32x32x16_bf16 v[80:95], a[44:47], v[228:231], v[80:95]
  s_addk_i32 s46, 0x1000
  s_waitcnt lgkmcnt(4)
  v_mfma_f32_32x32x16_bf16 v[64:79], a[48:51], v[232:235], v[64:79]
  buffer_load_dwordx4 a[192:195], v1, s[8:11], s46 offen offset:0
  v_mfma_f32_32x32x16_bf16 v[80:95], a[52:55], v[232:235], v[80:95]
  v_mfma_f32_32x32x16_bf16 v[64:79], a[56:59], v[236:239], v[64:79]
  buffer_load_dwordx4 a[196:199], v1, s[8:11], s46 offen offset:1024
  v_mfma_f32_32x32x16_bf16 v[80:95], a[60:63], v[236:239], v[80:95]
  s_waitcnt lgkmcnt(2)
  v_mfma_f32_32x32x16_bf16 v[64:79], a[176:179], v[240:243], v[64:79]
  buffer_load_dwordx4 a[200:203], v1, s[8:11], s46 offen offset:2048
  v_mfma_f32_32x32x16_bf16 v[80:95], a[180:183], v[240:243], v[80:95]
  v_mfma_f32_32x32x16_bf16 v[64:79], a[184:187], v[244:247], v[64:79]
  buffer_load_dwordx4 a[204:207], v1, s[8:11], s46 offen offset:3072
  v_mfma_f32_32x32x16_bf16 v[80:95], a[188:191], v[244:247], v[80:95]
  s_addk_i32 s46, 0x1000
  s_waitcnt lgkmcnt(0)
  v_mfma_f32_32x32x16_bf16 v[64:79], a[64:67], v[248:251], v[64:79]
  buffer_load_dwordx4 a[0:3], v1, s[8:11], s46 offen offset:0
  v_mfma_f32_32x32x16_bf16 v[80:95], a[68:71], v[248:251], v[80:95]
  v_mfma_f32_32x32x16_bf16 v[64:79], a[72:75], v[252:255], v[64:79]
  buffer_load_dwordx4 a[4:7], v1, s[8:11], s46 offen offset:1024
  v_mfma_f32_32x32x16_bf16 v[80:95], a[76:79], v[252:255], v[80:95]
  s_nop 9
  v_pk_add_f32 v[40:41], v[64:65], v[66:67]
  v_pk_mul_f32 v[42:43], v[64:65], v[64:65]
  buffer_load_dwordx4 a[8:11], v1, s[8:11], s46 offen offset:2048
  v_pk_fma_f32 v[42:43], v[66:67], v[66:67], v[42:43]
  v_pk_add_f32 v[40:41], v[40:41], v[68:69]
  v_pk_fma_f32 v[42:43], v[68:69], v[68:69], v[42:43]
  v_pk_add_f32 v[40:41], v[40:41], v[70:71]
  v_pk_fma_f32 v[42:43], v[70:71], v[70:71], v[42:43]
  v_pk_add_f32 v[40:41], v[40:41], v[72:73]
  v_pk_fma_f32 v[42:43], v[72:73], v[72:73], v[42:43]
  v_pk_add_f32 v[40:41], v[40:41], v[74:75]
  v_pk_fma_f32 v[42:43], v[74:75], v[74:75], v[42:43]
  v_pk_add_f32 v[40:41], v[40:41], v[76:77]
  v_pk_fma_f32 v[42:43], v[76:77], v[76:77], v[42:43]
  v_pk_add_f32 v[40:41], v[40:41], v[78:79]
  v_pk_fma_f32 v[42:43], v[78:79], v[78:79], v[42:43]
  buffer_load_dwordx4 a[12:15], v1, s[8:11], s46 offen offset:3072
  v_pk_add_f32 v[40:41], v[40:41], v[80:81]
  v_pk_fma_f32 v[42:43], v[80:81], v[80:81], v[42:43]
  v_pk_add_f32 v[40:41], v[40:41], v[82:83]
  v_pk_fma_f32 v[42:43], v[82:83], v[82:83], v[42:43]
  v_pk_add_f32 v[40:41], v[40:41], v[84:85]
  v_pk_fma_f32 v[42:43], v[84:85], v[84:85], v[42:43]
  v_pk_add_f32 v[40:41], v[40:41], v[86:87]
  v_pk_fma_f32 v[42:43], v[86:87], v[86:87], v[42:43]
  v_pk_add_f32 v[40:41], v[40:41], v[88:89]
  v_pk_fma_f32 v[42:43], v[88:89], v[88:89], v[42:43]
  v_pk_add_f32 v[40:41], v[40:41], v[90:91]
  v_pk_fma_f32 v[42:43], v[90:91], v[90:91], v[42:43]
  s_addk_i32 s46, 0x1000
  buffer_load_dwordx4 a[16:19], v1, s[8:11], s46 offen offset:0
  v_pk_add_f32 v[40:41], v[40:41], v[92:93]
  v_pk_fma_f32 v[42:43], v[92:93], v[92:93], v[42:43]
  v_pk_add_f32 v[40:41], v[40:41], v[94:95]
  v_pk_fma_f32 v[42:43], v[94:95], v[94:95], v[42:43]
  v_add_f32 v32, v40, v41
  v_add_f32 v33, v42, v43
  s_nop 1
  v_permlane32_swap_b32 v32, v33
  v_add_f32 v32, v32, v33
  ds_write_b32 v3, v32 offset:0
  s_waitcnt lgkmcnt(0)
  buffer_load_dwordx4 a[20:23], v1, s[8:11], s46 offen offset:1024
  s_barrier
  buffer_load_dwordx4 a[24:27], v1, s[8:11], s46 offen offset:2048
  ds_read_b128 v[160:163], v4 offset:0
  ds_read_b128 v[164:167], v4 offset:16
  buffer_load_dwordx4 a[28:31], v1, s[8:11], s46 offen offset:3072
  s_waitcnt lgkmcnt(1)
  v_pk_add_f32 v[160:161], v[160:161], v[162:163]
  s_waitcnt lgkmcnt(0)
  v_pk_add_f32 v[164:165], v[164:165], v[166:167]
  v_pk_add_f32 v[160:161], v[160:161], v[164:165]
  v_mul_f32 v162, 0xbb317218, v160
  v_mul_f32 v161, 0x3af5fdf0, v161
  v_fma_f32 v161, -v162, v162, v161
  v_max_f32 v161, 0, v161
  v_add_f32 v161, s39, v161
  v_rsq_f32 v33, v161
  v_mul_f32 v162, 0x3fb8aa3b, v162
  v_mul_f32 v32, v162, v33
  s_addk_i32 s46, 0x1000
  buffer_load_dwordx4 a[144:147], v1, s[8:11], s46 offen offset:0
  buffer_load_dwordx4 a[148:151], v1, s[8:11], s46 offen offset:1024
  v_pk_fma_f32 v[96:97], v[64:65], v[32:33], v[32:33] op_sel:[0,1,0] op_sel_hi:[1,1,0]
  v_pk_fma_f32 v[98:99], v[66:67], v[32:33], v[32:33] op_sel:[0,1,0] op_sel_hi:[1,1,0]
  v_pk_fma_f32 v[100:101], v[68:69], v[32:33], v[32:33] op_sel:[0,1,0] op_sel_hi:[1,1,0]
  v_pk_fma_f32 v[102:103], v[70:71], v[32:33], v[32:33] op_sel:[0,1,0] op_sel_hi:[1,1,0]
  v_pk_fma_f32 v[104:105], v[72:73], v[32:33], v[32:33] op_sel:[0,1,0] op_sel_hi:[1,1,0]
  v_pk_fma_f32 v[106:107], v[74:75], v[32:33], v[32:33] op_sel:[0,1,0] op_sel_hi:[1,1,0]
  buffer_load_dwordx4 a[152:155], v1, s[8:11], s46 offen offset:2048
  v_pk_fma_f32 v[108:109], v[76:77], v[32:33], v[32:33] op_sel:[0,1,0] op_sel_hi:[1,1,0]
  v_pk_fma_f32 v[110:111], v[78:79], v[32:33], v[32:33] op_sel:[0,1,0] op_sel_hi:[1,1,0]
  v_pk_fma_f32 v[112:113], v[80:81], v[32:33], v[32:33] op_sel:[0,1,0] op_sel_hi:[1,1,0]
  v_pk_fma_f32 v[114:115], v[82:83], v[32:33], v[32:33] op_sel:[0,1,0] op_sel_hi:[1,1,0]
  v_pk_fma_f32 v[116:117], v[84:85], v[32:33], v[32:33] op_sel:[0,1,0] op_sel_hi:[1,1,0]
  v_pk_fma_f32 v[118:119], v[86:87], v[32:33], v[32:33] op_sel:[0,1,0] op_sel_hi:[1,1,0]
  v_pk_fma_f32 v[120:121], v[88:89], v[32:33], v[32:33] op_sel:[0,1,0] op_sel_hi:[1,1,0]
  v_pk_fma_f32 v[122:123], v[90:91], v[32:33], v[32:33] op_sel:[0,1,0] op_sel_hi:[1,1,0]
  v_pk_fma_f32 v[124:125], v[92:93], v[32:33], v[32:33] op_sel:[0,1,0] op_sel_hi:[1,1,0]
  v_pk_fma_f32 v[126:127], v[94:95], v[32:33], v[32:33] op_sel:[0,1,0] op_sel_hi:[1,1,0]
  v_cvt_pk_bf16_f32 v40, v96, v100
  v_cvt_pk_bf16_f32 v41, v104, v108
  v_cvt_pk_bf16_f32 v42, v112, v116
  buffer_load_dwordx4 a[156:159], v1, s[8:11], s46 offen offset:3072
  v_cvt_pk_bf16_f32 v43, v120, v124
  ds_write_b128 v5, v[40:43] offset:0
  v_cvt_pk_bf16_f32 v44, v97, v101
  v_cvt_pk_bf16_f32 v45, v105, v109
  v_cvt_pk_bf16_f32 v46, v113, v117
  v_cvt_pk_bf16_f32 v47, v121, v125
  ds_write_b128 v5, v[44:47] offset:1024
  s_addk_i32 s46, 0x1000
  buffer_load_dwordx4 a[32:35], v1, s[8:11], s46 offen offset:0
  v_cvt_pk_bf16_f32 v48, v98, v102
  v_cvt_pk_bf16_f32 v49, v106, v110
  v_cvt_pk_bf16_f32 v50, v114, v118
  v_cvt_pk_bf16_f32 v51, v122, v126
  ds_write_b128 v5, v[48:51] offset:2048
  buffer_load_dwordx4 a[36:39], v1, s[8:11], s46 offen offset:1024
  v_cvt_pk_bf16_f32 v52, v99, v103
  v_cvt_pk_bf16_f32 v53, v107, v111
  v_cvt_pk_bf16_f32 v54, v115, v119
  v_cvt_pk_bf16_f32 v55, v123, v127
  ds_write_b128 v5, v[52:55] offset:3072
  s_waitcnt lgkmcnt(0)
  buffer_load_dwordx4 a[40:43], v1, s[8:11], s46 offen offset:2048
  s_barrier
  buffer_load_dwordx4 a[160:163], v1, s[8:11], s46 offen offset:3072
  ds_read_b128 v[192:195], v1 offset:0
  s_addk_i32 s46, 0x1000
  s_waitcnt vmcnt(50) lgkmcnt(0)
  v_mfma_f32_32x32x16_bf16 v[128:143], a[80:83], v[192:195], 0
  buffer_load_dwordx4 a[164:167], v1, s[8:11], s46 offen offset:0
  ds_read_b128 v[196:199], v1 offset:1024
  ds_read_b128 v[200:203], v1 offset:2048
  ds_read_b128 v[204:207], v1 offset:3072
  ds_read_b128 v[208:211], v1 offset:4096
  ds_read_b128 v[212:215], v1 offset:5120
  ds_read_b128 v[216:219], v1 offset:6144
  v_mfma_f32_32x32x16_bf16 v[144:159], a[84:87], v[192:195], 0
  buffer_load_dwordx4 a[168:171], v1, s[8:11], s46 offen offset:1024
  s_waitcnt lgkmcnt(5)
  v_mfma_f32_32x32x16_bf16 v[128:143], a[88:91], v[196:199], v[128:143]
  ds_read_b128 v[220:223], v1 offset:7168
  s_waitcnt vmcnt(32)
  v_lshlrev_b32 v40, 16, v16
  v_and_b32 v41, s25, v16
  v_mfma_f32_32x32x16_bf16 v[144:159], a[92:95], v[196:199], v[144:159]
  buffer_load_dwordx4 a[172:175], v1, s[8:11], s46 offen offset:2048
  v_lshlrev_b32 v42, 16, v17
  v_and_b32 v43, s25, v17
  s_waitcnt lgkmcnt(4)
  v_mfma_f32_32x32x16_bf16 v[128:143], a[208:211], v[200:203], v[128:143]
  ds_read_b128 v[224:227], v1 offset:8192
  v_lshlrev_b32 v44, 16, v18
  v_and_b32 v45, s25, v18
  v_mfma_f32_32x32x16_bf16 v[144:159], a[212:215], v[200:203], v[144:159]
  buffer_load_dwordx4 a[44:47], v1, s[8:11], s46 offen offset:3072
  v_lshlrev_b32 v46, 16, v19
  v_and_b32 v47, s25, v19
  v_mfma_f32_32x32x16_bf16 v[128:143], a[216:219], v[204:207], v[128:143]
  ds_read_b128 v[228:231], v1 offset:9216
  s_addk_i32 s46, 0x1000
  v_mfma_f32_32x32x16_bf16 v[144:159], a[220:223], v[204:207], v[144:159]
  ds_write_b128 v39, v[40:43] offset:0
  buffer_load_dwordx4 a[48:51], v1, s[8:11], s46 offen offset:0
  s_waitcnt lgkmcnt(5)
  v_mfma_f32_32x32x16_bf16 v[128:143], a[96:99], v[208:211], v[128:143]
  ds_read_b128 v[232:235], v1 offset:10240
  v_mfma_f32_32x32x16_bf16 v[144:159], a[100:103], v[208:211], v[144:159]
  buffer_load_dwordx4 a[52:55], v1, s[8:11], s46 offen offset:1024
  v_mfma_f32_32x32x16_bf16 v[128:143], a[104:107], v[212:215], v[128:143]
  ds_write_b128 v39, v[44:47] offset:16
  ds_read_b128 v[236:239], v1 offset:11264
  v_mfma_f32_32x32x16_bf16 v[144:159], a[108:111], v[212:215], v[144:159]
  buffer_load_dwordx4 a[56:59], v1, s[8:11], s46 offen offset:2048
  s_waitcnt lgkmcnt(6)
  v_mfma_f32_32x32x16_bf16 v[128:143], a[112:115], v[216:219], v[128:143]
  ds_read_b128 v[240:243], v1 offset:12288
  s_waitcnt vmcnt(36)
  v_lshlrev_b32 v48, 16, v20
  v_and_b32 v49, s25, v20
  v_mfma_f32_32x32x16_bf16 v[144:159], a[224:227], v[216:219], v[144:159]
  buffer_load_dwordx4 a[60:63], v1, s[8:11], s46 offen offset:3072
  v_lshlrev_b32 v50, 16, v21
  v_and_b32 v51, s25, v21
  v_mfma_f32_32x32x16_bf16 v[128:143], a[228:231], v[220:223], v[128:143]
  ds_read_b128 v[244:247], v1 offset:13312
  v_lshlrev_b32 v52, 16, v22
  v_and_b32 v53, s25, v22
  s_addk_i32 s46, 0x1000
  v_mfma_f32_32x32x16_bf16 v[144:159], a[232:235], v[220:223], v[144:159]
  buffer_load_dwordx4 a[176:179], v1, s[8:11], s46 offen offset:0
  v_lshlrev_b32 v54, 16, v23
  s_waitcnt lgkmcnt(6)
  v_mfma_f32_32x32x16_bf16 v[128:143], a[236:239], v[224:227], v[128:143]
  ds_read_b128 v[248:251], v1 offset:14336
  v_and_b32 v55, s25, v23
  v_mfma_f32_32x32x16_bf16 v[144:159], a[116:119], v[224:227], v[144:159]
  buffer_load_dwordx4 a[180:183], v1, s[8:11], s46 offen offset:1024
  ds_write_b128 v39, v[48:51] offset:2048
  v_mfma_f32_32x32x16_bf16 v[128:143], a[120:123], v[228:231], v[128:143]
  ds_read_b128 v[252:255], v1 offset:15360
  buffer_load_dwordx4 a[184:187], v1, s[8:11], s46 offen offset:2048
  v_mfma_f32_32x32x16_bf16 v[144:159], a[124:127], v[228:231], v[144:159]
  s_waitcnt vmcnt(39) lgkmcnt(5)
  v_mfma_f32_32x32x16_bf16 v[128:143], a[240:243], v[232:235], v[128:143]
  ds_write_b128 v39, v[52:55] offset:2064
  buffer_load_dwordx4 a[188:191], v1, s[8:11], s46 offen offset:3072
  v_mfma_f32_32x32x16_bf16 v[144:159], a[244:247], v[232:235], v[144:159]
  s_addk_i32 s46, 0x1000
  v_mfma_f32_32x32x16_bf16 v[128:143], a[248:251], v[236:239], v[128:143]
  ds_read_b64 v[96:97], v63 offset:0
  ds_read_b64 v[98:99], v63 offset:256
  buffer_load_dwordx4 a[64:67], v1, s[8:11], s46 offen offset:0
  v_mfma_f32_32x32x16_bf16 v[144:159], a[252:255], v[236:239], v[144:159]
  ds_read_b64 v[100:101], v63 offset:512
  ds_read_b64 v[102:103], v63 offset:768
  s_waitcnt vmcnt(33) lgkmcnt(8)
  v_mfma_f32_32x32x16_bf16 v[128:143], a[128:131], v[240:243], v[128:143]
  ds_read_b64 v[104:105], v63 offset:1024
  ds_read_b64 v[106:107], v63 offset:1280
  buffer_load_dwordx4 a[68:71], v1, s[8:11], s46 offen offset:1024
  v_mfma_f32_32x32x16_bf16 v[144:159], a[132:135], v[240:243], v[144:159]
  ds_read_b64 v[108:109], v63 offset:1536
  v_mfma_f32_32x32x16_bf16 v[128:143], a[136:139], v[244:247], v[128:143]
  ds_read_b64 v[110:111], v63 offset:1792
  ds_read_b64 v[112:113], v63 offset:2048
  buffer_load_dwordx4 a[72:75], v1, s[8:11], s46 offen offset:2048
  v_mfma_f32_32x32x16_bf16 v[144:159], a[140:143], v[244:247], v[144:159]
  ds_read_b64 v[114:115], v63 offset:2304
  ds_read_b64 v[116:117], v63 offset:2560
  s_waitcnt vmcnt(31) lgkmcnt(12)
  v_mfma_f32_32x32x16_bf16 v[128:143], a[192:195], v[248:251], v[128:143]
  ds_read_b64 v[118:119], v63 offset:2816
  ds_read_b64 v[120:121], v63 offset:3072
  buffer_load_dwordx4 a[76:79], v1, s[8:11], s46 offen offset:3072
  v_mfma_f32_32x32x16_bf16 v[144:159], a[196:199], v[248:251], v[144:159]
  ds_read_b64 v[122:123], v63 offset:3328
  ds_read_b64 v[124:125], v63 offset:3584
  s_addk_i32 s46, 0x1000
  v_mfma_f32_32x32x16_bf16 v[128:143], a[200:203], v[252:255], v[128:143]
  buffer_load_dwordx4 a[80:83], v1, s[8:11], s46 offen offset:0
  v_mfma_f32_32x32x16_bf16 v[144:159], a[204:207], v[252:255], v[144:159]
  s_waitcnt vmcnt(29)
  v_mfma_f32_32x32x16_bf16 v[160:175], a[0:3], v[192:195], 0
  buffer_load_dwordx4 a[84:87], v1, s[8:11], s46 offen offset:1024
  v_mfma_f32_32x32x16_bf16 v[176:191], a[4:7], v[192:195], 0
  s_nop 7
  v_exp_f32 v144, v144
  v_exp_f32 v148, v148
  v_exp_f32 v152, v152
  v_exp_f32 v156, v156
  v_mfma_f32_32x32x16_bf16 v[160:175], a[8:11], v[196:199], v[160:175]
  buffer_load_dwordx4 a[88:91], v1, s[8:11], s46 offen offset:2048
  v_add_f32 v144, 1.0, v144
  v_add_f32 v148, 1.0, v148
  v_add_f32 v152, 1.0, v152
  v_add_f32 v156, 1.0, v156
  v_rcp_f32 v144, v144
  v_mfma_f32_32x32x16_bf16 v[176:191], a[12:15], v[196:199], v[176:191]
  buffer_load_dwordx4 a[92:95], v1, s[8:11], s46 offen offset:3072
  v_rcp_f32 v148, v148
  v_rcp_f32 v152, v152
  v_rcp_f32 v156, v156
  v_mul_f32 v40, v128, v144
  v_mul_f32 v41, v132, v148
  s_waitcnt vmcnt(28)
  v_mfma_f32_32x32x16_bf16 v[160:175], a[16:19], v[200:203], v[160:175]
  v_mul_f32 v42, v136, v152
  v_mul_f32 v43, v140, v156
  v_mfma_f32_32x32x16_bf16 v[176:191], a[20:23], v[200:203], v[176:191]
  buffer_store_dwordx4 v[40:43], v61, s[8:11], s60 offen offset:0 sc1
  ds_write_b128 v6, v[40:43] offset:0
  v_exp_f32 v145, v145
  v_exp_f32 v149, v149
  v_exp_f32 v153, v153
  v_mfma_f32_32x32x16_bf16 v[160:175], a[24:27], v[204:207], v[160:175]
  v_exp_f32 v157, v157
  v_add_f32 v145, 1.0, v145
  v_add_f32 v149, 1.0, v149
  v_add_f32 v153, 1.0, v153
  v_add_f32 v157, 1.0, v157
  v_mfma_f32_32x32x16_bf16 v[176:191], a[28:31], v[204:207], v[176:191]
  v_rcp_f32 v145, v145
  v_rcp_f32 v149, v149
  v_rcp_f32 v153, v153
  v_rcp_f32 v157, v157
  s_waitcnt vmcnt(25)
  v_mfma_f32_32x32x16_bf16 v[160:175], a[144:147], v[208:211], v[160:175]
  v_mul_f32 v44, v129, v145
  v_mul_f32 v45, v133, v149
  v_mul_f32 v46, v137, v153
  v_mul_f32 v47, v141, v157
  v_mfma_f32_32x32x16_bf16 v[176:191], a[148:151], v[208:211], v[176:191]
  buffer_store_dwordx4 v[44:47], v61, s[8:11], s60 offen offset:256 sc1
  ds_write_b128 v6, v[44:47] offset:32
  v_exp_f32 v146, v146
  v_exp_f32 v150, v150
  v_mfma_f32_32x32x16_bf16 v[160:175], a[152:155], v[212:215], v[160:175]
  v_exp_f32 v154, v154
  v_exp_f32 v158, v158
  v_add_f32 v146, 1.0, v146
  v_add_f32 v150, 1.0, v150
  v_add_f32 v154, 1.0, v154
  v_mfma_f32_32x32x16_bf16 v[176:191], a[156:159], v[212:215], v[176:191]
  v_add_f32 v158, 1.0, v158
  v_rcp_f32 v146, v146
  v_rcp_f32 v150, v150
  v_rcp_f32 v154, v154
  s_waitcnt vmcnt(22)
  v_mfma_f32_32x32x16_bf16 v[160:175], a[32:35], v[216:219], v[160:175]
  v_rcp_f32 v158, v158
  v_mul_f32 v48, v130, v146
  v_mul_f32 v49, v134, v150
  v_mul_f32 v50, v138, v154
  v_mul_f32 v51, v142, v158
  v_mfma_f32_32x32x16_bf16 v[176:191], a[36:39], v[216:219], v[176:191]
  buffer_store_dwordx4 v[48:51], v61, s[8:11], s60 offen offset:512 sc1
  ds_write_b128 v6, v[48:51] offset:64
  v_exp_f32 v147, v147
  v_mfma_f32_32x32x16_bf16 v[160:175], a[40:43], v[220:223], v[160:175]
  v_exp_f32 v151, v151
  v_exp_f32 v155, v155
  v_exp_f32 v159, v159
  v_add_f32 v147, 1.0, v147
  v_mfma_f32_32x32x16_bf16 v[176:191], a[160:163], v[220:223], v[176:191]
  v_add_f32 v151, 1.0, v151
  v_add_f32 v155, 1.0, v155
  v_add_f32 v159, 1.0, v159
  v_rcp_f32 v147, v147
  v_rcp_f32 v151, v151
  s_waitcnt vmcnt(19)
  v_mfma_f32_32x32x16_bf16 v[160:175], a[164:167], v[224:227], v[160:175]
  v_rcp_f32 v155, v155
  v_rcp_f32 v159, v159
  v_mul_f32 v52, v131, v147
  v_mul_f32 v53, v135, v151
  v_mul_f32 v54, v139, v155
  v_mul_f32 v55, v143, v159
  v_mfma_f32_32x32x16_bf16 v[176:191], a[168:171], v[224:227], v[176:191]
  buffer_store_dwordx4 v[52:55], v61, s[8:11], s60 offen offset:768 sc1
  ds_write_b128 v6, v[52:55] offset:96
  s_addk_i32 s46, 0x1000
  v_mfma_f32_32x32x16_bf16 v[160:175], a[172:175], v[228:231], v[160:175]
  buffer_load_dwordx4 a[208:211], v1, s[8:11], s46 offen offset:0
  buffer_load_dwordx4 a[212:215], v1, s[8:11], s46 offen offset:1024
  v_mfma_f32_32x32x16_bf16 v[176:191], a[44:47], v[228:231], v[176:191]
  buffer_load_dwordx4 a[216:219], v1, s[8:11], s46 offen offset:2048
  s_waitcnt vmcnt(19)
  v_mfma_f32_32x32x16_bf16 v[160:175], a[48:51], v[232:235], v[160:175]
  v_mfma_f32_32x32x16_bf16 v[176:191], a[52:55], v[232:235], v[176:191]
  buffer_load_dwordx4 a[220:223], v1, s[8:11], s46 offen offset:3072
  v_mfma_f32_32x32x16_bf16 v[160:175], a[56:59], v[236:239], v[160:175]
  s_addk_i32 s46, 0x1000
  v_mfma_f32_32x32x16_bf16 v[176:191], a[60:63], v[236:239], v[176:191]
  buffer_load_dwordx4 a[96:99], v1, s[8:11], s46 offen offset:0
  s_waitcnt vmcnt(17)
  v_mfma_f32_32x32x16_bf16 v[160:175], a[176:179], v[240:243], v[160:175]
  ds_read_b64 v[128:129], v8 offset:1904
  v_mfma_f32_32x32x16_bf16 v[176:191], a[180:183], v[240:243], v[176:191]
  ds_read_b64 v[130:131], v8 offset:2176
  ds_read_b64 v[132:133], v8 offset:2448
  buffer_load_dwordx4 a[100:103], v1, s[8:11], s46 offen offset:1024
  v_mfma_f32_32x32x16_bf16 v[160:175], a[184:187], v[244:247], v[160:175]
  ds_read_b64 v[134:135], v8 offset:2720
  v_mfma_f32_32x32x16_bf16 v[176:191], a[188:191], v[244:247], v[176:191]
  ds_read_b64 v[136:137], v8 offset:2992
  buffer_load_dwordx4 a[104:107], v1, s[8:11], s46 offen offset:2048
  s_waitcnt vmcnt(15)
  v_mfma_f32_32x32x16_bf16 v[160:175], a[64:67], v[248:251], v[160:175]
  ds_read_b64 v[138:139], v8 offset:3264
  ds_read_b64 v[140:141], v8 offset:3536
  v_mfma_f32_32x32x16_bf16 v[176:191], a[68:71], v[248:251], v[176:191]
  ds_read_b64 v[142:143], v8 offset:3808
  buffer_load_dwordx4 a[108:111], v1, s[8:11], s46 offen offset:3072
  v_mfma_f32_32x32x16_bf16 v[160:175], a[72:75], v[252:255], v[160:175]
  v_mfma_f32_32x32x16_bf16 v[176:191], a[76:79], v[252:255], v[176:191]
  ds_read_b64 v[192:193], v63 offset:16
  ds_read_b64 v[194:195], v63 offset:272
  ds_read_b64 v[196:197], v63 offset:528
  ds_read_b64 v[198:199], v63 offset:784
  ds_read_b64 v[200:201], v63 offset:1040
  ds_read_b64 v[202:203], v63 offset:1296
  ds_read_b64 v[204:205], v63 offset:1552
  ds_read_b64 v[206:207], v63 offset:1808
  ds_read_b64 v[208:209], v63 offset:2064
  ds_read_b64 v[210:211], v63 offset:2320
  ds_read_b64 v[212:213], v63 offset:2576
  ds_read_b64 v[214:215], v63 offset:2832
  ds_read_b64 v[216:217], v63 offset:3088
  ds_read_b64 v[218:219], v63 offset:3344
  ds_read_b64 v[220:221], v63 offset:3600
  v_exp_f32 v176, v176
  v_exp_f32 v177, v177
  v_exp_f32 v178, v178
  v_exp_f32 v179, v179
  v_exp_f32 v180, v180
  v_exp_f32 v181, v181
  v_exp_f32 v182, v182
  v_exp_f32 v183, v183
  v_exp_f32 v184, v184
  v_exp_f32 v185, v185
  v_exp_f32 v186, v186
  v_exp_f32 v187, v187
  v_exp_f32 v188, v188
  v_exp_f32 v189, v189
  v_exp_f32 v190, v190
  v_exp_f32 v191, v191
  v_pk_add_f32 v[176:177], v[176:177], 1.0 op_sel_hi:[1,0]
  v_pk_add_f32 v[178:179], v[178:179], 1.0 op_sel_hi:[1,0]
  v_pk_add_f32 v[180:181], v[180:181], 1.0 op_sel_hi:[1,0]
  v_pk_add_f32 v[182:183], v[182:183], 1.0 op_sel_hi:[1,0]
  v_pk_add_f32 v[184:185], v[184:185], 1.0 op_sel_hi:[1,0]
  v_pk_add_f32 v[186:187], v[186:187], 1.0 op_sel_hi:[1,0]
  v_pk_add_f32 v[188:189], v[188:189], 1.0 op_sel_hi:[1,0]
  v_pk_add_f32 v[190:191], v[190:191], 1.0 op_sel_hi:[1,0]
  v_rcp_f32 v176, v176
  v_rcp_f32 v180, v180
  v_rcp_f32 v184, v184
  v_rcp_f32 v188, v188
  v_mul_f32 v40, v160, v176
  v_mul_f32 v41, v164, v180
  v_mul_f32 v42, v168, v184
  v_mul_f32 v43, v172, v188
  buffer_store_dwordx4 v[40:43], v61, s[8:11], s60 offen offset:2048 sc1
  ds_write_b128 v6, v[40:43] offset:16
  v_rcp_f32 v177, v177
  v_rcp_f32 v181, v181
  v_rcp_f32 v185, v185
  v_rcp_f32 v189, v189
  v_mul_f32 v44, v161, v177
  v_mul_f32 v45, v165, v181
  v_mul_f32 v46, v169, v185
  v_mul_f32 v47, v173, v189
  buffer_store_dwordx4 v[44:47], v61, s[8:11], s60 offen offset:2304 sc1
  ds_write_b128 v6, v[44:47] offset:48
  v_rcp_f32 v178, v178
  v_rcp_f32 v182, v182
  v_rcp_f32 v186, v186
  v_rcp_f32 v190, v190
  v_mul_f32 v48, v162, v178
  v_mul_f32 v49, v166, v182
  v_mul_f32 v50, v170, v186
  v_mul_f32 v51, v174, v190
  buffer_store_dwordx4 v[48:51], v61, s[8:11], s60 offen offset:2560 sc1
  ds_write_b128 v6, v[48:51] offset:80
  v_rcp_f32 v179, v179
  v_rcp_f32 v183, v183
  v_rcp_f32 v187, v187
  v_rcp_f32 v191, v191
  v_mul_f32 v52, v163, v179
  v_mul_f32 v53, v167, v183
  buffer_load_dwordx4 v[224:227], v62, s[8:11], s58 offen offset:0 sc1
  buffer_load_dwordx4 v[228:231], v60, s[8:11], s58 offen offset:1024 sc1
  v_mul_f32 v54, v171, v187
  v_mul_f32 v55, v175, v191
  buffer_store_dwordx4 v[52:55], v61, s[8:11], s60 offen offset:2816 sc1
  ds_write_b128 v6, v[52:55] offset:112
  ds_read_b64 v[160:161], v8 offset:1920
  ds_read_b64 v[162:163], v8 offset:2192
  ds_read_b64 v[164:165], v8 offset:2464
  s_addk_i32 s46, 0x1000
  buffer_load_dwordx4 a[112:115], v1, s[8:11], s46 offen offset:0
  ds_read_b64 v[166:167], v8 offset:2736
  ds_read_b64 v[168:169], v8 offset:3008
  ds_read_b64 v[170:171], v8 offset:3280
  ds_read_b64 v[172:173], v8 offset:3552
  ds_read_b64 v[174:175], v8 offset:3824
  s_waitcnt lgkmcnt(15)
  v_pk_mul_f32 v[30:31], v[128:129], v[96:97]
  v_pk_mul_f32 v[28:29], v[128:129], v[98:99]
  v_pk_mul_f32 v[26:27], v[128:129], v[100:101]
  v_pk_mul_f32 v[24:25], v[128:129], v[102:103]
  v_pk_mul_f32 v[22:23], v[128:129], v[104:105]
  v_pk_mul_f32 v[20:21], v[128:129], v[106:107]
  v_pk_mul_f32 v[18:19], v[128:129], v[108:109]
  v_pk_mul_f32 v[16:17], v[128:129], v[110:111]
  buffer_load_dwordx4 a[224:227], v1, s[8:11], s46 offen offset:1024
  s_waitcnt lgkmcnt(15)
  v_pk_fma_f32 v[30:31], v[130:131], v[98:99], v[30:31]
  v_pk_fma_f32 v[28:29], v[130:131], v[100:101], v[28:29]
  v_pk_fma_f32 v[26:27], v[130:131], v[102:103], v[26:27]
  v_pk_fma_f32 v[24:25], v[130:131], v[104:105], v[24:25]
  v_pk_fma_f32 v[22:23], v[130:131], v[106:107], v[22:23]
  v_pk_fma_f32 v[20:21], v[130:131], v[108:109], v[20:21]
  v_pk_fma_f32 v[18:19], v[130:131], v[110:111], v[18:19]
  v_pk_fma_f32 v[16:17], v[130:131], v[112:113], v[16:17]
  s_waitcnt lgkmcnt(15)
  v_pk_fma_f32 v[30:31], v[132:133], v[100:101], v[30:31]
  v_pk_fma_f32 v[28:29], v[132:133], v[102:103], v[28:29]
  v_pk_fma_f32 v[26:27], v[132:133], v[104:105], v[26:27]
  v_pk_fma_f32 v[24:25], v[132:133], v[106:107], v[24:25]
  v_pk_fma_f32 v[22:23], v[132:133], v[108:109], v[22:23]
  v_pk_fma_f32 v[20:21], v[132:133], v[110:111], v[20:21]
  v_pk_fma_f32 v[18:19], v[132:133], v[112:113], v[18:19]
  buffer_load_dwordx4 a[228:231], v1, s[8:11], s46 offen offset:2048
  v_pk_fma_f32 v[16:17], v[132:133], v[114:115], v[16:17]
  s_waitcnt lgkmcnt(15)
  v_pk_fma_f32 v[30:31], v[134:135], v[102:103], v[30:31]
  v_pk_fma_f32 v[28:29], v[134:135], v[104:105], v[28:29]
  v_pk_fma_f32 v[26:27], v[134:135], v[106:107], v[26:27]
  v_pk_fma_f32 v[24:25], v[134:135], v[108:109], v[24:25]
  v_pk_fma_f32 v[22:23], v[134:135], v[110:111], v[22:23]
  v_pk_fma_f32 v[20:21], v[134:135], v[112:113], v[20:21]
  v_pk_fma_f32 v[18:19], v[134:135], v[114:115], v[18:19]
  v_pk_fma_f32 v[16:17], v[134:135], v[116:117], v[16:17]
  s_waitcnt lgkmcnt(15)
  v_pk_fma_f32 v[30:31], v[136:137], v[104:105], v[30:31]
  v_pk_fma_f32 v[28:29], v[136:137], v[106:107], v[28:29]
  v_pk_fma_f32 v[26:27], v[136:137], v[108:109], v[26:27]
  v_pk_fma_f32 v[24:25], v[136:137], v[110:111], v[24:25]
  v_pk_fma_f32 v[22:23], v[136:137], v[112:113], v[22:23]
  buffer_load_dwordx4 a[232:235], v1, s[8:11], s46 offen offset:3072
  v_pk_fma_f32 v[20:21], v[136:137], v[114:115], v[20:21]
  v_pk_fma_f32 v[18:19], v[136:137], v[116:117], v[18:19]
  v_pk_fma_f32 v[16:17], v[136:137], v[118:119], v[16:17]
  s_waitcnt lgkmcnt(15)
  v_pk_fma_f32 v[30:31], v[138:139], v[106:107], v[30:31]
  v_pk_fma_f32 v[28:29], v[138:139], v[108:109], v[28:29]
  v_pk_fma_f32 v[26:27], v[138:139], v[110:111], v[26:27]
  v_pk_fma_f32 v[24:25], v[138:139], v[112:113], v[24:25]
  v_pk_fma_f32 v[22:23], v[138:139], v[114:115], v[22:23]
  v_pk_fma_f32 v[20:21], v[138:139], v[116:117], v[20:21]
  v_pk_fma_f32 v[18:19], v[138:139], v[118:119], v[18:19]
  v_pk_fma_f32 v[16:17], v[138:139], v[120:121], v[16:17]
  s_waitcnt lgkmcnt(15)
  v_pk_fma_f32 v[30:31], v[140:141], v[108:109], v[30:31]
  v_pk_fma_f32 v[28:29], v[140:141], v[110:111], v[28:29]
  v_pk_fma_f32 v[26:27], v[140:141], v[112:113], v[26:27]
  s_addk_i32 s46, 0x1000
  buffer_load_dwordx4 a[236:239], v1, s[8:11], s46 offen offset:0
  v_pk_fma_f32 v[24:25], v[140:141], v[114:115], v[24:25]
  v_pk_fma_f32 v[22:23], v[140:141], v[116:117], v[22:23]
  v_pk_fma_f32 v[20:21], v[140:141], v[118:119], v[20:21]
  v_pk_fma_f32 v[18:19], v[140:141], v[120:121], v[18:19]
  v_pk_fma_f32 v[16:17], v[140:141], v[122:123], v[16:17]
  s_waitcnt lgkmcnt(15)
  v_pk_fma_f32 v[30:31], v[142:143], v[110:111], v[30:31]
  v_pk_fma_f32 v[28:29], v[142:143], v[112:113], v[28:29]
  v_pk_fma_f32 v[26:27], v[142:143], v[114:115], v[26:27]
  v_pk_fma_f32 v[24:25], v[142:143], v[116:117], v[24:25]
  v_pk_fma_f32 v[22:23], v[142:143], v[118:119], v[22:23]
  v_pk_fma_f32 v[20:21], v[142:143], v[120:121], v[20:21]
  v_pk_fma_f32 v[18:19], v[142:143], v[122:123], v[18:19]
  v_pk_fma_f32 v[16:17], v[142:143], v[124:125], v[16:17]
  s_waitcnt lgkmcnt(7)
  v_pk_mul_f32 v[254:255], v[160:161], v[192:193]
  buffer_load_dwordx4 a[116:119], v1, s[8:11], s46 offen offset:1024
  v_pk_mul_f32 v[252:253], v[160:161], v[194:195]
  v_pk_mul_f32 v[250:251], v[160:161], v[196:197]
  v_pk_mul_f32 v[248:249], v[160:161], v[198:199]
  v_pk_mul_f32 v[246:247], v[160:161], v[200:201]
  v_pk_mul_f32 v[244:245], v[160:161], v[202:203]
  v_pk_mul_f32 v[242:243], v[160:161], v[204:205]
  v_pk_mul_f32 v[240:241], v[160:161], v[206:207]
  s_waitcnt lgkmcnt(6)
  v_pk_fma_f32 v[254:255], v[162:163], v[194:195], v[254:255]
  v_pk_fma_f32 v[252:253], v[162:163], v[196:197], v[252:253]
  v_pk_fma_f32 v[250:251], v[162:163], v[198:199], v[250:251]
  v_pk_fma_f32 v[248:249], v[162:163], v[200:201], v[248:249]
  v_pk_fma_f32 v[246:247], v[162:163], v[202:203], v[246:247]
  v_pk_fma_f32 v[244:245], v[162:163], v[204:205], v[244:245]
  v_pk_fma_f32 v[242:243], v[162:163], v[206:207], v[242:243]
  buffer_load_dwordx4 a[120:123], v1, s[8:11], s46 offen offset:2048
  v_pk_fma_f32 v[240:241], v[162:163], v[208:209], v[240:241]
  s_waitcnt lgkmcnt(5)
  v_pk_fma_f32 v[254:255], v[164:165], v[196:197], v[254:255]
  v_pk_fma_f32 v[252:253], v[164:165], v[198:199], v[252:253]
  v_pk_fma_f32 v[250:251], v[164:165], v[200:201], v[250:251]
  v_pk_fma_f32 v[248:249], v[164:165], v[202:203], v[248:249]
  v_pk_fma_f32 v[246:247], v[164:165], v[204:205], v[246:247]
  v_pk_fma_f32 v[244:245], v[164:165], v[206:207], v[244:245]
  v_pk_fma_f32 v[242:243], v[164:165], v[208:209], v[242:243]
  v_pk_fma_f32 v[240:241], v[164:165], v[210:211], v[240:241]
  s_waitcnt lgkmcnt(4)
  v_pk_fma_f32 v[254:255], v[166:167], v[198:199], v[254:255]
  v_pk_fma_f32 v[252:253], v[166:167], v[200:201], v[252:253]
  v_pk_fma_f32 v[250:251], v[166:167], v[202:203], v[250:251]
  v_pk_fma_f32 v[248:249], v[166:167], v[204:205], v[248:249]
  v_pk_fma_f32 v[246:247], v[166:167], v[206:207], v[246:247]
  v_pk_fma_f32 v[244:245], v[166:167], v[208:209], v[244:245]
  buffer_load_dwordx4 a[124:127], v1, s[8:11], s46 offen offset:3072
  v_pk_fma_f32 v[242:243], v[166:167], v[210:211], v[242:243]
  v_pk_fma_f32 v[240:241], v[166:167], v[212:213], v[240:241]
  s_waitcnt lgkmcnt(3)
  v_pk_fma_f32 v[254:255], v[168:169], v[200:201], v[254:255]
  v_pk_fma_f32 v[252:253], v[168:169], v[202:203], v[252:253]
  v_pk_fma_f32 v[250:251], v[168:169], v[204:205], v[250:251]
  v_pk_fma_f32 v[248:249], v[168:169], v[206:207], v[248:249]
  v_pk_fma_f32 v[246:247], v[168:169], v[208:209], v[246:247]
  v_pk_fma_f32 v[244:245], v[168:169], v[210:211], v[244:245]
  v_pk_fma_f32 v[242:243], v[168:169], v[212:213], v[242:243]
  v_pk_fma_f32 v[240:241], v[168:169], v[214:215], v[240:241]
  s_waitcnt lgkmcnt(2)
  v_pk_fma_f32 v[254:255], v[170:171], v[202:203], v[254:255]
  v_pk_fma_f32 v[252:253], v[170:171], v[204:205], v[252:253]
  v_pk_fma_f32 v[250:251], v[170:171], v[206:207], v[250:251]
  v_pk_fma_f32 v[248:249], v[170:171], v[208:209], v[248:249]
  buffer_load_dwordx4 v[232:235], v62, s[8:11], s58 offen offset:2048 sc1
  buffer_load_dwordx4 v[236:239], v60, s[8:11], s58 offen offset:3072 sc1
  v_pk_fma_f32 v[246:247], v[170:171], v[210:211], v[246:247]
  v_pk_fma_f32 v[244:245], v[170:171], v[212:213], v[244:245]
  v_pk_fma_f32 v[242:243], v[170:171], v[214:215], v[242:243]
  v_pk_fma_f32 v[240:241], v[170:171], v[216:217], v[240:241]
  s_waitcnt lgkmcnt(1)
  v_pk_fma_f32 v[254:255], v[172:173], v[204:205], v[254:255]
  s_waitcnt vmcnt(12)
  v_max3_u32 v222, v224, v225, v226
  s_waitcnt vmcnt(11)
  v_max3_u32 v222, v222, v227, v228
  v_max3_u32 v222, v222, v229, v230
  v_max_u32 v222, v222, v231
  v_cmp_eq_u32 vcc, -1, v222
  s_nop 3
  s_cbranch_vccnz C_rh0
C_gh0:
  ds_write_b128 v7, v[224:227] offset:0
  v_and_b32 v228, s61, v228
  v_and_b32 v229, s61, v229
  v_and_b32 v230, s61, v230
  v_and_b32 v231, s61, v231
  ds_write_b128 v7, v[228:231] offset:10880
  s_addk_i32 s46, 0x1000
  buffer_load_dwordx4 a[240:243], v1, s[8:11], s46 offen offset:0
  ds_read_b64 v[144:145], v8 offset:0
  ds_read_b64 v[146:147], v8 offset:272
  ds_read_b64 v[148:149], v8 offset:544
  ds_read_b64 v[150:151], v8 offset:816
  ds_read_b64 v[152:153], v8 offset:1088
  ds_read_b64 v[154:155], v8 offset:1360
  ds_read_b64 v[156:157], v8 offset:1632
  ds_read_b64 v[128:129], v8 offset:4080
  ds_read_b64 v[130:131], v8 offset:4352
  ds_read_b64 v[132:133], v8 offset:4624
  buffer_load_dwordx4 a[244:247], v1, s[8:11], s46 offen offset:1024
  ds_read_b64 v[134:135], v8 offset:4896
  ds_read_b64 v[136:137], v8 offset:5168
  ds_read_b64 v[138:139], v8 offset:5440
  ds_read_b64 v[140:141], v8 offset:5712
  v_pk_fma_f32 v[252:253], v[172:173], v[206:207], v[252:253]
  v_pk_fma_f32 v[250:251], v[172:173], v[208:209], v[250:251]
  v_pk_fma_f32 v[248:249], v[172:173], v[210:211], v[248:249]
  v_pk_fma_f32 v[246:247], v[172:173], v[212:213], v[246:247]
  v_pk_fma_f32 v[244:245], v[172:173], v[214:215], v[244:245]
  v_pk_fma_f32 v[242:243], v[172:173], v[216:217], v[242:243]
  v_pk_fma_f32 v[240:241], v[172:173], v[218:219], v[240:241]
  s_waitcnt lgkmcnt(15)
  v_pk_fma_f32 v[254:255], v[174:175], v[206:207], v[254:255]
  v_pk_fma_f32 v[252:253], v[174:175], v[208:209], v[252:253]
  v_pk_fma_f32 v[250:251], v[174:175], v[210:211], v[250:251]
  v_pk_fma_f32 v[248:249], v[174:175], v[212:213], v[248:249]
  buffer_load_dwordx4 a[248:251], v1, s[8:11], s46 offen offset:2048
  v_pk_fma_f32 v[246:247], v[174:175], v[214:215], v[246:247]
  v_pk_fma_f32 v[244:245], v[174:175], v[216:217], v[244:245]
  v_pk_fma_f32 v[242:243], v[174:175], v[218:219], v[242:243]
  v_pk_fma_f32 v[240:241], v[174:175], v[220:221], v[240:241]
  s_waitcnt lgkmcnt(13)
  v_pk_fma_f32 v[16:17], v[144:145], v[96:97], v[16:17]
  s_waitcnt lgkmcnt(12)
  v_pk_fma_f32 v[18:19], v[146:147], v[96:97], v[18:19]
  v_pk_fma_f32 v[16:17], v[146:147], v[98:99], v[16:17]
  s_waitcnt lgkmcnt(11)
  v_pk_fma_f32 v[20:21], v[148:149], v[96:97], v[20:21]
  v_pk_fma_f32 v[18:19], v[148:149], v[98:99], v[18:19]
  v_pk_fma_f32 v[16:17], v[148:149], v[100:101], v[16:17]
  s_waitcnt lgkmcnt(10)
  v_pk_fma_f32 v[22:23], v[150:151], v[96:97], v[22:23]
  v_pk_fma_f32 v[20:21], v[150:151], v[98:99], v[20:21]
  v_pk_fma_f32 v[18:19], v[150:151], v[100:101], v[18:19]
  v_pk_fma_f32 v[16:17], v[150:151], v[102:103], v[16:17]
  buffer_load_dwordx4 a[252:255], v1, s[8:11], s46 offen offset:3072
  s_waitcnt lgkmcnt(9)
  v_pk_fma_f32 v[24:25], v[152:153], v[96:97], v[24:25]
  v_pk_fma_f32 v[22:23], v[152:153], v[98:99], v[22:23]
  v_pk_fma_f32 v[20:21], v[152:153], v[100:101], v[20:21]
  v_pk_fma_f32 v[18:19], v[152:153], v[102:103], v[18:19]
  v_pk_fma_f32 v[16:17], v[152:153], v[104:105], v[16:17]
  s_waitcnt lgkmcnt(8)
  v_pk_fma_f32 v[26:27], v[154:155], v[96:97], v[26:27]
  v_pk_fma_f32 v[24:25], v[154:155], v[98:99], v[24:25]
  v_pk_fma_f32 v[22:23], v[154:155], v[100:101], v[22:23]
  v_pk_fma_f32 v[20:21], v[154:155], v[102:103], v[20:21]
  v_pk_fma_f32 v[18:19], v[154:155], v[104:105], v[18:19]
  v_pk_fma_f32 v[16:17], v[154:155], v[106:107], v[16:17]
  s_waitcnt lgkmcnt(7)
  v_pk_fma_f32 v[28:29], v[156:157], v[96:97], v[28:29]
  v_pk_fma_f32 v[26:27], v[156:157], v[98:99], v[26:27]
  v_pk_fma_f32 v[24:25], v[156:157], v[100:101], v[24:25]
  s_addk_i32 s46, 0x1000
  buffer_load_dwordx4 a[128:131], v1, s[8:11], s46 offen offset:0
  v_pk_fma_f32 v[22:23], v[156:157], v[102:103], v[22:23]
  v_pk_fma_f32 v[20:21], v[156:157], v[104:105], v[20:21]
  v_pk_fma_f32 v[18:19], v[156:157], v[106:107], v[18:19]
  v_pk_fma_f32 v[16:17], v[156:157], v[108:109], v[16:17]
  s_waitcnt lgkmcnt(6)
  v_pk_fma_f32 v[30:31], v[128:129], v[112:113], v[30:31]
  v_pk_fma_f32 v[28:29], v[128:129], v[114:115], v[28:29]
  v_pk_fma_f32 v[26:27], v[128:129], v[116:117], v[26:27]
  v_pk_fma_f32 v[24:25], v[128:129], v[118:119], v[24:25]
  v_pk_fma_f32 v[22:23], v[128:129], v[120:121], v[22:23]
  v_pk_fma_f32 v[20:21], v[128:129], v[122:123], v[20:21]
  v_pk_fma_f32 v[18:19], v[128:129], v[124:125], v[18:19]
  s_waitcnt lgkmcnt(5)
  v_pk_fma_f32 v[30:31], v[130:131], v[114:115], v[30:31]
  v_pk_fma_f32 v[28:29], v[130:131], v[116:117], v[28:29]
  v_pk_fma_f32 v[26:27], v[130:131], v[118:119], v[26:27]
  buffer_load_dwordx4 a[132:135], v1, s[8:11], s46 offen offset:1024
  v_pk_fma_f32 v[24:25], v[130:131], v[120:121], v[24:25]
  v_pk_fma_f32 v[22:23], v[130:131], v[122:123], v[22:23]
  v_pk_fma_f32 v[20:21], v[130:131], v[124:125], v[20:21]
  s_waitcnt lgkmcnt(4)
  v_pk_fma_f32 v[30:31], v[132:133], v[116:117], v[30:31]
  v_pk_fma_f32 v[28:29], v[132:133], v[118:119], v[28:29]
  v_pk_fma_f32 v[26:27], v[132:133], v[120:121], v[26:27]
  v_pk_fma_f32 v[24:25], v[132:133], v[122:123], v[24:25]
  v_pk_fma_f32 v[22:23], v[132:133], v[124:125], v[22:23]
  s_waitcnt lgkmcnt(3)
  v_pk_fma_f32 v[30:31], v[134:135], v[118:119], v[30:31]
  v_pk_fma_f32 v[28:29], v[134:135], v[120:121], v[28:29]
  v_pk_fma_f32 v[26:27], v[134:135], v[122:123], v[26:27]
  v_pk_fma_f32 v[24:25], v[134:135], v[124:125], v[24:25]
  s_waitcnt lgkmcnt(2)
  v_pk_fma_f32 v[30:31], v[136:137], v[120:121], v[30:31]
  v_pk_fma_f32 v[28:29], v[136:137], v[122:123], v[28:29]
  buffer_load_dwordx4 a[136:139], v1, s[8:11], s46 offen offset:2048
  v_pk_fma_f32 v[26:27], v[136:137], v[124:125], v[26:27]
  s_waitcnt lgkmcnt(1)
  v_pk_fma_f32 v[30:31], v[138:139], v[122:123], v[30:31]
  v_pk_fma_f32 v[28:29], v[138:139], v[124:125], v[28:29]
  s_waitcnt lgkmcnt(0)
  v_pk_fma_f32 v[30:31], v[140:141], v[124:125], v[30:31]
  v_exp_f32 v32, v16
  v_exp_f32 v33, v17
  v_exp_f32 v34, v18
  v_exp_f32 v35, v19
  v_exp_f32 v36, v20
  v_exp_f32 v37, v21
  buffer_load_dwordx4 a[140:143], v1, s[8:11], s46 offen offset:3072
  v_exp_f32 v38, v22
  v_exp_f32 v39, v23
  v_pk_add_f32 v[32:33], v[32:33], 1.0 op_sel_hi:[1,0]
  v_pk_add_f32 v[34:35], v[34:35], 1.0 op_sel_hi:[1,0]
  v_pk_add_f32 v[36:37], v[36:37], 1.0 op_sel_hi:[1,0]
  v_pk_add_f32 v[38:39], v[38:39], 1.0 op_sel_hi:[1,0]
  v_rcp_f32 v32, v32
  v_rcp_f32 v33, v33
  v_rcp_f32 v34, v34
  s_addk_i32 s46, 0x1000
  buffer_load_dwordx4 a[192:195], v1, s[8:11], s46 offen offset:0
  v_rcp_f32 v35, v35
  v_rcp_f32 v36, v36
  v_rcp_f32 v37, v37
  v_rcp_f32 v38, v38
  v_rcp_f32 v39, v39
  v_pk_mul_f32 v[16:17], v[16:17], v[32:33]
  v_pk_mul_f32 v[18:19], v[18:19], v[34:35]
  v_pk_mul_f32 v[20:21], v[20:21], v[36:37]
  v_pk_mul_f32 v[22:23], v[22:23], v[38:39]
  buffer_load_dwordx4 a[196:199], v1, s[8:11], s46 offen offset:1024
  v_cvt_pk_bf16_f32 v16, v16, v17
  v_cvt_pk_bf16_f32 v18, v18, v19
  v_cvt_pk_bf16_f32 v20, v20, v21
  v_cvt_pk_bf16_f32 v22, v22, v23
  ds_write_b32 v9, v16 offset:0
  ds_write_b32 v9, v18 offset:16
  ds_write_b32 v9, v20 offset:32
  ds_write_b32 v9, v22 offset:48
  v_exp_f32 v32, v24
  v_exp_f32 v33, v25
  s_waitcnt vmcnt(11)
  v_max3_u32 v222, v232, v233, v234
  buffer_load_dwordx4 a[200:203], v1, s[8:11], s46 offen offset:2048
  s_waitcnt vmcnt(11)
  v_max3_u32 v222, v222, v235, v236
  v_max3_u32 v222, v222, v237, v238
  v_max_u32 v222, v222, v239
  v_cmp_eq_u32 vcc, -1, v222
  s_nop 3
  s_cbranch_vccnz C_rh1
C_gh1:
  ds_write_b128 v7, v[232:235] offset:16
  v_and_b32 v236, s61, v236
  v_and_b32 v237, s61, v237
  v_and_b32 v238, s61, v238
  v_and_b32 v239, s61, v239
  buffer_load_dwordx4 a[204:207], v1, s[8:11], s46 offen offset:3072
  ds_write_b128 v7, v[236:239] offset:10896
  ds_read_b64 v[176:177], v8 offset:16
  ds_read_b64 v[178:179], v8 offset:288
  ds_read_b64 v[180:181], v8 offset:560
  ds_read_b64 v[182:183], v8 offset:832
  ds_read_b64 v[184:185], v8 offset:1104
  ds_read_b64 v[186:187], v8 offset:1376
  ds_read_b64 v[188:189], v8 offset:1648
  ds_read_b64 v[160:161], v8 offset:4096
  ds_read_b64 v[162:163], v8 offset:4368
  s_add_u32 s46, s62, 0x20000
  buffer_load_dwordx4 a[0:3], v1, s[8:11], s46 offen offset:0
  ds_read_b64 v[164:165], v8 offset:4640
  ds_read_b64 v[166:167], v8 offset:4912
  ds_read_b64 v[168:169], v8 offset:5184
  ds_read_b64 v[170:171], v8 offset:5456
  ds_read_b64 v[172:173], v8 offset:5728
  v_exp_f32 v34, v26
  v_exp_f32 v35, v27
  v_exp_f32 v36, v28
  v_exp_f32 v37, v29
  v_exp_f32 v38, v30
  buffer_load_dwordx4 a[4:7], v1, s[8:11], s46 offen offset:1024
  v_exp_f32 v39, v31
  v_pk_add_f32 v[32:33], v[32:33], 1.0 op_sel_hi:[1,0]
  v_pk_add_f32 v[34:35], v[34:35], 1.0 op_sel_hi:[1,0]
  v_pk_add_f32 v[36:37], v[36:37], 1.0 op_sel_hi:[1,0]
  v_pk_add_f32 v[38:39], v[38:39], 1.0 op_sel_hi:[1,0]
  v_rcp_f32 v32, v32
  v_rcp_f32 v33, v33
  v_rcp_f32 v34, v34
  v_rcp_f32 v35, v35
  buffer_load_dwordx4 a[8:11], v1, s[8:11], s46 offen offset:2048
  v_rcp_f32 v36, v36
  v_rcp_f32 v37, v37
  v_rcp_f32 v38, v38
  v_rcp_f32 v39, v39
  v_pk_mul_f32 v[24:25], v[24:25], v[32:33]
  v_pk_mul_f32 v[26:27], v[26:27], v[34:35]
  v_pk_mul_f32 v[28:29], v[28:29], v[36:37]
  v_pk_mul_f32 v[30:31], v[30:31], v[38:39]
  v_cvt_pk_bf16_f32 v24, v24, v25
  v_cvt_pk_bf16_f32 v26, v26, v27
  buffer_load_dwordx4 a[12:15], v1, s[8:11], s46 offen offset:3072
  v_cvt_pk_bf16_f32 v28, v28, v29
  v_cvt_pk_bf16_f32 v30, v30, v31
  ds_write_b32 v9, v24 offset:64
  ds_write_b32 v9, v26 offset:80
  ds_write_b32 v9, v28 offset:96
  ds_write_b32 v9, v30 offset:112
  s_waitcnt lgkmcnt(15)
  v_pk_fma_f32 v[240:241], v[176:177], v[192:193], v[240:241]
  s_waitcnt lgkmcnt(15)
  v_pk_fma_f32 v[242:243], v[178:179], v[192:193], v[242:243]
  v_pk_fma_f32 v[240:241], v[178:179], v[194:195], v[240:241]
  s_waitcnt lgkmcnt(15)
  v_pk_fma_f32 v[244:245], v[180:181], v[192:193], v[244:245]
  v_pk_fma_f32 v[242:243], v[180:181], v[194:195], v[242:243]
  buffer_store_dwordx4 v[56:59], v2, s[8:11], s64 offen offset:0 sc1
  v_pk_fma_f32 v[240:241], v[180:181], v[196:197], v[240:241]
  s_waitcnt lgkmcnt(14)
  v_pk_fma_f32 v[246:247], v[182:183], v[192:193], v[246:247]
  v_pk_fma_f32 v[244:245], v[182:183], v[194:195], v[244:245]
  v_pk_fma_f32 v[242:243], v[182:183], v[196:197], v[242:243]
  v_pk_fma_f32 v[240:241], v[182:183], v[198:199], v[240:241]
  s_waitcnt lgkmcnt(13)
  v_pk_fma_f32 v[248:249], v[184:185], v[192:193], v[248:249]
  v_pk_fma_f32 v[246:247], v[184:185], v[194:195], v[246:247]
  v_pk_fma_f32 v[244:245], v[184:185], v[196:197], v[244:245]
  v_pk_fma_f32 v[242:243], v[184:185], v[198:199], v[242:243]
  v_pk_fma_f32 v[240:241], v[184:185], v[200:201], v[240:241]
  s_waitcnt lgkmcnt(12)
  v_pk_fma_f32 v[250:251], v[186:187], v[192:193], v[250:251]
  v_pk_fma_f32 v[248:249], v[186:187], v[194:195], v[248:249]
  v_pk_fma_f32 v[246:247], v[186:187], v[196:197], v[246:247]
  buffer_store_dwordx4 v[56:59], v2, s[8:11], s64 offen offset:1024 sc1
  v_pk_fma_f32 v[244:245], v[186:187], v[198:199], v[244:245]
  v_pk_fma_f32 v[242:243], v[186:187], v[200:201], v[242:243]
  v_pk_fma_f32 v[240:241], v[186:187], v[202:203], v[240:241]
  s_waitcnt lgkmcnt(11)
  v_pk_fma_f32 v[252:253], v[188:189], v[192:193], v[252:253]
  v_pk_fma_f32 v[250:251], v[188:189], v[194:195], v[250:251]
  v_pk_fma_f32 v[248:249], v[188:189], v[196:197], v[248:249]
  v_pk_fma_f32 v[246:247], v[188:189], v[198:199], v[246:247]
  v_pk_fma_f32 v[244:245], v[188:189], v[200:201], v[244:245]
  v_pk_fma_f32 v[242:243], v[188:189], v[202:203], v[242:243]
  v_pk_fma_f32 v[240:241], v[188:189], v[204:205], v[240:241]
  s_waitcnt lgkmcnt(10)
  v_pk_fma_f32 v[254:255], v[160:161], v[208:209], v[254:255]
  v_pk_fma_f32 v[252:253], v[160:161], v[210:211], v[252:253]
  v_pk_fma_f32 v[250:251], v[160:161], v[212:213], v[250:251]
  buffer_store_dwordx4 v[56:59], v2, s[8:11], s64 offen offset:2048 sc1
  v_pk_fma_f32 v[248:249], v[160:161], v[214:215], v[248:249]
  v_pk_fma_f32 v[246:247], v[160:161], v[216:217], v[246:247]
  v_pk_fma_f32 v[244:245], v[160:161], v[218:219], v[244:245]
  v_pk_fma_f32 v[242:243], v[160:161], v[220:221], v[242:243]
  s_waitcnt lgkmcnt(9)
  v_pk_fma_f32 v[254:255], v[162:163], v[210:211], v[254:255]
  v_pk_fma_f32 v[252:253], v[162:163], v[212:213], v[252:253]
  v_pk_fma_f32 v[250:251], v[162:163], v[214:215], v[250:251]
  v_pk_fma_f32 v[248:249], v[162:163], v[216:217], v[248:249]
  v_pk_fma_f32 v[246:247], v[162:163], v[218:219], v[246:247]
  v_pk_fma_f32 v[244:245], v[162:163], v[220:221], v[244:245]
  s_waitcnt lgkmcnt(8)
  v_pk_fma_f32 v[254:255], v[164:165], v[212:213], v[254:255]
  v_pk_fma_f32 v[252:253], v[164:165], v[214:215], v[252:253]
  v_pk_fma_f32 v[250:251], v[164:165], v[216:217], v[250:251]
  buffer_store_dwordx4 v[56:59], v2, s[8:11], s64 offen offset:3072 sc1
  v_pk_fma_f32 v[248:249], v[164:165], v[218:219], v[248:249]
  v_pk_fma_f32 v[246:247], v[164:165], v[220:221], v[246:247]
  s_waitcnt lgkmcnt(7)
  v_pk_fma_f32 v[254:255], v[166:167], v[214:215], v[254:255]
  v_pk_fma_f32 v[252:253], v[166:167], v[216:217], v[252:253]
  v_pk_fma_f32 v[250:251], v[166:167], v[218:219], v[250:251]
  v_pk_fma_f32 v[248:249], v[166:167], v[220:221], v[248:249]
  s_waitcnt lgkmcnt(6)
  v_pk_fma_f32 v[254:255], v[168:169], v[216:217], v[254:255]
  v_pk_fma_f32 v[252:253], v[168:169], v[218:219], v[252:253]
  v_pk_fma_f32 v[250:251], v[168:169], v[220:221], v[250:251]
  s_waitcnt lgkmcnt(5)
  v_pk_fma_f32 v[254:255], v[170:171], v[218:219], v[254:255]
  v_pk_fma_f32 v[252:253], v[170:171], v[220:221], v[252:253]
  s_waitcnt lgkmcnt(4)
  v_pk_fma_f32 v[254:255], v[172:173], v[220:221], v[254:255]
  v_exp_f32 v32, v240
  v_exp_f32 v33, v241
  v_exp_f32 v34, v242
  v_exp_f32 v35, v243
  v_exp_f32 v36, v244
  s_addk_i32 s46, 0x1000
  buffer_load_dwordx4 a[16:19], v1, s[8:11], s46 offen offset:0
  v_exp_f32 v37, v245
  v_exp_f32 v38, v246
  v_exp_f32 v39, v247
  v_pk_add_f32 v[32:33], v[32:33], 1.0 op_sel_hi:[1,0]
  v_pk_add_f32 v[34:35], v[34:35], 1.0 op_sel_hi:[1,0]
  v_pk_add_f32 v[36:37], v[36:37], 1.0 op_sel_hi:[1,0]
  v_pk_add_f32 v[38:39], v[38:39], 1.0 op_sel_hi:[1,0]
  v_rcp_f32 v32, v32
  v_rcp_f32 v33, v33
  buffer_load_dwordx4 a[20:23], v1, s[8:11], s46 offen offset:1024
  v_rcp_f32 v34, v34
  v_rcp_f32 v35, v35
  v_rcp_f32 v36, v36
  v_rcp_f32 v37, v37
  v_rcp_f32 v38, v38
  v_rcp_f32 v39, v39
  v_pk_mul_f32 v[240:241], v[240:241], v[32:33]
  v_pk_mul_f32 v[242:243], v[242:243], v[34:35]
  buffer_load_dwordx4 a[24:27], v1, s[8:11], s46 offen offset:2048
  v_pk_mul_f32 v[244:245], v[244:245], v[36:37]
  v_pk_mul_f32 v[246:247], v[246:247], v[38:39]
  v_cvt_pk_bf16_f32 v240, v240, v241
  v_cvt_pk_bf16_f32 v242, v242, v243
  v_cvt_pk_bf16_f32 v244, v244, v245
  v_cvt_pk_bf16_f32 v246, v246, v247
  ds_write_b32 v9, v240 offset:8
  ds_write_b32 v9, v242 offset:24
  ds_write_b32 v9, v244 offset:40
  ds_write_b32 v9, v246 offset:56
  v_exp_f32 v32, v248
  v_exp_f32 v33, v249
  buffer_load_dwordx4 a[28:31], v1, s[8:11], s46 offen offset:3072
  v_exp_f32 v34, v250
  v_exp_f32 v35, v251
  v_exp_f32 v36, v252
  v_exp_f32 v37, v253
  v_exp_f32 v38, v254
  v_exp_f32 v39, v255
  v_pk_add_f32 v[32:33], v[32:33], 1.0 op_sel_hi:[1,0]
  v_pk_add_f32 v[34:35], v[34:35], 1.0 op_sel_hi:[1,0]
  s_addk_i32 s46, 0x1000
  buffer_load_dwordx4 a[144:147], v1, s[8:11], s46 offen offset:0
  v_pk_add_f32 v[36:37], v[36:37], 1.0 op_sel_hi:[1,0]
  v_pk_add_f32 v[38:39], v[38:39], 1.0 op_sel_hi:[1,0]
  v_rcp_f32 v32, v32
  v_rcp_f32 v33, v33
  v_rcp_f32 v34, v34
  v_rcp_f32 v35, v35
  v_rcp_f32 v36, v36
  v_rcp_f32 v37, v37
  buffer_load_dwordx4 a[148:151], v1, s[8:11], s46 offen offset:1024
  v_rcp_f32 v38, v38
  v_rcp_f32 v39, v39
  v_pk_mul_f32 v[248:249], v[248:249], v[32:33]
  v_pk_mul_f32 v[250:251], v[250:251], v[34:35]
  v_pk_mul_f32 v[252:253], v[252:253], v[36:37]
  v_pk_mul_f32 v[254:255], v[254:255], v[38:39]
  v_cvt_pk_bf16_f32 v248, v248, v249
  v_cvt_pk_bf16_f32 v250, v250, v251
  v_cvt_pk_bf16_f32 v252, v252, v253
  v_cvt_pk_bf16_f32 v254, v254, v255
  ds_write_b32 v9, v248 offset:72
  ds_write_b32 v9, v250 offset:88
  buffer_load_dwordx4 a[152:155], v1, s[8:11], s46 offen offset:2048
  ds_write_b32 v9, v252 offset:104
  ds_write_b32 v9, v254 offset:120
  s_waitcnt lgkmcnt(0)
  buffer_load_dwordx4 a[156:159], v1, s[8:11], s46 offen offset:3072
  s_barrier
  ds_read_b128 v[192:195], v10 offset:0
  s_addk_i32 s46, 0x1000
  buffer_load_dwordx4 a[32:35], v1, s[8:11], s46 offen offset:0
  s_waitcnt lgkmcnt(0)
  v_mfma_f32_32x32x16_bf16 v[64:79], a[80:83], v[192:195], v[64:79]
  ds_read_b128 v[196:199], v10 offset:1104
  ds_read_b128 v[200:203], v10 offset:2208
  ds_read_b128 v[204:207], v10 offset:3312
  ds_read_b128 v[208:211], v10 offset:4416
  ds_read_b128 v[212:215], v10 offset:5520
  ds_read_b128 v[216:219], v10 offset:6624
  v_mfma_f32_32x32x16_bf16 v[80:95], a[84:87], v[192:195], v[80:95]
  buffer_load_dwordx4 a[36:39], v1, s[8:11], s46 offen offset:1024
  s_waitcnt lgkmcnt(5)
  v_mfma_f32_32x32x16_bf16 v[64:79], a[88:91], v[196:199], v[64:79]
  ds_read_b128 v[220:223], v10 offset:7728
  v_mfma_f32_32x32x16_bf16 v[80:95], a[92:95], v[196:199], v[80:95]
  s_waitcnt lgkmcnt(4)
  v_mfma_f32_32x32x16_bf16 v[64:79], a[208:211], v[200:203], v[64:79]
  buffer_load_dwordx4 a[40:43], v1, s[8:11], s46 offen offset:2048
  ds_read_b128 v[224:227], v10 offset:8832
  v_mfma_f32_32x32x16_bf16 v[80:95], a[212:215], v[200:203], v[80:95]
  v_mfma_f32_32x32x16_bf16 v[64:79], a[216:219], v[204:207], v[64:79]
  ds_read_b128 v[228:231], v10 offset:9936
  buffer_load_dwordx4 a[160:163], v1, s[8:11], s46 offen offset:3072
  v_mfma_f32_32x32x16_bf16 v[80:95], a[220:223], v[204:207], v[80:95]
  s_addk_i32 s46, 0x1000
  s_waitcnt lgkmcnt(4)
  v_mfma_f32_32x32x16_bf16 v[64:79], a[96:99], v[208:211], v[64:79]
  ds_read_b128 v[232:235], v10 offset:11040
  buffer_load_dwordx4 a[164:167], v1, s[8:11], s46 offen offset:0
  v_mfma_f32_32x32x16_bf16 v[80:95], a[100:103], v[208:211], v[80:95]
  v_mfma_f32_32x32x16_bf16 v[64:79], a[104:107], v[212:215], v[64:79]
  ds_read_b128 v[236:239], v10 offset:12144
  buffer_load_dwordx4 a[168:171], v1, s[8:11], s46 offen offset:1024
  v_mfma_f32_32x32x16_bf16 v[80:95], a[108:111], v[212:215], v[80:95]
  s_waitcnt lgkmcnt(4)
  v_mfma_f32_32x32x16_bf16 v[64:79], a[112:115], v[216:219], v[64:79]
  ds_read_b128 v[240:243], v10 offset:13248
  v_mfma_f32_32x32x16_bf16 v[80:95], a[224:227], v[216:219], v[80:95]
  buffer_load_dwordx4 a[172:175], v1, s[8:11], s46 offen offset:2048
  v_mfma_f32_32x32x16_bf16 v[64:79], a[228:231], v[220:223], v[64:79]
  ds_read_b128 v[244:247], v10 offset:14352
  v_mfma_f32_32x32x16_bf16 v[80:95], a[232:235], v[220:223], v[80:95]
  buffer_load_dwordx4 a[44:47], v1, s[8:11], s46 offen offset:3072
  s_waitcnt lgkmcnt(4)
  v_mfma_f32_32x32x16_bf16 v[64:79], a[236:239], v[224:227], v[64:79]
  ds_read_b128 v[248:251], v10 offset:15456
  s_addk_i32 s46, 0x1000
  v_mfma_f32_32x32x16_bf16 v[80:95], a[116:119], v[224:227], v[80:95]
  buffer_load_dwordx4 a[48:51], v1, s[8:11], s46 offen offset:0
  v_mfma_f32_32x32x16_bf16 v[64:79], a[120:123], v[228:231], v[64:79]
  ds_read_b128 v[252:255], v10 offset:16560
  v_mfma_f32_32x32x16_bf16 v[80:95], a[124:127], v[228:231], v[80:95]
  buffer_load_dwordx4 a[52:55], v1, s[8:11], s46 offen offset:1024
  s_waitcnt vmcnt(34) lgkmcnt(4)
  v_mfma_f32_32x32x16_bf16 v[64:79], a[240:243], v[232:235], v[64:79]
  v_mfma_f32_32x32x16_bf16 v[80:95], a[244:247], v[232:235], v[80:95]
  v_mfma_f32_32x32x16_bf16 v[64:79], a[248:251], v[236:239], v[64:79]
  buffer_load_dwordx4 a[56:59], v1, s[8:11], s46 offen offset:2048
  v_mfma_f32_32x32x16_bf16 v[80:95], a[252:255], v[236:239], v[80:95]
  s_waitcnt vmcnt(31) lgkmcnt(2)
  v_mfma_f32_32x32x16_bf16 v[64:79], a[128:131], v[240:243], v[64:79]
  buffer_load_dwordx4 a[60:63], v1, s[8:11], s46 offen offset:3072
  v_mfma_f32_32x32x16_bf16 v[80:95], a[132:135], v[240:243], v[80:95]
  s_addk_i32 s46, 0x1000
  v_mfma_f32_32x32x16_bf16 v[64:79], a[136:139], v[244:247], v[64:79]
  buffer_load_dwordx4 a[176:179], v1, s[8:11], s46 offen offset:0
  v_mfma_f32_32x32x16_bf16 v[80:95], a[140:143], v[244:247], v[80:95]
  s_waitcnt vmcnt(29) lgkmcnt(0)
  v_mfma_f32_32x32x16_bf16 v[64:79], a[192:195], v[248:251], v[64:79]
  buffer_load_dwordx4 a[180:183], v1, s[8:11], s46 offen offset:1024
  v_mfma_f32_32x32x16_bf16 v[80:95], a[196:199], v[248:251], v[80:95]
  v_mfma_f32_32x32x16_bf16 v[64:79], a[200:203], v[252:255], v[64:79]
  v_mfma_f32_32x32x16_bf16 v[80:95], a[204:207], v[252:255], v[80:95]
  buffer_load_dwordx4 a[184:187], v1, s[8:11], s46 offen offset:2048
  s_nop 9
  v_pk_add_f32 v[40:41], v[64:65], v[66:67]
  v_pk_mul_f32 v[42:43], v[64:65], v[64:65]
  v_pk_fma_f32 v[42:43], v[66:67], v[66:67], v[42:43]
  v_pk_add_f32 v[40:41], v[40:41], v[68:69]
  v_pk_fma_f32 v[42:43], v[68:69], v[68:69], v[42:43]
  buffer_load_dwordx4 a[188:191], v1, s[8:11], s46 offen offset:3072
  v_pk_add_f32 v[40:41], v[40:41], v[70:71]
  v_pk_fma_f32 v[42:43], v[70:71], v[70:71], v[42:43]
  v_pk_add_f32 v[40:41], v[40:41], v[72:73]
  v_pk_fma_f32 v[42:43], v[72:73], v[72:73], v[42:43]
  v_pk_add_f32 v[40:41], v[40:41], v[74:75]
  v_pk_fma_f32 v[42:43], v[74:75], v[74:75], v[42:43]
  v_pk_add_f32 v[40:41], v[40:41], v[76:77]
  v_pk_fma_f32 v[42:43], v[76:77], v[76:77], v[42:43]
  v_pk_add_f32 v[40:41], v[40:41], v[78:79]
  v_pk_fma_f32 v[42:43], v[78:79], v[78:79], v[42:43]
  v_pk_add_f32 v[40:41], v[40:41], v[80:81]
  v_pk_fma_f32 v[42:43], v[80:81], v[80:81], v[42:43]
  v_pk_add_f32 v[40:41], v[40:41], v[82:83]
  v_pk_fma_f32 v[42:43], v[82:83], v[82:83], v[42:43]
  s_addk_i32 s46, 0x1000
  buffer_load_dwordx4 a[64:67], v1, s[8:11], s46 offen offset:0
  v_pk_add_f32 v[40:41], v[40:41], v[84:85]
  v_pk_fma_f32 v[42:43], v[84:85], v[84:85], v[42:43]
  v_pk_add_f32 v[40:41], v[40:41], v[86:87]
  v_pk_fma_f32 v[42:43], v[86:87], v[86:87], v[42:43]
  v_pk_add_f32 v[40:41], v[40:41], v[88:89]
  v_pk_fma_f32 v[42:43], v[88:89], v[88:89], v[42:43]
  v_pk_add_f32 v[40:41], v[40:41], v[90:91]
  v_pk_fma_f32 v[42:43], v[90:91], v[90:91], v[42:43]
  v_pk_add_f32 v[40:41], v[40:41], v[92:93]
  v_pk_fma_f32 v[42:43], v[92:93], v[92:93], v[42:43]
  v_pk_add_f32 v[40:41], v[40:41], v[94:95]
  v_pk_fma_f32 v[42:43], v[94:95], v[94:95], v[42:43]
  v_add_f32 v32, v40, v41
  v_add_f32 v33, v42, v43
  buffer_load_dwordx4 a[68:71], v1, s[8:11], s46 offen offset:1024
  s_nop 0
  v_permlane32_swap_b32 v32, v33
  v_add_f32 v32, v32, v33
  ds_write_b32 v3, v32 offset:3072
  s_waitcnt lgkmcnt(0)
  buffer_load_dwordx4 a[72:75], v1, s[8:11], s46 offen offset:2048
  s_barrier
  buffer_load_dwordx4 a[76:79], v1, s[8:11], s46 offen offset:3072
  ds_read_b128 v[160:163], v4 offset:3072
  ds_read_b128 v[164:167], v4 offset:3088
  s_waitcnt lgkmcnt(1)
  v_pk_add_f32 v[160:161], v[160:161], v[162:163]
  s_waitcnt lgkmcnt(0)
  v_pk_add_f32 v[164:165], v[164:165], v[166:167]
  v_pk_add_f32 v[160:161], v[160:161], v[164:165]
  v_mul_f32 v162, 0xbb317218, v160
  v_mul_f32 v161, 0x3af5fdf0, v161
  v_fma_f32 v161, -v162, v162, v161
  v_max_f32 v161, 0, v161
  v_add_f32 v161, s39, v161
  v_rsq_f32 v33, v161
  v_mul_f32 v162, 0x3fb8aa3b, v162
  s_addk_i32 s46, 0x1000
  buffer_load_dwordx4 a[80:83], v1, s[8:11], s46 offen offset:0
  v_mul_f32 v32, v162, v33
  buffer_load_dwordx4 a[84:87], v1, s[8:11], s46 offen offset:1024
  v_pk_fma_f32 v[96:97], v[64:65], v[32:33], v[32:33] op_sel:[0,1,0] op_sel_hi:[1,1,0]
  v_pk_fma_f32 v[98:99], v[66:67], v[32:33], v[32:33] op_sel:[0,1,0] op_sel_hi:[1,1,0]
  v_pk_fma_f32 v[100:101], v[68:69], v[32:33], v[32:33] op_sel:[0,1,0] op_sel_hi:[1,1,0]
  v_pk_fma_f32 v[102:103], v[70:71], v[32:33], v[32:33] op_sel:[0,1,0] op_sel_hi:[1,1,0]
  v_pk_fma_f32 v[104:105], v[72:73], v[32:33], v[32:33] op_sel:[0,1,0] op_sel_hi:[1,1,0]
  v_pk_fma_f32 v[106:107], v[74:75], v[32:33], v[32:33] op_sel:[0,1,0] op_sel_hi:[1,1,0]
  v_pk_fma_f32 v[108:109], v[76:77], v[32:33], v[32:33] op_sel:[0,1,0] op_sel_hi:[1,1,0]
  v_pk_fma_f32 v[110:111], v[78:79], v[32:33], v[32:33] op_sel:[0,1,0] op_sel_hi:[1,1,0]
  v_pk_fma_f32 v[112:113], v[80:81], v[32:33], v[32:33] op_sel:[0,1,0] op_sel_hi:[1,1,0]
  buffer_load_dwordx4 a[88:91], v1, s[8:11], s46 offen offset:2048
  v_pk_fma_f32 v[114:115], v[82:83], v[32:33], v[32:33] op_sel:[0,1,0] op_sel_hi:[1,1,0]
  v_pk_fma_f32 v[116:117], v[84:85], v[32:33], v[32:33] op_sel:[0,1,0] op_sel_hi:[1,1,0]
  v_pk_fma_f32 v[118:119], v[86:87], v[32:33], v[32:33] op_sel:[0,1,0] op_sel_hi:[1,1,0]
  v_pk_fma_f32 v[120:121], v[88:89], v[32:33], v[32:33] op_sel:[0,1,0] op_sel_hi:[1,1,0]
  v_pk_fma_f32 v[122:123], v[90:91], v[32:33], v[32:33] op_sel:[0,1,0] op_sel_hi:[1,1,0]
  v_pk_fma_f32 v[124:125], v[92:93], v[32:33], v[32:33] op_sel:[0,1,0] op_sel_hi:[1,1,0]
  v_pk_fma_f32 v[126:127], v[94:95], v[32:33], v[32:33] op_sel:[0,1,0] op_sel_hi:[1,1,0]
  v_cvt_pk_bf16_f32 v40, v96, v100
  v_cvt_pk_bf16_f32 v41, v104, v108
  v_cvt_pk_bf16_f32 v42, v112, v116
  v_cvt_pk_bf16_f32 v43, v120, v124
  s_waitcnt vmcnt(31)
  buffer_store_dwordx4 v[40:43], v1, s[8:11], s65 offen offset:0 sc1
  v_cvt_pk_bf16_f32 v44, v97, v101
  v_cvt_pk_bf16_f32 v45, v105, v109
  v_cvt_pk_bf16_f32 v46, v113, v117
  v_cvt_pk_bf16_f32 v47, v121, v125
  buffer_store_dwordx4 v[44:47], v1, s[8:11], s65 offen offset:1024 sc1
  v_cvt_pk_bf16_f32 v48, v98, v102
  v_cvt_pk_bf16_f32 v49, v106, v110
  v_cvt_pk_bf16_f32 v50, v114, v118
  v_cvt_pk_bf16_f32 v51, v122, v126
  buffer_store_dwordx4 v[48:51], v1, s[8:11], s65 offen offset:2048 sc1
  v_cvt_pk_bf16_f32 v52, v99, v103
  v_cvt_pk_bf16_f32 v53, v107, v111
  v_cvt_pk_bf16_f32 v54, v115, v119
  v_cvt_pk_bf16_f32 v55, v123, v127
  buffer_store_dwordx4 v[52:55], v1, s[8:11], s65 offen offset:3072 sc1
  ds_write_b128 v5, v[40:43] offset:0
  ds_write_b128 v5, v[44:47] offset:1024
  ds_write_b128 v5, v[48:51] offset:2048
  ds_write_b128 v5, v[52:55] offset:3072
  buffer_load_dwordx4 a[92:95], v1, s[8:11], s46 offen offset:3072
  s_waitcnt lgkmcnt(0)
  s_addk_i32 s46, 0x1000
  buffer_load_dwordx4 a[208:211], v1, s[8:11], s46 offen offset:0
  s_barrier
  buffer_load_dwordx4 a[212:215], v1, s[8:11], s46 offen offset:1024
  ds_read_b128 v[224:227], v1 offset:0
  s_waitcnt lgkmcnt(0)
  v_mfma_f32_32x32x16_bf16 v[96:111], a[0:3], v[224:227], 0
  ds_read_b128 v[228:231], v1 offset:1024
  ds_read_b128 v[232:235], v1 offset:2048
  ds_read_b128 v[236:239], v1 offset:3072
  ds_read_b128 v[240:243], v1 offset:4096
  ds_read_b128 v[244:247], v1 offset:5120
  buffer_load_dwordx4 a[216:219], v1, s[8:11], s46 offen offset:2048
  ds_read_b128 v[248:251], v1 offset:6144
  s_lshl_b32 s28, s24, 13
  v_add_u32 v11, s28, v15
  v_mfma_f32_32x32x16_bf16 v[112:127], a[4:7], v[224:227], 0
  s_waitcnt lgkmcnt(5)
  v_mfma_f32_32x32x16_bf16 v[96:111], a[8:11], v[228:231], v[96:111]
  ds_read_b128 v[252:255], v1 offset:7168
  buffer_load_dwordx4 a[220:223], v1, s[8:11], s46 offen offset:3072
  v_mfma_f32_32x32x16_bf16 v[112:127], a[12:15], v[228:231], v[112:127]
  s_addk_i32 s46, 0x1000
  s_waitcnt vmcnt(38) lgkmcnt(4)
  v_mfma_f32_32x32x16_bf16 v[96:111], a[16:19], v[232:235], v[96:111]
  ds_read_b128 v[224:227], v1 offset:8192
  buffer_load_dwordx4 a[96:99], v1, s[8:11], s46 offen offset:0
  v_mfma_f32_32x32x16_bf16 v[112:127], a[20:23], v[232:235], v[112:127]
  s_waitcnt vmcnt(37)
  v_mfma_f32_32x32x16_bf16 v[96:111], a[24:27], v[236:239], v[96:111]
  ds_read_b128 v[228:231], v1 offset:9216
  buffer_load_dwordx4 a[100:103], v1, s[8:11], s46 offen offset:1024
  v_mfma_f32_32x32x16_bf16 v[112:127], a[28:31], v[236:239], v[112:127]
  s_waitcnt vmcnt(36) lgkmcnt(4)
  v_mfma_f32_32x32x16_bf16 v[96:111], a[144:147], v[240:243], v[96:111]
  ds_read_b128 v[232:235], v1 offset:10240
  buffer_load_dwordx4 a[104:107], v1, s[8:11], s46 offen offset:2048
  v_mfma_f32_32x32x16_bf16 v[112:127], a[148:151], v[240:243], v[112:127]
  s_waitcnt vmcnt(35)
  v_mfma_f32_32x32x16_bf16 v[96:111], a[152:155], v[244:247], v[96:111]
  ds_read_b128 v[236:239], v1 offset:11264
  buffer_load_dwordx4 a[108:111], v1, s[8:11], s46 offen offset:3072
  v_mfma_f32_32x32x16_bf16 v[112:127], a[156:159], v[244:247], v[112:127]
  s_addk_i32 s46, 0x1000
  s_waitcnt vmcnt(34) lgkmcnt(4)
  v_mfma_f32_32x32x16_bf16 v[96:111], a[32:35], v[248:251], v[96:111]
  ds_read_b128 v[240:243], v1 offset:12288
  buffer_load_dwordx4 a[112:115], v1, s[8:11], s46 offen offset:0
  v_mfma_f32_32x32x16_bf16 v[112:127], a[36:39], v[248:251], v[112:127]
  s_waitcnt vmcnt(33)
  v_mfma_f32_32x32x16_bf16 v[96:111], a[40:43], v[252:255], v[96:111]
  ds_read_b128 v[244:247], v1 offset:13312
  buffer_load_dwordx4 a[224:227], v1, s[8:11], s46 offen offset:1024
  v_mfma_f32_32x32x16_bf16 v[112:127], a[160:163], v[252:255], v[112:127]
  s_waitcnt vmcnt(32) lgkmcnt(4)
  v_mfma_f32_32x32x16_bf16 v[96:111], a[164:167], v[224:227], v[96:111]
  ds_read_b128 v[248:251], v1 offset:14336
  buffer_load_dwordx4 a[228:231], v1, s[8:11], s46 offen offset:2048
  v_mfma_f32_32x32x16_bf16 v[112:127], a[168:171], v[224:227], v[112:127]
  s_waitcnt vmcnt(31)
  v_mfma_f32_32x32x16_bf16 v[96:111], a[172:175], v[228:231], v[96:111]
  ds_read_b128 v[252:255], v1 offset:15360
  buffer_load_dwordx4 a[232:235], v1, s[8:11], s46 offen offset:3072
  v_mfma_f32_32x32x16_bf16 v[112:127], a[44:47], v[228:231], v[112:127]
  s_addk_i32 s46, 0x1000
  s_waitcnt vmcnt(30) lgkmcnt(4)
  v_mfma_f32_32x32x16_bf16 v[96:111], a[48:51], v[232:235], v[96:111]
  ds_read_b128 v[224:227], v1 offset:0
  buffer_load_dwordx4 a[236:239], v1, s[8:11], s46 offen offset:0
  v_mfma_f32_32x32x16_bf16 v[112:127], a[52:55], v[232:235], v[112:127]
  s_waitcnt vmcnt(29)
  v_mfma_f32_32x32x16_bf16 v[96:111], a[56:59], v[236:239], v[96:111]
  ds_read_b128 v[228:231], v1 offset:1024
  buffer_load_dwordx4 a[116:119], v1, s[8:11], s46 offen offset:1024
  v_mfma_f32_32x32x16_bf16 v[112:127], a[60:63], v[236:239], v[112:127]
  s_waitcnt vmcnt(28) lgkmcnt(4)
  v_mfma_f32_32x32x16_bf16 v[96:111], a[176:179], v[240:243], v[96:111]
  ds_read_b128 v[232:235], v1 offset:2048
  buffer_load_dwordx4 a[120:123], v1, s[8:11], s46 offen offset:2048
  v_mfma_f32_32x32x16_bf16 v[112:127], a[180:183], v[240:243], v[112:127]
  s_waitcnt vmcnt(27)
  v_mfma_f32_32x32x16_bf16 v[96:111], a[184:187], v[244:247], v[96:111]
  ds_read_b128 v[236:239], v1 offset:3072
  buffer_load_dwordx4 a[124:127], v1, s[8:11], s46 offen offset:3072
  v_mfma_f32_32x32x16_bf16 v[112:127], a[188:191], v[244:247], v[112:127]
  s_addk_i32 s46, 0x1000
  s_waitcnt vmcnt(26) lgkmcnt(4)
  v_mfma_f32_32x32x16_bf16 v[96:111], a[64:67], v[248:251], v[96:111]
  ds_read_b128 v[240:243], v1 offset:4096
  buffer_load_dwordx4 a[240:243], v1, s[8:11], s46 offen offset:0
  v_mfma_f32_32x32x16_bf16 v[112:127], a[68:71], v[248:251], v[112:127]
  s_waitcnt vmcnt(25)
  v_mfma_f32_32x32x16_bf16 v[96:111], a[72:75], v[252:255], v[96:111]
  buffer_load_dwordx4 v[16:19], v1, s[8:11], s64 offen offset:0 sc1
  ds_read_b128 v[244:247], v1 offset:5120
  v_mfma_f32_32x32x16_bf16 v[112:127], a[76:79], v[252:255], v[112:127]
  buffer_load_dwordx4 v[20:23], v1, s[8:11], s64 offen offset:1024 sc1
  s_waitcnt vmcnt(25) lgkmcnt(4)
  v_mfma_f32_32x32x16_bf16 v[128:143], a[80:83], v[224:227], 0
  buffer_load_dwordx4 v[24:27], v1, s[8:11], s64 offen offset:2048 sc1
  ds_read_b128 v[248:251], v1 offset:6144
  v_mfma_f32_32x32x16_bf16 v[144:159], a[84:87], v[224:227], 0
  buffer_load_dwordx4 v[28:31], v1, s[8:11], s64 offen offset:3072 sc1
  s_nop 1
  v_exp_f32 v40, v96
  v_exp_f32 v41, v100
  v_exp_f32 v42, v104
  v_exp_f32 v43, v108
  v_exp_f32 v44, v112
  s_waitcnt vmcnt(21)
  v_mfma_f32_32x32x16_bf16 v[128:143], a[88:91], v[228:231], v[128:143]
  ds_read_b128 v[252:255], v1 offset:7168
  buffer_load_dwordx4 a[244:247], v1, s[8:11], s46 offen offset:1024
  v_exp_f32 v45, v116
  v_exp_f32 v46, v120
  v_exp_f32 v47, v124
  v_fma_f32 v40, v40, 2.0, 2.0
  v_fma_f32 v41, v41, 2.0, 2.0
  v_mfma_f32_32x32x16_bf16 v[144:159], a[92:95], v[228:231], v[144:159]
  v_fma_f32 v42, v42, 2.0, 2.0
  v_fma_f32 v43, v43, 2.0, 2.0
  v_fma_f32 v44, v44, 2.0, 2.0
  v_fma_f32 v45, v45, 2.0, 2.0
  v_fma_f32 v46, v46, 2.0, 2.0
  v_fma_f32 v47, v47, 2.0, 2.0
  v_rcp_f32 v40, v40
  s_waitcnt vmcnt(20) lgkmcnt(4)
  v_mfma_f32_32x32x16_bf16 v[128:143], a[208:211], v[232:235], v[128:143]
  buffer_load_dwordx4 a[248:251], v1, s[8:11], s46 offen offset:2048
  ds_read_b128 v[224:227], v1 offset:8192
  v_rcp_f32 v41, v41
  v_rcp_f32 v42, v42
  v_rcp_f32 v43, v43
  v_rcp_f32 v44, v44
  v_rcp_f32 v45, v45
  v_mfma_f32_32x32x16_bf16 v[144:159], a[212:215], v[232:235], v[144:159]
  buffer_load_dwordx4 a[252:255], v1, s[8:11], s46 offen offset:3072
  v_rcp_f32 v46, v46
  v_rcp_f32 v47, v47
  v_mul_f32 v96, v96, v40
  v_mul_f32 v100, v100, v41
  v_mul_f32 v104, v104, v42
  v_mul_f32 v108, v108, v43
  v_mul_f32 v112, v112, v44
  s_addk_i32 s46, 0x1000
  s_waitcnt vmcnt(20)
  v_mfma_f32_32x32x16_bf16 v[128:143], a[216:219], v[236:239], v[128:143]
  buffer_load_dwordx4 a[128:131], v1, s[8:11], s46 offen offset:0
  ds_read_b128 v[228:231], v1 offset:9216
  v_mul_f32 v116, v116, v45
  v_mul_f32 v120, v120, v46
  v_mul_f32 v124, v124, v47
  v_cvt_pk_bf16_f32 v48, v96, v100
  v_cvt_pk_bf16_f32 v49, v104, v108
  v_cvt_pk_bf16_f32 v50, v112, v116
  v_cvt_pk_bf16_f32 v51, v120, v124
  v_mfma_f32_32x32x16_bf16 v[144:159], a[220:223], v[236:239], v[144:159]
  ds_write_b128 v11, v[48:51] offset:0
  buffer_load_dwordx4 a[132:135], v1, s[8:11], s46 offen offset:1024
  v_exp_f32 v40, v97
  v_exp_f32 v41, v101
  s_waitcnt vmcnt(20) lgkmcnt(5)
  v_mfma_f32_32x32x16_bf16 v[128:143], a[96:99], v[240:243], v[128:143]
  buffer_load_dwordx4 a[136:139], v1, s[8:11], s46 offen offset:2048
  ds_read_b128 v[232:235], v1 offset:10240
  v_exp_f32 v42, v105
  v_exp_f32 v43, v109
  v_exp_f32 v44, v113
  v_exp_f32 v45, v117
  v_exp_f32 v46, v121
  v_mfma_f32_32x32x16_bf16 v[144:159], a[100:103], v[240:243], v[144:159]
  buffer_load_dwordx4 a[140:143], v1, s[8:11], s46 offen offset:3072
  v_exp_f32 v47, v125
  v_fma_f32 v40, v40, 2.0, 2.0
  v_fma_f32 v41, v41, 2.0, 2.0
  v_fma_f32 v42, v42, 2.0, 2.0
  v_fma_f32 v43, v43, 2.0, 2.0
  v_fma_f32 v44, v44, 2.0, 2.0
  v_fma_f32 v45, v45, 2.0, 2.0
  s_addk_i32 s46, 0x1000
  s_waitcnt vmcnt(20)
  v_mfma_f32_32x32x16_bf16 v[128:143], a[104:107], v[244:247], v[128:143]
  ds_read_b128 v[236:239], v1 offset:11264
  buffer_load_dwordx4 a[192:195], v1, s[8:11], s46 offen offset:0
  v_fma_f32 v46, v46, 2.0, 2.0
  v_fma_f32 v47, v47, 2.0, 2.0
  v_rcp_f32 v40, v40
  v_rcp_f32 v41, v41
  v_rcp_f32 v42, v42
  v_rcp_f32 v43, v43
  v_mfma_f32_32x32x16_bf16 v[144:159], a[108:111], v[244:247], v[144:159]
  v_rcp_f32 v44, v44
  v_rcp_f32 v45, v45
  v_rcp_f32 v46, v46
  v_rcp_f32 v47, v47
  s_waitcnt vmcnt(19) lgkmcnt(5)
  v_mfma_f32_32x32x16_bf16 v[128:143], a[112:115], v[248:251], v[128:143]
  buffer_load_dwordx4 a[196:199], v1, s[8:11], s46 offen offset:1024
  v_mul_f32 v97, v97, v40
  v_mul_f32 v101, v101, v41
  v_mul_f32 v105, v105, v42
  v_mul_f32 v109, v109, v43
  v_mul_f32 v113, v113, v44
  v_mul_f32 v117, v117, v45
  v_mul_f32 v121, v121, v46
  v_mul_f32 v125, v125, v47
  v_cvt_pk_bf16_f32 v52, v97, v101
  v_mfma_f32_32x32x16_bf16 v[144:159], a[224:227], v[248:251], v[144:159]
  buffer_load_dwordx4 a[200:203], v1, s[8:11], s46 offen offset:2048
  v_cvt_pk_bf16_f32 v53, v105, v109
  v_cvt_pk_bf16_f32 v54, v113, v117
  v_cvt_pk_bf16_f32 v55, v121, v125
  s_waitcnt vmcnt(19)
  v_mfma_f32_32x32x16_bf16 v[128:143], a[228:231], v[252:255], v[128:143]
  ds_write_b128 v11, v[52:55] offset:1024
  buffer_load_dwordx4 a[204:207], v1, s[8:11], s46 offen offset:3072
  v_mfma_f32_32x32x16_bf16 v[144:159], a[232:235], v[252:255], v[144:159]
  s_waitcnt vmcnt(14)
  v_max3_u32 v34, v16, v17, v18
  s_waitcnt vmcnt(13)
  v_max3_u32 v34, v34, v19, v20
  v_max3_u32 v34, v34, v21, v22
  s_waitcnt vmcnt(12)
  v_max3_u32 v34, v34, v23, v24
  s_waitcnt lgkmcnt(4)
  v_mfma_f32_32x32x16_bf16 v[128:143], a[236:239], v[224:227], v[128:143]
  v_max3_u32 v34, v34, v25, v26
  s_waitcnt vmcnt(11)
  v_max3_u32 v34, v34, v27, v28
  v_max3_u32 v34, v34, v29, v30
  v_max_u32 v34, v34, v31
  v_mfma_f32_32x32x16_bf16 v[144:159], a[116:119], v[224:227], v[144:159]
  v_cmp_eq_u32 vcc, -1, v34
  s_nop 3
  s_cbranch_vccnz C_ra
C_ga:
  v_mfma_f32_32x32x16_bf16 v[128:143], a[120:123], v[228:231], v[128:143]
  ds_write_b128 v5, v[16:19] offset:16384
  v_mfma_f32_32x32x16_bf16 v[144:159], a[124:127], v[228:231], v[144:159]
  ds_write_b128 v5, v[20:23] offset:17408
  s_waitcnt vmcnt(10) lgkmcnt(3)
  v_mfma_f32_32x32x16_bf16 v[128:143], a[240:243], v[232:235], v[128:143]
  ds_write_b128 v5, v[24:27] offset:18432
  v_mfma_f32_32x32x16_bf16 v[144:159], a[244:247], v[232:235], v[144:159]
  ds_write_b128 v5, v[28:31] offset:19456
  s_waitcnt vmcnt(8)
  v_mfma_f32_32x32x16_bf16 v[128:143], a[248:251], v[236:239], v[128:143]
  s_waitcnt lgkmcnt(0)
  s_barrier
  ds_read_b128 v[240:243], v1 offset:16384
  ds_read_b128 v[244:247], v1 offset:17408
  ds_read_b128 v[248:251], v1 offset:18432
  ds_read_b128 v[252:255], v1 offset:19456
  ds_read_b128 v[224:227], v1 offset:20480
  ds_read_b128 v[228:231], v1 offset:21504
  v_mfma_f32_32x32x16_bf16 v[144:159], a[252:255], v[236:239], v[144:159]
  v_exp_f32 v40, v98
  v_exp_f32 v41, v102
  s_add_u32 s46, s63, 0x40000
  s_waitcnt lgkmcnt(5)
  v_mfma_f32_32x32x16_bf16 v[160:175], a[0:3], v[240:243], 0
  buffer_load_dwordx4 a[0:3], v1, s[8:11], s46 offen offset:0
  ds_read_b128 v[232:235], v1 offset:22528
  v_exp_f32 v42, v106
  v_exp_f32 v43, v110
  s_waitcnt lgkmcnt(5)
  v_mfma_f32_32x32x16_bf16 v[176:191], a[4:7], v[240:243], 0
  buffer_load_dwordx4 a[4:7], v1, s[8:11], s46 offen offset:1024
  v_exp_f32 v44, v114
  v_mfma_f32_32x32x16_bf16 v[160:175], a[8:11], v[244:247], v[160:175]
  buffer_load_dwordx4 a[8:11], v1, s[8:11], s46 offen offset:2048
  ds_read_b128 v[236:239], v1 offset:23552
  v_exp_f32 v45, v118
  v_exp_f32 v46, v122
  v_mfma_f32_32x32x16_bf16 v[176:191], a[12:15], v[244:247], v[176:191]
  buffer_load_dwordx4 a[12:15], v1, s[8:11], s46 offen offset:3072
  v_exp_f32 v47, v126
  v_fma_f32 v40, v40, 2.0, 2.0
  v_fma_f32 v41, v41, 2.0, 2.0
  s_waitcnt lgkmcnt(4)
  v_mfma_f32_32x32x16_bf16 v[160:175], a[16:19], v[248:251], v[160:175]
  ds_read_b128 v[240:243], v1 offset:24576
  v_fma_f32 v42, v42, 2.0, 2.0
  v_fma_f32 v43, v43, 2.0, 2.0
  v_fma_f32 v44, v44, 2.0, 2.0
  s_addk_i32 s46, 0x1000
  v_mfma_f32_32x32x16_bf16 v[176:191], a[20:23], v[248:251], v[176:191]
  buffer_load_dwordx4 a[16:19], v1, s[8:11], s46 offen offset:0
  v_fma_f32 v45, v45, 2.0, 2.0
  v_fma_f32 v46, v46, 2.0, 2.0
  v_fma_f32 v47, v47, 2.0, 2.0
  v_mfma_f32_32x32x16_bf16 v[160:175], a[24:27], v[252:255], v[160:175]
  ds_read_b128 v[244:247], v1 offset:25600
  v_rcp_f32 v40, v40
  v_rcp_f32 v41, v41
  v_mfma_f32_32x32x16_bf16 v[176:191], a[28:31], v[252:255], v[176:191]
  buffer_load_dwordx4 a[20:23], v1, s[8:11], s46 offen offset:1024
  v_rcp_f32 v42, v42
  v_rcp_f32 v43, v43
  s_waitcnt lgkmcnt(4)
  v_mfma_f32_32x32x16_bf16 v[160:175], a[144:147], v[224:227], v[160:175]
  ds_read_b128 v[248:251], v1 offset:26624
  v_rcp_f32 v44, v44
  v_rcp_f32 v45, v45
  v_mfma_f32_32x32x16_bf16 v[176:191], a[148:151], v[224:227], v[176:191]
  buffer_load_dwordx4 a[24:27], v1, s[8:11], s46 offen offset:2048
  v_rcp_f32 v46, v46
  v_mfma_f32_32x32x16_bf16 v[160:175], a[152:155], v[228:231], v[160:175]
  ds_read_b128 v[252:255], v1 offset:27648
  v_rcp_f32 v47, v47
  v_mul_f32 v98, v98, v40
  v_mul_f32 v102, v102, v41
  v_mfma_f32_32x32x16_bf16 v[176:191], a[156:159], v[228:231], v[176:191]
  buffer_load_dwordx4 a[28:31], v1, s[8:11], s46 offen offset:3072
  v_mul_f32 v106, v106, v42
  v_mul_f32 v110, v110, v43
  v_mul_f32 v114, v114, v44
  v_mul_f32 v118, v118, v45
  s_waitcnt lgkmcnt(4)
  v_mfma_f32_32x32x16_bf16 v[160:175], a[32:35], v[232:235], v[160:175]
  ds_read_b128 v[224:227], v1 offset:28672
  v_mul_f32 v122, v122, v46
  v_mul_f32 v126, v126, v47
  v_cvt_pk_bf16_f32 v48, v98, v102
  s_add_u32 s46, s63, 0x48000
  v_mfma_f32_32x32x16_bf16 v[176:191], a[36:39], v[232:235], v[176:191]
  buffer_load_dwordx4 a[144:147], v1, s[8:11], s46 offen offset:0
  v_cvt_pk_bf16_f32 v49, v106, v110
  v_cvt_pk_bf16_f32 v50, v114, v118
  v_cvt_pk_bf16_f32 v51, v122, v126
  v_mfma_f32_32x32x16_bf16 v[160:175], a[40:43], v[236:239], v[160:175]
  ds_write_b128 v11, v[48:51] offset:2048
  ds_read_b128 v[228:231], v1 offset:29696
  buffer_load_dwordx4 a[148:151], v1, s[8:11], s46 offen offset:1024
  v_mfma_f32_32x32x16_bf16 v[176:191], a[160:163], v[236:239], v[176:191]
  v_exp_f32 v40, v99
  s_waitcnt lgkmcnt(5)
  v_mfma_f32_32x32x16_bf16 v[160:175], a[164:167], v[240:243], v[160:175]
  ds_read_b128 v[232:235], v1 offset:30720
  buffer_load_dwordx4 a[152:155], v1, s[8:11], s46 offen offset:2048
  v_exp_f32 v41, v103
  v_exp_f32 v42, v107
  v_mfma_f32_32x32x16_bf16 v[176:191], a[168:171], v[240:243], v[176:191]
  v_exp_f32 v43, v111
  v_mfma_f32_32x32x16_bf16 v[160:175], a[172:175], v[244:247], v[160:175]
  buffer_load_dwordx4 a[156:159], v1, s[8:11], s46 offen offset:3072
  ds_read_b128 v[236:239], v1 offset:31744
  v_exp_f32 v44, v115
  v_exp_f32 v45, v119
  v_mfma_f32_32x32x16_bf16 v[176:191], a[44:47], v[244:247], v[176:191]
  v_exp_f32 v46, v123
  v_exp_f32 v47, v127
  s_addk_i32 s46, 0x1000
  s_waitcnt lgkmcnt(5)
  v_mfma_f32_32x32x16_bf16 v[160:175], a[48:51], v[248:251], v[160:175]
  buffer_load_dwordx4 a[32:35], v1, s[8:11], s46 offen offset:0
  ds_read_b128 v[240:243], v1 offset:16384
  v_fma_f32 v40, v40, 2.0, 2.0
  v_fma_f32 v41, v41, 2.0, 2.0
  v_fma_f32 v42, v42, 2.0, 2.0
  v_mfma_f32_32x32x16_bf16 v[176:191], a[52:55], v[248:251], v[176:191]
  v_fma_f32 v43, v43, 2.0, 2.0
  v_fma_f32 v44, v44, 2.0, 2.0
  v_fma_f32 v45, v45, 2.0, 2.0
  v_fma_f32 v46, v46, 2.0, 2.0
  v_mfma_f32_32x32x16_bf16 v[160:175], a[56:59], v[252:255], v[160:175]
  buffer_load_dwordx4 a[36:39], v1, s[8:11], s46 offen offset:1024
  ds_read_b128 v[244:247], v1 offset:17408
  v_fma_f32 v47, v47, 2.0, 2.0
  v_rcp_f32 v40, v40
  v_mfma_f32_32x32x16_bf16 v[176:191], a[60:63], v[252:255], v[176:191]
  v_rcp_f32 v41, v41
  v_rcp_f32 v42, v42
  s_waitcnt lgkmcnt(4)
  v_mfma_f32_32x32x16_bf16 v[160:175], a[176:179], v[224:227], v[160:175]
  buffer_load_dwordx4 a[40:43], v1, s[8:11], s46 offen offset:2048
  ds_read_b128 v[248:251], v1 offset:18432
  v_rcp_f32 v43, v43
  v_rcp_f32 v44, v44
  v_mfma_f32_32x32x16_bf16 v[176:191], a[180:183], v[224:227], v[176:191]
  v_rcp_f32 v45, v45
  v_mfma_f32_32x32x16_bf16 v[160:175], a[184:187], v[228:231], v[160:175]
  buffer_load_dwordx4 a[160:163], v1, s[8:11], s46 offen offset:3072
  ds_read_b128 v[252:255], v1 offset:19456
  v_rcp_f32 v46, v46
  v_rcp_f32 v47, v47
  v_mul_f32 v99, v99, v40
  v_mfma_f32_32x32x16_bf16 v[176:191], a[188:191], v[228:231], v[176:191]
  v_mul_f32 v103, v103, v41
  v_mul_f32 v107, v107, v42
  v_mul_f32 v111, v111, v43
  s_add_u32 s46, s63, 0x50000
  s_waitcnt lgkmcnt(4)
  v_mfma_f32_32x32x16_bf16 v[160:175], a[64:67], v[232:235], v[160:175]
  buffer_load_dwordx4 a[164:167], v1, s[8:11], s46 offen offset:0
  ds_read_b128 v[224:227], v1 offset:20480
  v_mul_f32 v115, v115, v44
  v_mul_f32 v119, v119, v45
  v_mul_f32 v123, v123, v46
  v_mfma_f32_32x32x16_bf16 v[176:191], a[68:71], v[232:235], v[176:191]
  v_mul_f32 v127, v127, v47
  v_cvt_pk_bf16_f32 v52, v99, v103
  v_cvt_pk_bf16_f32 v53, v107, v111
  v_cvt_pk_bf16_f32 v54, v115, v119
  v_mfma_f32_32x32x16_bf16 v[160:175], a[72:75], v[236:239], v[160:175]
  buffer_load_dwordx4 a[168:171], v1, s[8:11], s46 offen offset:1024
  ds_read_b128 v[228:231], v1 offset:21504
  v_cvt_pk_bf16_f32 v55, v123, v127
  v_mfma_f32_32x32x16_bf16 v[176:191], a[76:79], v[236:239], v[176:191]
  ds_write_b128 v11, v[52:55] offset:3072
  buffer_load_dwordx4 a[172:175], v1, s[8:11], s46 offen offset:2048
  s_waitcnt lgkmcnt(5)
  v_mfma_f32_32x32x16_bf16 v[96:111], a[80:83], v[240:243], 0
  ds_read_b128 v[232:235], v1 offset:22528
  v_mfma_f32_32x32x16_bf16 v[112:127], a[84:87], v[240:243], 0
  buffer_load_dwordx4 a[44:47], v1, s[8:11], s46 offen offset:3072
  s_nop 0
  v_exp_f32 v40, v160
  v_exp_f32 v41, v164
  v_exp_f32 v42, v168
  v_exp_f32 v43, v172
  s_addk_i32 s46, 0x1000
  v_mfma_f32_32x32x16_bf16 v[96:111], a[88:91], v[244:247], v[96:111]
  buffer_load_dwordx4 a[48:51], v1, s[8:11], s46 offen offset:0
  ds_read_b128 v[236:239], v1 offset:23552
  v_exp_f32 v44, v176
  v_exp_f32 v45, v180
  v_exp_f32 v46, v184
  v_exp_f32 v47, v188
  v_mfma_f32_32x32x16_bf16 v[112:127], a[92:95], v[244:247], v[112:127]
  v_fma_f32 v40, v40, 2.0, 2.0
  v_fma_f32 v41, v41, 2.0, 2.0
  v_fma_f32 v42, v42, 2.0, 2.0
  v_fma_f32 v43, v43, 2.0, 2.0
  v_fma_f32 v44, v44, 2.0, 2.0
  v_fma_f32 v45, v45, 2.0, 2.0
  s_waitcnt lgkmcnt(5)
  v_mfma_f32_32x32x16_bf16 v[96:111], a[208:211], v[248:251], v[96:111]
  buffer_load_dwordx4 a[52:55], v1, s[8:11], s46 offen offset:1024
  ds_read_b128 v[240:243], v1 offset:24576
  v_fma_f32 v46, v46, 2.0, 2.0
  v_fma_f32 v47, v47, 2.0, 2.0
  v_rcp_f32 v40, v40
  v_rcp_f32 v41, v41
  v_rcp_f32 v42, v42
  v_mfma_f32_32x32x16_bf16 v[112:127], a[212:215], v[248:251], v[112:127]
  buffer_load_dwordx4 a[56:59], v1, s[8:11], s46 offen offset:2048
  v_rcp_f32 v43, v43
  v_rcp_f32 v44, v44
  v_rcp_f32 v45, v45
  v_rcp_f32 v46, v46
  v_mfma_f32_32x32x16_bf16 v[96:111], a[216:219], v[252:255], v[96:111]
  buffer_load_dwordx4 a[60:63], v1, s[8:11], s46 offen offset:3072
  ds_read_b128 v[244:247], v1 offset:25600
  v_rcp_f32 v47, v47
  v_mul_f32 v160, v160, v40
  v_mul_f32 v164, v164, v41
  v_mul_f32 v168, v168, v42
  v_mul_f32 v172, v172, v43
  v_mul_f32 v176, v176, v44
  v_mfma_f32_32x32x16_bf16 v[112:127], a[220:223], v[252:255], v[112:127]
  v_mul_f32 v180, v180, v45
  v_mul_f32 v184, v184, v46
  v_mul_f32 v188, v188, v47
  v_cvt_pk_bf16_f32 v48, v160, v164
  v_cvt_pk_bf16_f32 v49, v168, v172
  v_cvt_pk_bf16_f32 v50, v176, v180
  v_cvt_pk_bf16_f32 v51, v184, v188
  s_add_u32 s46, s63, 0x58000
  s_waitcnt lgkmcnt(5)
  v_mfma_f32_32x32x16_bf16 v[96:111], a[96:99], v[224:227], v[96:111]
  ds_write_b128 v11, v[48:51] offset:32768
  buffer_load_dwordx4 a[176:179], v1, s[8:11], s46 offen offset:0
  ds_read_b128 v[248:251], v1 offset:26624
  v_exp_f32 v40, v161
  v_mfma_f32_32x32x16_bf16 v[112:127], a[100:103], v[224:227], v[112:127]
  buffer_load_dwordx4 a[180:183], v1, s[8:11], s46 offen offset:1024
  v_exp_f32 v41, v165
  v_exp_f32 v42, v169
  v_exp_f32 v43, v173
  v_exp_f32 v44, v177
  v_mfma_f32_32x32x16_bf16 v[96:111], a[104:107], v[228:231], v[96:111]
  buffer_load_dwordx4 a[184:187], v1, s[8:11], s46 offen offset:2048
  ds_read_b128 v[252:255], v1 offset:27648
  v_exp_f32 v45, v181
  v_exp_f32 v46, v185
  v_exp_f32 v47, v189
  v_fma_f32 v40, v40, 2.0, 2.0
  v_mfma_f32_32x32x16_bf16 v[112:127], a[108:111], v[228:231], v[112:127]
  v_fma_f32 v41, v41, 2.0, 2.0
  v_fma_f32 v42, v42, 2.0, 2.0
  v_fma_f32 v43, v43, 2.0, 2.0
  v_fma_f32 v44, v44, 2.0, 2.0
  v_fma_f32 v45, v45, 2.0, 2.0
  v_fma_f32 v46, v46, 2.0, 2.0
  v_fma_f32 v47, v47, 2.0, 2.0
  s_waitcnt lgkmcnt(5)
  v_mfma_f32_32x32x16_bf16 v[96:111], a[112:115], v[232:235], v[96:111]
  buffer_load_dwordx4 a[188:191], v1, s[8:11], s46 offen offset:3072
  ds_read_b128 v[224:227], v1 offset:28672
  v_rcp_f32 v40, v40
  v_rcp_f32 v41, v41
  v_rcp_f32 v42, v42
  v_rcp_f32 v43, v43
  s_addk_i32 s46, 0x1000
  v_mfma_f32_32x32x16_bf16 v[112:127], a[224:227], v[232:235], v[112:127]
  buffer_load_dwordx4 a[64:67], v1, s[8:11], s46 offen offset:0
  v_rcp_f32 v44, v44
  v_rcp_f32 v45, v45
  v_rcp_f32 v46, v46
  v_rcp_f32 v47, v47
  v_mfma_f32_32x32x16_bf16 v[96:111], a[228:231], v[236:239], v[96:111]
  buffer_load_dwordx4 a[68:71], v1, s[8:11], s46 offen offset:1024
  ds_read_b128 v[228:231], v1 offset:29696
  v_mul_f32 v161, v161, v40
  v_mul_f32 v165, v165, v41
  v_mul_f32 v169, v169, v42
  v_mul_f32 v173, v173, v43
  v_mul_f32 v177, v177, v44
  v_mul_f32 v181, v181, v45
  v_mul_f32 v185, v185, v46
  v_mfma_f32_32x32x16_bf16 v[112:127], a[232:235], v[236:239], v[112:127]
  v_mul_f32 v189, v189, v47
  v_cvt_pk_bf16_f32 v52, v161, v165
  v_cvt_pk_bf16_f32 v53, v169, v173
  v_cvt_pk_bf16_f32 v54, v177, v181
  v_cvt_pk_bf16_f32 v55, v185, v189
  s_waitcnt lgkmcnt(5)
  v_mfma_f32_32x32x16_bf16 v[96:111], a[236:239], v[240:243], v[96:111]
  ds_write_b128 v11, v[52:55] offset:33792
  buffer_load_dwordx4 a[72:75], v1, s[8:11], s46 offen offset:2048
  ds_read_b128 v[232:235], v1 offset:30720
  v_exp_f32 v40, v162
  v_exp_f32 v41, v166
  v_mfma_f32_32x32x16_bf16 v[112:127], a[116:119], v[240:243], v[112:127]
  buffer_load_dwordx4 a[76:79], v1, s[8:11], s46 offen offset:3072
  v_exp_f32 v42, v170
  v_exp_f32 v43, v174
  v_exp_f32 v44, v178
  v_exp_f32 v45, v182
  s_add_u32 s46, s63, 0x42000
  v_mfma_f32_32x32x16_bf16 v[96:111], a[120:123], v[244:247], v[96:111]
  buffer_load_dwordx4 a[80:83], v1, s[8:11], s46 offen offset:0
  ds_read_b128 v[236:239], v1 offset:31744
  v_exp_f32 v46, v186
  v_exp_f32 v47, v190
  v_fma_f32 v40, v40, 2.0, 2.0
  v_fma_f32 v41, v41, 2.0, 2.0
  v_fma_f32 v42, v42, 2.0, 2.0
  v_mfma_f32_32x32x16_bf16 v[112:127], a[124:127], v[244:247], v[112:127]
  v_fma_f32 v43, v43, 2.0, 2.0
  v_fma_f32 v44, v44, 2.0, 2.0
  v_fma_f32 v45, v45, 2.0, 2.0
  v_fma_f32 v46, v46, 2.0, 2.0
  v_fma_f32 v47, v47, 2.0, 2.0
  v_rcp_f32 v40, v40
  s_waitcnt lgkmcnt(5)
  v_mfma_f32_32x32x16_bf16 v[96:111], a[240:243], v[248:251], v[96:111]
  buffer_load_dwordx4 a[84:87], v1, s[8:11], s46 offen offset:1024
  ds_read_b128 v[240:243], v1 offset:12288
  v_rcp_f32 v41, v41
  v_rcp_f32 v42, v42
  v_rcp_f32 v43, v43
  v_rcp_f32 v44, v44
  v_mfma_f32_32x32x16_bf16 v[112:127], a[244:247], v[248:251], v[112:127]
  buffer_load_dwordx4 a[88:91], v1, s[8:11], s46 offen offset:2048
  v_rcp_f32 v45, v45
  v_rcp_f32 v46, v46
  v_rcp_f32 v47, v47
  v_mul_f32 v162, v162, v40
  v_mfma_f32_32x32x16_bf16 v[96:111], a[248:251], v[252:255], v[96:111]
  buffer_load_dwordx4 a[92:95], v1, s[8:11], s46 offen offset:3072
  ds_read_b128 v[244:247], v1 offset:13312
  v_mul_f32 v166, v166, v41
  v_mul_f32 v170, v170, v42
  v_mul_f32 v174, v174, v43
  v_mul_f32 v178, v178, v44
  v_mul_f32 v182, v182, v45
  v_mul_f32 v186, v186, v46
  v_mul_f32 v190, v190, v47
  v_mfma_f32_32x32x16_bf16 v[112:127], a[252:255], v[252:255], v[112:127]
  v_cvt_pk_bf16_f32 v48, v162, v166
  v_cvt_pk_bf16_f32 v49, v170, v174
  v_cvt_pk_bf16_f32 v50, v178, v182
  v_cvt_pk_bf16_f32 v51, v186, v190
  s_addk_i32 s46, 0x1000
  s_waitcnt vmcnt(42) lgkmcnt(5)
  v_mfma_f32_32x32x16_bf16 v[96:111], a[128:131], v[224:227], v[96:111]
  ds_write_b128 v11, v[48:51] offset:34816
  buffer_load_dwordx4 a[208:211], v1, s[8:11], s46 offen offset:0
  ds_read_b128 v[248:251], v1 offset:14336
  v_exp_f32 v40, v163
  v_exp_f32 v41, v167
  v_exp_f32 v42, v171
  v_mfma_f32_32x32x16_bf16 v[112:127], a[132:135], v[224:227], v[112:127]
  buffer_load_dwordx4 a[212:215], v1, s[8:11], s46 offen offset:1024
  v_exp_f32 v43, v175
  v_exp_f32 v44, v179
  v_exp_f32 v45, v183
  v_exp_f32 v46, v187
  s_waitcnt vmcnt(42)
  v_mfma_f32_32x32x16_bf16 v[96:111], a[136:139], v[228:231], v[96:111]
  buffer_load_dwordx4 a[216:219], v1, s[8:11], s46 offen offset:2048
  ds_read_b128 v[252:255], v1 offset:15360
  v_exp_f32 v47, v191
  v_fma_f32 v40, v40, 2.0, 2.0
  v_fma_f32 v41, v41, 2.0, 2.0
  v_fma_f32 v42, v42, 2.0, 2.0
  v_fma_f32 v43, v43, 2.0, 2.0
  v_fma_f32 v44, v44, 2.0, 2.0
  v_mfma_f32_32x32x16_bf16 v[112:127], a[140:143], v[228:231], v[112:127]
  buffer_load_dwordx4 a[220:223], v1, s[8:11], s46 offen offset:3072
  v_fma_f32 v45, v45, 2.0, 2.0
  v_fma_f32 v46, v46, 2.0, 2.0
  v_fma_f32 v47, v47, 2.0, 2.0
  v_rcp_f32 v40, v40
  v_rcp_f32 v41, v41
  s_waitcnt vmcnt(42) lgkmcnt(5)
  v_mfma_f32_32x32x16_bf16 v[96:111], a[192:195], v[232:235], v[96:111]
  v_rcp_f32 v42, v42
  v_rcp_f32 v43, v43
  v_rcp_f32 v44, v44
  v_rcp_f32 v45, v45
  s_add_u32 s46, s63, 0x4a000
  v_mfma_f32_32x32x16_bf16 v[112:127], a[196:199], v[232:235], v[112:127]
  buffer_load_dwordx4 a[96:99], v1, s[8:11], s46 offen offset:0
  v_rcp_f32 v46, v46
  v_rcp_f32 v47, v47
  v_mul_f32 v163, v163, v40
  v_mul_f32 v167, v167, v41
  v_mul_f32 v171, v171, v42
  s_waitcnt vmcnt(41)
  v_mfma_f32_32x32x16_bf16 v[96:111], a[200:203], v[236:239], v[96:111]
  buffer_load_dwordx4 a[100:103], v1, s[8:11], s46 offen offset:1024
  v_mul_f32 v175, v175, v43
  v_mul_f32 v179, v179, v44
  v_mul_f32 v183, v183, v45
  v_mul_f32 v187, v187, v46
  v_mul_f32 v191, v191, v47
  v_cvt_pk_bf16_f32 v52, v163, v167
  v_cvt_pk_bf16_f32 v53, v171, v175
  v_mfma_f32_32x32x16_bf16 v[112:127], a[204:207], v[236:239], v[112:127]
  v_cvt_pk_bf16_f32 v54, v179, v183
  v_cvt_pk_bf16_f32 v55, v187, v191
  s_waitcnt lgkmcnt(3)
  v_mfma_f32_32x32x16_bf16 v[128:143], a[128:131], v[240:243], v[128:143]
  ds_write_b128 v11, v[52:55] offset:35840
  buffer_load_dwordx4 a[104:107], v1, s[8:11], s46 offen offset:2048
  s_waitcnt lgkmcnt(0)
  s_barrier
  buffer_load_dwordx4 a[108:111], v1, s[8:11], s46 offen offset:3072
  ds_read_b128 v[224:227], v15 offset:32768
  ds_read_b128 v[228:231], v15 offset:33792
  ds_read_b128 v[232:235], v15 offset:34816
  v_mfma_f32_32x32x16_bf16 v[144:159], a[132:135], v[240:243], v[144:159]
  v_exp_f32 v40, v96
  v_exp_f32 v41, v100
  v_exp_f32 v42, v104
  s_addk_i32 s46, 0x1000
  v_mfma_f32_32x32x16_bf16 v[128:143], a[136:139], v[244:247], v[128:143]
  buffer_load_dwordx4 a[112:115], v1, s[8:11], s46 offen offset:0
  ds_read_b128 v[236:239], v15 offset:35840
  v_exp_f32 v43, v108
  v_exp_f32 v44, v112
  v_exp_f32 v45, v116
  v_mfma_f32_32x32x16_bf16 v[144:159], a[140:143], v[244:247], v[144:159]
  buffer_load_dwordx4 a[224:227], v1, s[8:11], s46 offen offset:1024
  v_exp_f32 v46, v120
  v_exp_f32 v47, v124
  v_fma_f32 v40, v40, 2.0, 2.0
  v_fma_f32 v41, v41, 2.0, 2.0
  v_fma_f32 v42, v42, 2.0, 2.0
  v_mfma_f32_32x32x16_bf16 v[128:143], a[192:195], v[248:251], v[128:143]
  buffer_load_dwordx4 a[228:231], v1, s[8:11], s46 offen offset:2048
  ds_read_b128 v[240:243], v15 offset:40960
  v_fma_f32 v43, v43, 2.0, 2.0
  v_fma_f32 v44, v44, 2.0, 2.0
  v_fma_f32 v45, v45, 2.0, 2.0
  v_fma_f32 v46, v46, 2.0, 2.0
  v_fma_f32 v47, v47, 2.0, 2.0
  v_rcp_f32 v40, v40
  v_mfma_f32_32x32x16_bf16 v[144:159], a[196:199], v[248:251], v[144:159]
  v_rcp_f32 v41, v41
  v_rcp_f32 v42, v42
  v_rcp_f32 v43, v43
  v_mfma_f32_32x32x16_bf16 v[128:143], a[200:203], v[252:255], v[128:143]
  buffer_load_dwordx4 a[232:235], v1, s[8:11], s46 offen offset:3072
  ds_read_b128 v[244:247], v15 offset:41984
  v_rcp_f32 v44, v44
  v_rcp_f32 v45, v45
  v_rcp_f32 v46, v46
  v_mfma_f32_32x32x16_bf16 v[144:159], a[204:207], v[252:255], v[144:159]
  v_rcp_f32 v47, v47
  v_mul_f32 v96, v96, v40
  v_mul_f32 v100, v100, v41
  v_mul_f32 v104, v104, v42
  v_mul_f32 v108, v108, v43
  s_add_u32 s46, s63, 0x52000
  s_waitcnt vmcnt(46) lgkmcnt(4)
  v_mfma_f32_32x32x16_bf16 v[192:207], a[0:3], v[224:227], 0
  buffer_load_dwordx4 a[236:239], v1, s[8:11], s46 offen offset:0
  ds_read_b128 v[248:251], v15 offset:43008
  v_mul_f32 v112, v112, v44
  v_mul_f32 v116, v116, v45
  v_mul_f32 v120, v120, v46
  v_mul_f32 v124, v124, v47
  v_cvt_pk_bf16_f32 v48, v96, v100
  v_cvt_pk_bf16_f32 v49, v104, v108
  v_mfma_f32_32x32x16_bf16 v[208:223], a[4:7], v[224:227], 0
  buffer_load_dwordx4 a[116:119], v1, s[8:11], s46 offen offset:1024
  v_cvt_pk_bf16_f32 v50, v112, v116
  v_cvt_pk_bf16_f32 v51, v120, v124
  s_waitcnt vmcnt(46)
  v_mfma_f32_32x32x16_bf16 v[192:207], a[8:11], v[228:231], v[192:207]
  ds_write_b128 v11, v[48:51] offset:36864
  ds_read_b128 v[252:255], v15 offset:44032
  v_exp_f32 v40, v97
  v_exp_f32 v41, v101
  v_mfma_f32_32x32x16_bf16 v[208:223], a[12:15], v[228:231], v[208:223]
  buffer_load_dwordx4 a[120:123], v1, s[8:11], s46 offen offset:2048
  v_exp_f32 v42, v105
  v_exp_f32 v43, v109
  v_exp_f32 v44, v113
  v_exp_f32 v45, v117
  s_waitcnt vmcnt(45) lgkmcnt(5)
  v_mfma_f32_32x32x16_bf16 v[192:207], a[16:19], v[232:235], v[192:207]
  buffer_load_dwordx4 a[124:127], v1, s[8:11], s46 offen offset:3072
  ds_read_b128 v[224:227], v15 offset:49152
  v_exp_f32 v46, v121
  v_exp_f32 v47, v125
  v_fma_f32 v40, v40, 2.0, 2.0
  v_mfma_f32_32x32x16_bf16 v[208:223], a[20:23], v[232:235], v[208:223]
  v_fma_f32 v41, v41, 2.0, 2.0
  v_fma_f32 v42, v42, 2.0, 2.0
  v_fma_f32 v43, v43, 2.0, 2.0
  v_fma_f32 v44, v44, 2.0, 2.0
  v_fma_f32 v45, v45, 2.0, 2.0
  v_fma_f32 v46, v46, 2.0, 2.0
  s_addk_i32 s46, 0x1000
  s_waitcnt vmcnt(44)
  v_mfma_f32_32x32x16_bf16 v[192:207], a[24:27], v[236:239], v[192:207]
  buffer_load_dwordx4 a[240:243], v1, s[8:11], s46 offen offset:0
  ds_read_b128 v[228:231], v15 offset:50176
  v_fma_f32 v47, v47, 2.0, 2.0
  v_rcp_f32 v40, v40
  v_rcp_f32 v41, v41
  v_rcp_f32 v42, v42
  v_mfma_f32_32x32x16_bf16 v[208:223], a[28:31], v[236:239], v[208:223]
  buffer_load_dwordx4 a[244:247], v1, s[8:11], s46 offen offset:1024
  v_rcp_f32 v43, v43
  v_rcp_f32 v44, v44
  v_rcp_f32 v45, v45
  s_waitcnt vmcnt(44) lgkmcnt(5)
  v_mfma_f32_32x32x16_bf16 v[192:207], a[144:147], v[240:243], v[192:207]
  ds_read_b128 v[232:235], v15 offset:51200
  buffer_load_dwordx4 a[248:251], v1, s[8:11], s46 offen offset:2048
  v_rcp_f32 v46, v46
  v_rcp_f32 v47, v47
  v_mul_f32 v97, v97, v40
  v_mul_f32 v101, v101, v41
  v_mfma_f32_32x32x16_bf16 v[208:223], a[148:151], v[240:243], v[208:223]
  v_mul_f32 v105, v105, v42
  v_mul_f32 v109, v109, v43
  v_mul_f32 v113, v113, v44
  v_mul_f32 v117, v117, v45
  v_mul_f32 v121, v121, v46
  v_mul_f32 v125, v125, v47
  s_waitcnt vmcnt(43)
  v_mfma_f32_32x32x16_bf16 v[192:207], a[152:155], v[244:247], v[192:207]
  buffer_load_dwordx4 a[252:255], v1, s[8:11], s46 offen offset:3072
  ds_read_b128 v[236:239], v15 offset:52224
  v_cvt_pk_bf16_f32 v52, v97, v101
  v_cvt_pk_bf16_f32 v53, v105, v109
  v_cvt_pk_bf16_f32 v54, v113, v117
  v_cvt_pk_bf16_f32 v55, v121, v125
  s_add_u32 s46, s63, 0x5a000
  v_mfma_f32_32x32x16_bf16 v[208:223], a[156:159], v[244:247], v[208:223]
  ds_write_b128 v11, v[52:55] offset:37888
  buffer_load_dwordx4 a[128:131], v1, s[8:11], s46 offen offset:0
  v_exp_f32 v40, v98
  v_exp_f32 v41, v102
  s_waitcnt vmcnt(43) lgkmcnt(5)
  v_mfma_f32_32x32x16_bf16 v[192:207], a[32:35], v[248:251], v[192:207]
  ds_read_b128 v[240:243], v15 offset:57344
  v_exp_f32 v42, v106
  v_exp_f32 v43, v110
  v_exp_f32 v44, v114
  v_mfma_f32_32x32x16_bf16 v[208:223], a[36:39], v[248:251], v[208:223]
  buffer_load_dwordx4 a[132:135], v1, s[8:11], s46 offen offset:1024
  v_exp_f32 v45, v118
  v_exp_f32 v46, v122
  v_exp_f32 v47, v126
  s_waitcnt vmcnt(42)
  v_mfma_f32_32x32x16_bf16 v[192:207], a[40:43], v[252:255], v[192:207]
  ds_read_b128 v[244:247], v15 offset:58368
  buffer_load_dwordx4 a[136:139], v1, s[8:11], s46 offen offset:2048
  v_fma_f32 v40, v40, 2.0, 2.0
  v_fma_f32 v41, v41, 2.0, 2.0
  v_fma_f32 v42, v42, 2.0, 2.0
  v_fma_f32 v43, v43, 2.0, 2.0
  v_fma_f32 v44, v44, 2.0, 2.0
  v_fma_f32 v45, v45, 2.0, 2.0
  v_mfma_f32_32x32x16_bf16 v[208:223], a[160:163], v[252:255], v[208:223]
  v_fma_f32 v46, v46, 2.0, 2.0
  v_fma_f32 v47, v47, 2.0, 2.0
  v_rcp_f32 v40, v40
  v_rcp_f32 v41, v41
  s_waitcnt vmcnt(41) lgkmcnt(5)
  v_mfma_f32_32x32x16_bf16 v[192:207], a[164:167], v[224:227], v[192:207]
  buffer_load_dwordx4 a[140:143], v1, s[8:11], s46 offen offset:3072
  ds_read_b128 v[248:251], v15 offset:59392
  v_rcp_f32 v42, v42
  v_rcp_f32 v43, v43
  v_rcp_f32 v44, v44
  v_mfma_f32_32x32x16_bf16 v[208:223], a[168:171], v[224:227], v[208:223]
  v_rcp_f32 v45, v45
  v_rcp_f32 v46, v46
  v_rcp_f32 v47, v47
  v_mul_f32 v98, v98, v40
  s_addk_i32 s46, 0x1000
  s_waitcnt vmcnt(40)
  v_mfma_f32_32x32x16_bf16 v[192:207], a[172:175], v[228:231], v[192:207]
  buffer_load_dwordx4 a[192:195], v1, s[8:11], s46 offen offset:0
  ds_read_b128 v[252:255], v15 offset:60416
  v_mul_f32 v102, v102, v41
  v_mul_f32 v106, v106, v42
  v_mul_f32 v110, v110, v43
  v_mul_f32 v114, v114, v44
  v_mul_f32 v118, v118, v45
  v_mul_f32 v122, v122, v46
  v_mfma_f32_32x32x16_bf16 v[208:223], a[44:47], v[228:231], v[208:223]
  buffer_load_dwordx4 a[196:199], v1, s[8:11], s46 offen offset:1024
  v_mul_f32 v126, v126, v47
  v_cvt_pk_bf16_f32 v48, v98, v102
  v_cvt_pk_bf16_f32 v49, v106, v110
  v_cvt_pk_bf16_f32 v50, v114, v118
  v_cvt_pk_bf16_f32 v51, v122, v126
  s_waitcnt vmcnt(40) lgkmcnt(5)
  v_mfma_f32_32x32x16_bf16 v[192:207], a[48:51], v[232:235], v[192:207]
  ds_write_b128 v11, v[48:51] offset:38912
  v_exp_f32 v40, v99
  v_mfma_f32_32x32x16_bf16 v[208:223], a[52:55], v[232:235], v[208:223]
  buffer_load_dwordx4 a[200:203], v1, s[8:11], s46 offen offset:2048
  v_exp_f32 v41, v103
  v_exp_f32 v42, v107
  v_exp_f32 v43, v111
  s_waitcnt vmcnt(39)
  v_mfma_f32_32x32x16_bf16 v[192:207], a[56:59], v[236:239], v[192:207]
  buffer_load_dwordx4 a[204:207], v1, s[8:11], s46 offen offset:3072
  v_exp_f32 v44, v115
  v_exp_f32 v45, v119
  v_exp_f32 v46, v123
  v_mfma_f32_32x32x16_bf16 v[208:223], a[60:63], v[236:239], v[208:223]
  v_exp_f32 v47, v127
  v_fma_f32 v40, v40, 2.0, 2.0
  v_fma_f32 v41, v41, 2.0, 2.0
  v_fma_f32 v42, v42, 2.0, 2.0
  v_fma_f32 v43, v43, 2.0, 2.0
  s_waitcnt vmcnt(38) lgkmcnt(3)
  v_mfma_f32_32x32x16_bf16 v[192:207], a[176:179], v[240:243], v[192:207]
  v_fma_f32 v44, v44, 2.0, 2.0
  v_fma_f32 v45, v45, 2.0, 2.0
  v_fma_f32 v46, v46, 2.0, 2.0
  v_fma_f32 v47, v47, 2.0, 2.0
  v_rcp_f32 v40, v40
  v_mfma_f32_32x32x16_bf16 v[208:223], a[180:183], v[240:243], v[208:223]
  v_rcp_f32 v41, v41
  v_rcp_f32 v42, v42
  v_rcp_f32 v43, v43
  s_waitcnt vmcnt(36)
  v_mfma_f32_32x32x16_bf16 v[192:207], a[184:187], v[244:247], v[192:207]
  v_rcp_f32 v44, v44
  v_rcp_f32 v45, v45
  v_rcp_f32 v46, v46
  v_rcp_f32 v47, v47
  v_mfma_f32_32x32x16_bf16 v[208:223], a[188:191], v[244:247], v[208:223]
  v_mul_f32 v99, v99, v40
  v_mul_f32 v103, v103, v41
  v_mul_f32 v107, v107, v42
  v_mul_f32 v111, v111, v43
  v_mul_f32 v115, v115, v44
  s_waitcnt vmcnt(34) lgkmcnt(1)
  v_mfma_f32_32x32x16_bf16 v[192:207], a[64:67], v[248:251], v[192:207]
  v_mul_f32 v119, v119, v45
  v_mul_f32 v123, v123, v46
  v_mul_f32 v127, v127, v47
  v_cvt_pk_bf16_f32 v52, v99, v103
  v_cvt_pk_bf16_f32 v53, v107, v111
  v_cvt_pk_bf16_f32 v54, v115, v119
  v_mfma_f32_32x32x16_bf16 v[208:223], a[68:71], v[248:251], v[208:223]
  v_cvt_pk_bf16_f32 v55, v123, v127
  s_waitcnt vmcnt(32)
  v_mfma_f32_32x32x16_bf16 v[192:207], a[72:75], v[252:255], v[192:207]
  ds_write_b128 v11, v[52:55] offset:39936
  s_waitcnt lgkmcnt(0)
  s_barrier
  ds_read_b128 v[224:227], v15 offset:36864
  ds_read_b128 v[228:231], v15 offset:37888
  ds_read_b128 v[232:235], v15 offset:38912
  ds_read_b128 v[236:239], v15 offset:39936
  ds_read_b128 v[240:243], v15 offset:45056
  ds_read_b128 v[244:247], v15 offset:46080
  v_mfma_f32_32x32x16_bf16 v[208:223], a[76:79], v[252:255], v[208:223]
  v_exp_f32 v40, v128
  v_exp_f32 v41, v132
  v_exp_f32 v42, v136
  s_waitcnt vmcnt(30) lgkmcnt(5)
  v_mfma_f32_32x32x16_bf16 v[192:207], a[80:83], v[224:227], v[192:207]
  ds_read_b128 v[248:251], v15 offset:47104
  v_exp_f32 v43, v140
  v_exp_f32 v44, v144
  s_waitcnt lgkmcnt(5)
  v_mfma_f32_32x32x16_bf16 v[208:223], a[84:87], v[224:227], v[208:223]
  v_exp_f32 v45, v148
  v_exp_f32 v46, v152
  v_exp_f32 v47, v156
  s_waitcnt vmcnt(28)
  v_mfma_f32_32x32x16_bf16 v[192:207], a[88:91], v[228:231], v[192:207]
  ds_read_b128 v[252:255], v15 offset:48128
  v_fma_f32 v40, v40, 2.0, 2.0
  v_fma_f32 v41, v41, 2.0, 2.0
  v_fma_f32 v42, v42, 2.0, 2.0
  v_fma_f32 v43, v43, 2.0, 2.0
  v_fma_f32 v44, v44, 2.0, 2.0
  v_mfma_f32_32x32x16_bf16 v[208:223], a[92:95], v[228:231], v[208:223]
  v_fma_f32 v45, v45, 2.0, 2.0
  v_fma_f32 v46, v46, 2.0, 2.0
  v_fma_f32 v47, v47, 2.0, 2.0
  v_rcp_f32 v40, v40
  s_waitcnt vmcnt(26) lgkmcnt(4)
  v_mfma_f32_32x32x16_bf16 v[192:207], a[208:211], v[232:235], v[192:207]
  ds_read_b128 v[224:227], v15 offset:53248
  v_rcp_f32 v41, v41
  v_rcp_f32 v42, v42
  v_mfma_f32_32x32x16_bf16 v[208:223], a[212:215], v[232:235], v[208:223]
  v_rcp_f32 v43, v43
  v_rcp_f32 v44, v44
  v_rcp_f32 v45, v45
  s_waitcnt vmcnt(24)
  v_mfma_f32_32x32x16_bf16 v[192:207], a[216:219], v[236:239], v[192:207]
  ds_read_b128 v[228:231], v15 offset:54272
  v_rcp_f32 v46, v46
  v_rcp_f32 v47, v47
  v_mul_f32 v128, v128, v40
  v_mfma_f32_32x32x16_bf16 v[208:223], a[220:223], v[236:239], v[208:223]
  v_mul_f32 v132, v132, v41
  v_mul_f32 v136, v136, v42
  v_mul_f32 v140, v140, v43
  v_mul_f32 v144, v144, v44
  v_mul_f32 v148, v148, v45
  s_waitcnt vmcnt(22) lgkmcnt(4)
  v_mfma_f32_32x32x16_bf16 v[192:207], a[96:99], v[240:243], v[192:207]
  ds_read_b128 v[232:235], v15 offset:55296
  v_mul_f32 v152, v152, v46
  v_mul_f32 v156, v156, v47
  v_cvt_pk_bf16_f32 v48, v128, v132
  v_cvt_pk_bf16_f32 v49, v136, v140
  v_cvt_pk_bf16_f32 v50, v144, v148
  v_mfma_f32_32x32x16_bf16 v[208:223], a[100:103], v[240:243], v[208:223]
  v_cvt_pk_bf16_f32 v51, v152, v156
  s_waitcnt vmcnt(20)
  v_mfma_f32_32x32x16_bf16 v[192:207], a[104:107], v[244:247], v[192:207]
  ds_write_b128 v11, v[48:51] offset:4096
  ds_read_b128 v[236:239], v15 offset:56320
  v_exp_f32 v40, v129
  v_exp_f32 v41, v133
  v_mfma_f32_32x32x16_bf16 v[208:223], a[108:111], v[244:247], v[208:223]
  v_exp_f32 v42, v137
  v_exp_f32 v43, v141
  s_waitcnt vmcnt(18) lgkmcnt(5)
  v_mfma_f32_32x32x16_bf16 v[192:207], a[112:115], v[248:251], v[192:207]
  ds_read_b128 v[240:243], v15 offset:61440
  v_exp_f32 v44, v145
  v_exp_f32 v45, v149
  v_exp_f32 v46, v153
  v_mfma_f32_32x32x16_bf16 v[208:223], a[224:227], v[248:251], v[208:223]
  v_exp_f32 v47, v157
  v_fma_f32 v40, v40, 2.0, 2.0
  v_fma_f32 v41, v41, 2.0, 2.0
  v_fma_f32 v42, v42, 2.0, 2.0
  s_waitcnt vmcnt(16)
  v_mfma_f32_32x32x16_bf16 v[192:207], a[228:231], v[252:255], v[192:207]
  ds_read_b128 v[244:247], v15 offset:62464
  v_fma_f32 v43, v43, 2.0, 2.0
  v_fma_f32 v44, v44, 2.0, 2.0
  v_fma_f32 v45, v45, 2.0, 2.0
  v_fma_f32 v46, v46, 2.0, 2.0
  v_fma_f32 v47, v47, 2.0, 2.0
  v_mfma_f32_32x32x16_bf16 v[208:223], a[232:235], v[252:255], v[208:223]
  v_rcp_f32 v40, v40
  v_rcp_f32 v41, v41
  s_waitcnt vmcnt(14) lgkmcnt(5)
  v_mfma_f32_32x32x16_bf16 v[192:207], a[236:239], v[224:227], v[192:207]
  ds_read_b128 v[248:251], v15 offset:63488
  v_rcp_f32 v42, v42
  v_rcp_f32 v43, v43
  v_rcp_f32 v44, v44
  v_mfma_f32_32x32x16_bf16 v[208:223], a[116:119], v[224:227], v[208:223]
  v_rcp_f32 v45, v45
  v_rcp_f32 v46, v46
  v_rcp_f32 v47, v47
  s_waitcnt vmcnt(12)
  v_mfma_f32_32x32x16_bf16 v[192:207], a[120:123], v[228:231], v[192:207]
  ds_read_b128 v[252:255], v15 offset:64512
  v_mul_f32 v129, v129, v40
  v_mul_f32 v133, v133, v41
  v_mul_f32 v137, v137, v42
  v_mul_f32 v141, v141, v43
  v_mfma_f32_32x32x16_bf16 v[208:223], a[124:127], v[228:231], v[208:223]
  v_mul_f32 v145, v145, v44
  v_mul_f32 v149, v149, v45
  v_mul_f32 v153, v153, v46
  v_mul_f32 v157, v157, v47
  v_cvt_pk_bf16_f32 v52, v129, v133
  s_waitcnt vmcnt(10) lgkmcnt(4)
  v_mfma_f32_32x32x16_bf16 v[192:207], a[240:243], v[232:235], v[192:207]
  ds_read_b128 v[224:227], v15 offset:0
  v_cvt_pk_bf16_f32 v53, v137, v141
  v_cvt_pk_bf16_f32 v54, v145, v149
  v_cvt_pk_bf16_f32 v55, v153, v157
  v_mfma_f32_32x32x16_bf16 v[208:223], a[244:247], v[232:235], v[208:223]
  ds_write_b128 v11, v[52:55] offset:5120
  v_exp_f32 v40, v130
  s_waitcnt vmcnt(8)
  v_mfma_f32_32x32x16_bf16 v[192:207], a[248:251], v[236:239], v[192:207]
  ds_read_b128 v[228:231], v15 offset:1024
  v_exp_f32 v41, v134
  v_exp_f32 v42, v138
  v_mfma_f32_32x32x16_bf16 v[208:223], a[252:255], v[236:239], v[208:223]
  v_exp_f32 v43, v142
  v_exp_f32 v44, v146
  v_exp_f32 v45, v150
  s_waitcnt vmcnt(6) lgkmcnt(5)
  v_mfma_f32_32x32x16_bf16 v[192:207], a[128:131], v[240:243], v[192:207]
  ds_read_b128 v[232:235], v15 offset:2048
  v_exp_f32 v46, v154
  v_exp_f32 v47, v158
  v_fma_f32 v40, v40, 2.0, 2.0
  v_mfma_f32_32x32x16_bf16 v[208:223], a[132:135], v[240:243], v[208:223]
  v_fma_f32 v41, v41, 2.0, 2.0
  v_fma_f32 v42, v42, 2.0, 2.0
  v_fma_f32 v43, v43, 2.0, 2.0
  v_fma_f32 v44, v44, 2.0, 2.0
  v_fma_f32 v45, v45, 2.0, 2.0
  s_waitcnt vmcnt(4)
  v_mfma_f32_32x32x16_bf16 v[192:207], a[136:139], v[244:247], v[192:207]
  ds_read_b128 v[236:239], v15 offset:3072
  v_fma_f32 v46, v46, 2.0, 2.0
  v_fma_f32 v47, v47, 2.0, 2.0
  v_rcp_f32 v40, v40
  v_rcp_f32 v41, v41
  v_mfma_f32_32x32x16_bf16 v[208:223], a[140:143], v[244:247], v[208:223]
  v_rcp_f32 v42, v42
  v_rcp_f32 v43, v43
  s_waitcnt vmcnt(2) lgkmcnt(5)
  v_mfma_f32_32x32x16_bf16 v[192:207], a[192:195], v[248:251], v[192:207]
  ds_read_b128 v[240:243], v15 offset:8192
  v_rcp_f32 v44, v44
  v_rcp_f32 v45, v45
  v_rcp_f32 v46, v46
  v_mfma_f32_32x32x16_bf16 v[208:223], a[196:199], v[248:251], v[208:223]
  v_rcp_f32 v47, v47
  v_mul_f32 v130, v130, v40
  v_mul_f32 v134, v134, v41
  v_mul_f32 v138, v138, v42
  s_waitcnt vmcnt(0)
  v_mfma_f32_32x32x16_bf16 v[192:207], a[200:203], v[252:255], v[192:207]
  ds_read_b128 v[244:247], v15 offset:9216
  v_mul_f32 v142, v142, v43
  v_mul_f32 v146, v146, v44
  v_mul_f32 v150, v150, v45
  v_mul_f32 v154, v154, v46
  v_mul_f32 v158, v158, v47
  v_mfma_f32_32x32x16_bf16 v[208:223], a[204:207], v[252:255], v[208:223]
  v_cvt_pk_bf16_f32 v48, v130, v134
  v_cvt_pk_bf16_f32 v49, v138, v142
  v_cvt_pk_bf16_f32 v50, v146, v150
  v_cvt_pk_bf16_f32 v51, v154, v158
  s_waitcnt lgkmcnt(4)
  v_mfma_f32_32x32x16_bf16 v[64:79], a[0:3], v[224:227], v[64:79]
  ds_write_b128 v11, v[48:51] offset:6144
  ds_read_b128 v[248:251], v15 offset:10240
  v_mfma_f32_32x32x16_bf16 v[80:95], a[4:7], v[224:227], v[80:95]
  v_cvt_pk_bf16_f32 v16, v192, v193
  v_cvt_pk_bf16_f32 v17, v194, v195
  v_cvt_pk_bf16_f32 v18, v196, v197
  v_mfma_f32_32x32x16_bf16 v[64:79], a[8:11], v[228:231], v[64:79]
  v_cvt_pk_bf16_f32 v19, v198, v199
  v_cvt_pk_bf16_f32 v20, v200, v201
  v_cvt_pk_bf16_f32 v21, v202, v203
  v_mfma_f32_32x32x16_bf16 v[80:95], a[12:15], v[228:231], v[80:95]
  buffer_store_dwordx4 v[16:19], v2, s[8:11], s65 offen offset:0 sc1
  ds_read_b128 v[252:255], v15 offset:11264
  v_cvt_pk_bf16_f32 v22, v204, v205
  v_cvt_pk_bf16_f32 v23, v206, v207
  s_waitcnt lgkmcnt(5)
  v_mfma_f32_32x32x16_bf16 v[64:79], a[16:19], v[232:235], v[64:79]
  buffer_store_dwordx4 v[20:23], v2, s[8:11], s65 offen offset:1024 sc1
  ds_read_b128 v[224:227], v15 offset:16384
  v_cvt_pk_bf16_f32 v24, v208, v209
  v_cvt_pk_bf16_f32 v25, v210, v211
  v_cvt_pk_bf16_f32 v26, v212, v213
  v_mfma_f32_32x32x16_bf16 v[80:95], a[20:23], v[232:235], v[80:95]
  v_cvt_pk_bf16_f32 v27, v214, v215
  v_cvt_pk_bf16_f32 v28, v216, v217
  v_cvt_pk_bf16_f32 v29, v218, v219
  v_mfma_f32_32x32x16_bf16 v[64:79], a[24:27], v[236:239], v[64:79]
  buffer_store_dwordx4 v[24:27], v2, s[8:11], s65 offen offset:2048 sc1
  v_cvt_pk_bf16_f32 v30, v220, v221
  v_cvt_pk_bf16_f32 v31, v222, v223
  v_mfma_f32_32x32x16_bf16 v[80:95], a[28:31], v[236:239], v[80:95]
  buffer_store_dwordx4 v[28:31], v2, s[8:11], s65 offen offset:3072 sc1
  ds_read_b128 v[228:231], v15 offset:17408
  v_exp_f32 v40, v131
  v_exp_f32 v41, v135
  s_waitcnt lgkmcnt(5)
  v_mfma_f32_32x32x16_bf16 v[64:79], a[144:147], v[240:243], v[64:79]
  ds_read_b128 v[232:235], v15 offset:18432
  v_exp_f32 v42, v139
  v_mfma_f32_32x32x16_bf16 v[80:95], a[148:151], v[240:243], v[80:95]
  v_exp_f32 v43, v143
  v_exp_f32 v44, v147
  v_mfma_f32_32x32x16_bf16 v[64:79], a[152:155], v[244:247], v[64:79]
  ds_read_b128 v[236:239], v15 offset:19456
  v_exp_f32 v45, v151
  v_mfma_f32_32x32x16_bf16 v[80:95], a[156:159], v[244:247], v[80:95]
  v_exp_f32 v46, v155
  v_exp_f32 v47, v159
  s_waitcnt lgkmcnt(4)
  v_mfma_f32_32x32x16_bf16 v[64:79], a[32:35], v[248:251], v[64:79]
  ds_read_b128 v[240:243], v15 offset:24576
  v_fma_f32 v40, v40, 2.0, 2.0
  v_fma_f32 v41, v41, 2.0, 2.0
  v_mfma_f32_32x32x16_bf16 v[80:95], a[36:39], v[248:251], v[80:95]
  v_fma_f32 v42, v42, 2.0, 2.0
  v_fma_f32 v43, v43, 2.0, 2.0
  v_fma_f32 v44, v44, 2.0, 2.0
  v_mfma_f32_32x32x16_bf16 v[64:79], a[40:43], v[252:255], v[64:79]
  ds_read_b128 v[244:247], v15 offset:25600
  v_fma_f32 v45, v45, 2.0, 2.0
  v_fma_f32 v46, v46, 2.0, 2.0
  v_fma_f32 v47, v47, 2.0, 2.0
  v_mfma_f32_32x32x16_bf16 v[80:95], a[160:163], v[252:255], v[80:95]
  v_rcp_f32 v40, v40
  v_rcp_f32 v41, v41
  s_waitcnt lgkmcnt(4)
  v_mfma_f32_32x32x16_bf16 v[64:79], a[164:167], v[224:227], v[64:79]
  ds_read_b128 v[248:251], v15 offset:26624
  v_rcp_f32 v42, v42
  v_mfma_f32_32x32x16_bf16 v[80:95], a[168:171], v[224:227], v[80:95]
  v_rcp_f32 v43, v43
  v_rcp_f32 v44, v44
  v_mfma_f32_32x32x16_bf16 v[64:79], a[172:175], v[228:231], v[64:79]
  ds_read_b128 v[252:255], v15 offset:27648
  v_rcp_f32 v45, v45
  v_mfma_f32_32x32x16_bf16 v[80:95], a[44:47], v[228:231], v[80:95]
  v_rcp_f32 v46, v46
  v_rcp_f32 v47, v47
  s_waitcnt lgkmcnt(4)
  v_mfma_f32_32x32x16_bf16 v[64:79], a[48:51], v[232:235], v[64:79]
  v_mul_f32 v131, v131, v40
  v_mul_f32 v135, v135, v41
  v_mul_f32 v139, v139, v42
  v_mfma_f32_32x32x16_bf16 v[80:95], a[52:55], v[232:235], v[80:95]
  v_mul_f32 v143, v143, v43
  v_mul_f32 v147, v147, v44
  v_mul_f32 v151, v151, v45
  v_mfma_f32_32x32x16_bf16 v[64:79], a[56:59], v[236:239], v[64:79]
  v_mul_f32 v155, v155, v46
  v_mul_f32 v159, v159, v47
  v_cvt_pk_bf16_f32 v52, v131, v135
  v_mfma_f32_32x32x16_bf16 v[80:95], a[60:63], v[236:239], v[80:95]
  v_cvt_pk_bf16_f32 v53, v139, v143
  v_cvt_pk_bf16_f32 v54, v147, v151
  v_cvt_pk_bf16_f32 v55, v155, v159
  s_waitcnt lgkmcnt(2)
  v_mfma_f32_32x32x16_bf16 v[64:79], a[176:179], v[240:243], v[64:79]
  v_mfma_f32_32x32x16_bf16 v[80:95], a[180:183], v[240:243], v[80:95]
  ds_write_b128 v11, v[52:55] offset:7168
  v_mfma_f32_32x32x16_bf16 v[64:79], a[184:187], v[244:247], v[64:79]
  s_waitcnt lgkmcnt(0)
  s_barrier
  ds_read_b128 v[224:227], v15 offset:4096
  ds_read_b128 v[228:231], v15 offset:5120
  ds_read_b128 v[232:235], v15 offset:6144
  ds_read_b128 v[236:239], v15 offset:7168
  v_mfma_f32_32x32x16_bf16 v[80:95], a[188:191], v[244:247], v[80:95]
  v_mfma_f32_32x32x16_bf16 v[64:79], a[64:67], v[248:251], v[64:79]
  ds_read_b128 v[240:243], v15 offset:12288
  v_mfma_f32_32x32x16_bf16 v[80:95], a[68:71], v[248:251], v[80:95]
  v_mfma_f32_32x32x16_bf16 v[64:79], a[72:75], v[252:255], v[64:79]
  ds_read_b128 v[244:247], v15 offset:13312
  v_mfma_f32_32x32x16_bf16 v[80:95], a[76:79], v[252:255], v[80:95]
  s_waitcnt lgkmcnt(4)
  v_mfma_f32_32x32x16_bf16 v[64:79], a[80:83], v[224:227], v[64:79]
  ds_read_b128 v[248:251], v15 offset:14336
  v_mfma_f32_32x32x16_bf16 v[80:95], a[84:87], v[224:227], v[80:95]
  v_mfma_f32_32x32x16_bf16 v[64:79], a[88:91], v[228:231], v[64:79]
  buffer_load_dwordx4 v[160:163], v2, s[8:11], s64 offen offset:0 sc1
  ds_read_b128 v[252:255], v15 offset:15360
  v_mfma_f32_32x32x16_bf16 v[80:95], a[92:95], v[228:231], v[80:95]
  buffer_load_dwordx4 v[164:167], v2, s[8:11], s64 offen offset:1024 sc1
  s_waitcnt lgkmcnt(4)
  v_mfma_f32_32x32x16_bf16 v[64:79], a[208:211], v[232:235], v[64:79]
  buffer_load_dwordx4 v[168:171], v2, s[8:11], s64 offen offset:2048 sc1
  ds_read_b128 v[224:227], v15 offset:20480
  v_mfma_f32_32x32x16_bf16 v[80:95], a[212:215], v[232:235], v[80:95]
  buffer_load_dwordx4 v[172:175], v2, s[8:11], s64 offen offset:3072 sc1
  v_mfma_f32_32x32x16_bf16 v[64:79], a[216:219], v[236:239], v[64:79]
  ds_read_b128 v[228:231], v15 offset:21504
  v_mfma_f32_32x32x16_bf16 v[80:95], a[220:223], v[236:239], v[80:95]
  s_waitcnt lgkmcnt(4)
  v_mfma_f32_32x32x16_bf16 v[64:79], a[96:99], v[240:243], v[64:79]
  ds_read_b128 v[232:235], v15 offset:22528
  v_mfma_f32_32x32x16_bf16 v[80:95], a[100:103], v[240:243], v[80:95]
  v_mfma_f32_32x32x16_bf16 v[64:79], a[104:107], v[244:247], v[64:79]
  ds_read_b128 v[236:239], v15 offset:23552
  v_mfma_f32_32x32x16_bf16 v[80:95], a[108:111], v[244:247], v[80:95]
  s_waitcnt lgkmcnt(4)
  v_mfma_f32_32x32x16_bf16 v[64:79], a[112:115], v[248:251], v[64:79]
  ds_read_b128 v[240:243], v15 offset:28672
  v_mfma_f32_32x32x16_bf16 v[80:95], a[224:227], v[248:251], v[80:95]
  v_mfma_f32_32x32x16_bf16 v[64:79], a[228:231], v[252:255], v[64:79]
  ds_read_b128 v[244:247], v15 offset:29696
  v_mfma_f32_32x32x16_bf16 v[80:95], a[232:235], v[252:255], v[80:95]
  s_waitcnt lgkmcnt(4)
  v_mfma_f32_32x32x16_bf16 v[64:79], a[236:239], v[224:227], v[64:79]
  ds_read_b128 v[248:251], v15 offset:30720
  v_mfma_f32_32x32x16_bf16 v[80:95], a[116:119], v[224:227], v[80:95]
  v_mfma_f32_32x32x16_bf16 v[64:79], a[120:123], v[228:231], v[64:79]
  ds_read_b128 v[252:255], v15 offset:31744
  v_mfma_f32_32x32x16_bf16 v[80:95], a[124:127], v[228:231], v[80:95]
  s_waitcnt lgkmcnt(4)
  v_mfma_f32_32x32x16_bf16 v[64:79], a[240:243], v[232:235], v[64:79]
  v_mfma_f32_32x32x16_bf16 v[80:95], a[244:247], v[232:235], v[80:95]
  v_mfma_f32_32x32x16_bf16 v[64:79], a[248:251], v[236:239], v[64:79]
  v_mfma_f32_32x32x16_bf16 v[80:95], a[252:255], v[236:239], v[80:95]
  s_waitcnt lgkmcnt(2)
  v_mfma_f32_32x32x16_bf16 v[64:79], a[128:131], v[240:243], v[64:79]
  s_waitcnt vmcnt(3)
  v_max3_u32 v34, v160, v161, v162
  s_waitcnt vmcnt(2)
  v_max3_u32 v34, v34, v163, v164
  v_max3_u32 v34, v34, v165, v166
  s_waitcnt vmcnt(1)
  v_max3_u32 v34, v34, v167, v168
  v_mfma_f32_32x32x16_bf16 v[80:95], a[132:135], v[240:243], v[80:95]
  v_max3_u32 v34, v34, v169, v170
  s_waitcnt vmcnt(0)
  v_max3_u32 v34, v34, v171, v172
  v_max3_u32 v34, v34, v173, v174
  v_max_u32 v34, v34, v175
  v_mfma_f32_32x32x16_bf16 v[64:79], a[136:139], v[244:247], v[64:79]
  v_cmp_eq_u32 vcc, -1, v34
  s_nop 3
  s_cbranch_vccnz C_rb
C_gb:
  v_mfma_f32_32x32x16_bf16 v[80:95], a[140:143], v[244:247], v[80:95]
  v_lshlrev_b32 v96, 16, v160
  v_and_b32 v97, s25, v160
  v_lshlrev_b32 v98, 16, v161
  v_and_b32 v99, s25, v161
  v_lshlrev_b32 v100, 16, v162
  v_and_b32 v101, s25, v162
  s_waitcnt lgkmcnt(0)
  v_mfma_f32_32x32x16_bf16 v[64:79], a[192:195], v[248:251], v[64:79]
  v_lshlrev_b32 v102, 16, v163
  v_and_b32 v103, s25, v163
  v_lshlrev_b32 v104, 16, v164
  v_and_b32 v105, s25, v164
  v_lshlrev_b32 v106, 16, v165
  v_and_b32 v107, s25, v165
  v_lshlrev_b32 v108, 16, v166
  v_mfma_f32_32x32x16_bf16 v[80:95], a[196:199], v[248:251], v[80:95]
  v_and_b32 v109, s25, v166
  v_lshlrev_b32 v110, 16, v167
  v_and_b32 v111, s25, v167
  v_lshlrev_b32 v112, 16, v168
  v_and_b32 v113, s25, v168
  v_lshlrev_b32 v114, 16, v169
  v_mfma_f32_32x32x16_bf16 v[64:79], a[200:203], v[252:255], v[64:79]
  v_and_b32 v115, s25, v169
  v_lshlrev_b32 v116, 16, v170
  v_and_b32 v117, s25, v170
  v_lshlrev_b32 v118, 16, v171
  v_and_b32 v119, s25, v171
  v_lshlrev_b32 v120, 16, v172
  v_and_b32 v121, s25, v172
  v_mfma_f32_32x32x16_bf16 v[80:95], a[204:207], v[252:255], v[80:95]
  v_lshlrev_b32 v122, 16, v173
  v_and_b32 v123, s25, v173
  v_lshlrev_b32 v124, 16, v174
  v_and_b32 v125, s25, v174
  v_lshlrev_b32 v126, 16, v175
  v_and_b32 v127, s25, v175
  v_pk_add_f32 v[64:65], v[64:65], v[96:97]
  v_pk_add_f32 v[66:67], v[66:67], v[98:99]
  v_pk_add_f32 v[68:69], v[68:69], v[100:101]
  v_pk_add_f32 v[70:71], v[70:71], v[102:103]
  v_pk_add_f32 v[72:73], v[72:73], v[104:105]
  v_pk_add_f32 v[74:75], v[74:75], v[106:107]
  v_pk_add_f32 v[76:77], v[76:77], v[108:109]
  v_pk_add_f32 v[78:79], v[78:79], v[110:111]
  v_pk_add_f32 v[80:81], v[80:81], v[112:113]
  v_pk_add_f32 v[82:83], v[82:83], v[114:115]
  v_pk_add_f32 v[84:85], v[84:85], v[116:117]
  v_pk_add_f32 v[86:87], v[86:87], v[118:119]
  v_pk_add_f32 v[88:89], v[88:89], v[120:121]
  v_pk_add_f32 v[90:91], v[90:91], v[122:123]
  v_pk_add_f32 v[92:93], v[92:93], v[124:125]
  v_pk_add_f32 v[94:95], v[94:95], v[126:127]
  v_add_u32 v14, s66, v14
  v_xor_b32 v36, 16, v12
  v_xor_b32 v37, 32, v12
  v_xor_b32 v38, 48, v12
  s_lshl_b32 s29, s38, 14
  v_pk_add_f32 v[40:41], v[64:65], v[66:67]
  v_pk_mul_f32 v[42:43], v[64:65], v[64:65]
  v_pk_fma_f32 v[42:43], v[66:67], v[66:67], v[42:43]
  v_pk_add_f32 v[40:41], v[40:41], v[68:69]
  v_pk_fma_f32 v[42:43], v[68:69], v[68:69], v[42:43]
  v_pk_add_f32 v[40:41], v[40:41], v[70:71]
  v_pk_fma_f32 v[42:43], v[70:71], v[70:71], v[42:43]
  v_pk_add_f32 v[40:41], v[40:41], v[72:73]
  v_pk_fma_f32 v[42:43], v[72:73], v[72:73], v[42:43]
  v_pk_add_f32 v[40:41], v[40:41], v[74:75]
  v_pk_fma_f32 v[42:43], v[74:75], v[74:75], v[42:43]
  v_pk_add_f32 v[40:41], v[40:41], v[76:77]
  v_pk_fma_f32 v[42:43], v[76:77], v[76:77], v[42:43]
  v_pk_add_f32 v[40:41], v[40:41], v[78:79]
  v_pk_fma_f32 v[42:43], v[78:79], v[78:79], v[42:43]
  v_pk_add_f32 v[40:41], v[40:41], v[80:81]
  v_pk_fma_f32 v[42:43], v[80:81], v[80:81], v[42:43]
  v_pk_add_f32 v[40:41], v[40:41], v[82:83]
  v_pk_fma_f32 v[42:43], v[82:83], v[82:83], v[42:43]
  v_pk_add_f32 v[40:41], v[40:41], v[84:85]
  v_pk_fma_f32 v[42:43], v[84:85], v[84:85], v[42:43]
  v_pk_add_f32 v[40:41], v[40:41], v[86:87]
  v_pk_fma_f32 v[42:43], v[86:87], v[86:87], v[42:43]
  v_pk_add_f32 v[40:41], v[40:41], v[88:89]
  v_pk_fma_f32 v[42:43], v[88:89], v[88:89], v[42:43]
  v_pk_add_f32 v[40:41], v[40:41], v[90:91]
  v_pk_fma_f32 v[42:43], v[90:91], v[90:91], v[42:43]
  v_pk_add_f32 v[40:41], v[40:41], v[92:93]
  v_pk_fma_f32 v[42:43], v[92:93], v[92:93], v[42:43]
  v_pk_add_f32 v[40:41], v[40:41], v[94:95]
  v_pk_fma_f32 v[42:43], v[94:95], v[94:95], v[42:43]
  v_add_f32 v32, v40, v41
  v_add_f32 v33, v42, v43
  s_nop 1
  v_permlane32_swap_b32 v32, v33
  v_add_f32 v32, v32, v33
  ds_write_b32 v3, v32 offset:4608
  s_waitcnt lgkmcnt(0)
  s_barrier
  ds_read_b128 v[160:163], v4 offset:4608
  ds_read_b128 v[164:167], v4 offset:4624
  s_waitcnt lgkmcnt(1)
  v_pk_add_f32 v[160:161], v[160:161], v[162:163]
  s_waitcnt lgkmcnt(0)
  v_pk_add_f32 v[164:165], v[164:165], v[166:167]
  v_pk_add_f32 v[160:161], v[160:161], v[164:165]
  v_mul_f32 v162, 0xbb317218, v160
  v_mul_f32 v161, 0x3af5fdf0, v161
  v_fma_f32 v161, -v162, v162, v161
  v_max_f32 v161, 0, v161
  v_add_f32 v161, s39, v161
  v_rsq_f32 v33, v161
  v_mul_f32 v162, 0xbf800000, v162
  v_mul_f32 v32, v162, v33
  v_mul_f32 v33, 0xbf317218, v33
  v_pk_fma_f32 v[64:65], v[64:65], v[32:33], v[32:33] op_sel:[0,1,0] op_sel_hi:[1,1,0]
  v_pk_fma_f32 v[66:67], v[66:67], v[32:33], v[32:33] op_sel:[0,1,0] op_sel_hi:[1,1,0]
  v_pk_fma_f32 v[68:69], v[68:69], v[32:33], v[32:33] op_sel:[0,1,0] op_sel_hi:[1,1,0]
  v_pk_fma_f32 v[70:71], v[70:71], v[32:33], v[32:33] op_sel:[0,1,0] op_sel_hi:[1,1,0]
  v_pk_fma_f32 v[72:73], v[72:73], v[32:33], v[32:33] op_sel:[0,1,0] op_sel_hi:[1,1,0]
  v_pk_fma_f32 v[74:75], v[74:75], v[32:33], v[32:33] op_sel:[0,1,0] op_sel_hi:[1,1,0]
  v_pk_fma_f32 v[76:77], v[76:77], v[32:33], v[32:33] op_sel:[0,1,0] op_sel_hi:[1,1,0]
  v_pk_fma_f32 v[78:79], v[78:79], v[32:33], v[32:33] op_sel:[0,1,0] op_sel_hi:[1,1,0]
  v_pk_fma_f32 v[80:81], v[80:81], v[32:33], v[32:33] op_sel:[0,1,0] op_sel_hi:[1,1,0]
  v_pk_fma_f32 v[82:83], v[82:83], v[32:33], v[32:33] op_sel:[0,1,0] op_sel_hi:[1,1,0]
  v_pk_fma_f32 v[84:85], v[84:85], v[32:33], v[32:33] op_sel:[0,1,0] op_sel_hi:[1,1,0]
  v_pk_fma_f32 v[86:87], v[86:87], v[32:33], v[32:33] op_sel:[0,1,0] op_sel_hi:[1,1,0]
  v_pk_fma_f32 v[88:89], v[88:89], v[32:33], v[32:33] op_sel:[0,1,0] op_sel_hi:[1,1,0]
  v_pk_fma_f32 v[90:91], v[90:91], v[32:33], v[32:33] op_sel:[0,1,0] op_sel_hi:[1,1,0]
  v_pk_fma_f32 v[92:93], v[92:93], v[32:33], v[32:33] op_sel:[0,1,0] op_sel_hi:[1,1,0]
  v_pk_fma_f32 v[94:95], v[94:95], v[32:33], v[32:33] op_sel:[0,1,0] op_sel_hi:[1,1,0]
  v_cvt_pk_bf16_f32 v40, v64, v68
  v_cvt_pk_bf16_f32 v41, v72, v76
  v_cvt_pk_bf16_f32 v42, v80, v84
  v_cvt_pk_bf16_f32 v43, v88, v92
  ds_write_b128 v12, v[40:43] offset:0
  v_cvt_pk_bf16_f32 v44, v65, v69
  v_cvt_pk_bf16_f32 v45, v73, v77
  v_cvt_pk_bf16_f32 v46, v81, v85
  v_cvt_pk_bf16_f32 v47, v89, v93
  ds_write_b128 v36, v[44:47] offset:0
  v_cvt_pk_bf16_f32 v48, v66, v70
  v_cvt_pk_bf16_f32 v49, v74, v78
  v_cvt_pk_bf16_f32 v50, v82, v86
  v_cvt_pk_bf16_f32 v51, v90, v94
  ds_write_b128 v37, v[48:51] offset:0
  v_cvt_pk_bf16_f32 v52, v67, v71
  v_cvt_pk_bf16_f32 v53, v75, v79
  v_cvt_pk_bf16_f32 v54, v83, v87
  v_cvt_pk_bf16_f32 v55, v91, v95
  ds_write_b128 v38, v[52:55] offset:0
  ds_read_b128 v[96:99], v13 offset:0
  ds_read_b128 v[100:103], v13 offset:1024
  ds_read_b128 v[104:107], v13 offset:2048
  ds_read_b128 v[108:111], v13 offset:3072
  s_waitcnt lgkmcnt(3)
  buffer_store_dwordx4 v[96:99], v14, s[16:19], s29 offen
  s_addk_i32 s29, 0x1000
  s_waitcnt lgkmcnt(2)
  buffer_store_dwordx4 v[100:103], v14, s[16:19], s29 offen
  s_addk_i32 s29, 0x1000
  s_waitcnt lgkmcnt(1)
  buffer_store_dwordx4 v[104:107], v14, s[16:19], s29 offen
  s_addk_i32 s29, 0x1000
  s_waitcnt lgkmcnt(0)
  buffer_store_dwordx4 v[108:111], v14, s[16:19], s29 offen
B_exit:
  s_endpgm
B_fallback:
  s_waitcnt vmcnt(0)
  s_mov_b32 s36, 0
  v_mov_b32 v212, 0xff7fffff
B_fb1:
  buffer_load_dwordx4 a[192:195], v1, s[4:7], s36 offen offset:0
  buffer_load_dwordx4 a[196:199], v1, s[4:7], s36 offen offset:1024
  buffer_load_dwordx4 a[200:203], v1, s[4:7], s36 offen offset:2048
  buffer_load_dwordx4 a[204:207], v1, s[4:7], s36 offen offset:3072
  s_waitcnt vmcnt(3)
  v_mfma_f32_32x32x16_bf16 v[16:31], a[192:195], a[128:131], 0
  s_waitcnt vmcnt(2)
  v_mfma_f32_32x32x16_bf16 v[16:31], a[196:199], a[132:135], v[16:31]
  s_waitcnt vmcnt(1)
  v_mfma_f32_32x32x16_bf16 v[16:31], a[200:203], a[136:139], v[16:31]
  s_waitcnt vmcnt(0)
  v_mfma_f32_32x32x16_bf16 v[16:31], a[204:207], a[140:143], v[16:31]
  s_nop 11
  v_max3_f32 v212, v212, v16, v17
  v_max3_f32 v212, v212, v18, v19
  v_max3_f32 v212, v212, v20, v21
  v_max3_f32 v212, v212, v22, v23
  v_max3_f32 v212, v212, v24, v25
  v_max3_f32 v212, v212, v26, v27
  v_max3_f32 v212, v212, v28, v29
  v_max3_f32 v212, v212, v30, v31
  s_add_u32 s36, s36, 0x2000
  s_cmp_lt_u32 s36, 0xfa000
  s_cbranch_scc1 B_fb1
  v_mov_b32 v213, v212
  s_nop 1
  v_permlane32_swap_b32 v213, v212
  v_max_f32 v212, v212, v213
  v_pk_add_f32 v[64:65], v[212:213], 0 op_sel_hi:[0,0] neg_lo:[1,0] neg_hi:[1,0]
  v_pk_add_f32 v[66:67], v[212:213], 0 op_sel_hi:[0,0] neg_lo:[1,0] neg_hi:[1,0]
  v_pk_add_f32 v[68:69], v[212:213], 0 op_sel_hi:[0,0] neg_lo:[1,0] neg_hi:[1,0]
  v_pk_add_f32 v[70:71], v[212:213], 0 op_sel_hi:[0,0] neg_lo:[1,0] neg_hi:[1,0]
  v_pk_add_f32 v[72:73], v[212:213], 0 op_sel_hi:[0,0] neg_lo:[1,0] neg_hi:[1,0]
  v_pk_add_f32 v[74:75], v[212:213], 0 op_sel_hi:[0,0] neg_lo:[1,0] neg_hi:[1,0]
  v_pk_add_f32 v[76:77], v[212:213], 0 op_sel_hi:[0,0] neg_lo:[1,0] neg_hi:[1,0]
  v_pk_add_f32 v[78:79], v[212:213], 0 op_sel_hi:[0,0] neg_lo:[1,0] neg_hi:[1,0]
  v_mov_b32 v220, 0
  v_mov_b32 v221, 0
  v_mov_b32 v222, 0
  v_mov_b32 v223, 0
  v_mov_b32 v224, 0
  v_mov_b32 v225, 0
  v_mov_b32 v226, 0
  v_mov_b32 v227, 0
  v_mov_b32 v228, 0
  v_mov_b32 v229, 0
  v_mov_b32 v230, 0
  v_mov_b32 v231, 0
  v_mov_b32 v232, 0
  v_mov_b32 v233, 0
  v_mov_b32 v234, 0
  v_mov_b32 v235, 0
  v_mov_b32 v236, 0
  v_mov_b32 v237, 0
  v_mov_b32 v238, 0
  v_mov_b32 v239, 0
  v_mov_b32 v240, 0
  v_mov_b32 v241, 0
  v_mov_b32 v242, 0
  v_mov_b32 v243, 0
  v_mov_b32 v244, 0
  v_mov_b32 v245, 0
  v_mov_b32 v246, 0
  v_mov_b32 v247, 0
  v_mov_b32 v248, 0
  v_mov_b32 v249, 0
  v_mov_b32 v250, 0
  v_mov_b32 v251, 0
  v_mov_b32 v192, 0
  v_mov_b32 v193, 0
  v_mov_b32 v194, 0
  v_mov_b32 v195, 0
  s_mov_b32 s36, 0
B_fb2:
  buffer_load_dwordx4 a[192:195], v1, s[4:7], s36 offen offset:0
  buffer_load_dwordx4 a[196:199], v1, s[4:7], s36 offen offset:1024
  buffer_load_dwordx4 a[200:203], v1, s[4:7], s36 offen offset:2048
  buffer_load_dwordx4 a[204:207], v1, s[4:7], s36 offen offset:3072
  buffer_load_dwordx4 v[128:131], v2, s[4:7], s36 offen offset:0
  buffer_load_dwordx4 v[132:135], v2, s[4:7], s36 offen offset:1024
  buffer_load_dwordx4 v[136:139], v2, s[4:7], s36 offen offset:2048
  buffer_load_dwordx4 v[140:143], v2, s[4:7], s36 offen offset:3072
  s_waitcnt vmcnt(7)
  v_mfma_f32_32x32x16_bf16 v[16:31], a[192:195], a[128:131], v[64:79]
  s_waitcnt vmcnt(6)
  v_mfma_f32_32x32x16_bf16 v[16:31], a[196:199], a[132:135], v[16:31]
  s_waitcnt vmcnt(5)
  v_mfma_f32_32x32x16_bf16 v[16:31], a[200:203], a[136:139], v[16:31]
  s_waitcnt vmcnt(4)
  v_mfma_f32_32x32x16_bf16 v[16:31], a[204:207], a[140:143], v[16:31]
  s_nop 11
  v_exp_f32 v16, v16
  v_exp_f32 v17, v17
  v_exp_f32 v18, v18
  v_exp_f32 v19, v19
  v_exp_f32 v20, v20
  v_exp_f32 v21, v21
  v_exp_f32 v22, v22
  v_exp_f32 v23, v23
  v_exp_f32 v24, v24
  v_exp_f32 v25, v25
  v_exp_f32 v26, v26
  v_exp_f32 v27, v27
  v_exp_f32 v28, v28
  v_exp_f32 v29, v29
  v_exp_f32 v216, v30
  v_exp_f32 v217, v31
  v_cvt_pk_bf16_f32 v48, v16, v17
  v_cvt_pk_bf16_f32 v49, v18, v19
  v_cvt_pk_bf16_f32 v50, v20, v21
  v_cvt_pk_bf16_f32 v51, v22, v23
  v_cvt_pk_bf16_f32 v52, v24, v25
  v_cvt_pk_bf16_f32 v53, v26, v27
  v_cvt_pk_bf16_f32 v54, v28, v29
  v_cvt_pk_bf16_f32 v55, v216, v217
  s_waitcnt vmcnt(3)
  v_mfma_f32_32x32x16_bf16 v[220:235], v[128:131], v[48:51], v[220:235]
  s_waitcnt vmcnt(1)
  v_mfma_f32_32x32x16_bf16 v[236:251], v[136:139], v[48:51], v[236:251]
  v_mfma_f32_32x32x16_bf16 v[220:235], v[132:135], v[52:55], v[220:235]
  s_waitcnt vmcnt(0)
  v_mfma_f32_32x32x16_bf16 v[236:251], v[140:143], v[52:55], v[236:251]
  v_smfmac_f32_16x16x64_bf16 v[192:195], v[208:211], v[48:55], v218
  s_add_u32 s36, s36, 0x2000
  s_cmp_lt_u32 s36, 0xfa000
  s_cbranch_scc1 B_fb2
  s_nop 4
  v_add_f32 v8, v192, v193
  s_branch B_fin
B_gate:
  buffer_load_dword v219, v7, s[8:11], s13 offen sc1
  s_add_u32 s59, s59, 1
  s_waitcnt vmcnt(0)
  v_cmp_ne_u32 vcc, -1, v219
  s_nop 3
  s_cbranch_vccz B_open
  s_cmp_lt_u32 s59, 0x4000
  s_cbranch_scc1 B_gate
  s_branch B_open
C_rh0:
  buffer_load_dwordx4 v[224:227], v62, s[8:11], s58 offen offset:0 sc1
  buffer_load_dwordx4 v[228:231], v60, s[8:11], s58 offen offset:1024 sc1
  s_add_u32 s59, s59, 1
  s_waitcnt vmcnt(1)
  v_max3_u32 v222, v224, v225, v226
  s_waitcnt vmcnt(0)
  v_max3_u32 v222, v222, v227, v228
  v_max3_u32 v222, v222, v229, v230
  v_max_u32 v222, v222, v231
  v_cmp_eq_u32 vcc, -1, v222
  s_nop 3
  s_cbranch_vccz C_gh0
  s_cmp_lt_u32 s59, 0x4000
  s_cbranch_scc1 C_rh0
  s_branch C_gh0
C_rh1:
  buffer_load_dwordx4 v[232:235], v62, s[8:11], s58 offen offset:2048 sc1
  buffer_load_dwordx4 v[236:239], v60, s[8:11], s58 offen offset:3072 sc1
  s_add_u32 s59, s59, 1
  s_waitcnt vmcnt(1)
  v_max3_u32 v222, v232, v233, v234
  s_waitcnt vmcnt(0)
  v_max3_u32 v222, v222, v235, v236
  v_max3_u32 v222, v222, v237, v238
  v_max_u32 v222, v222, v239
  v_cmp_eq_u32 vcc, -1, v222
  s_nop 3
  s_cbranch_vccz C_gh1
  s_cmp_lt_u32 s59, 0x4000
  s_cbranch_scc1 C_rh1
  s_branch C_gh1
C_ra:
  buffer_load_dwordx4 v[16:19], v1, s[8:11], s64 offen offset:0 sc1
  buffer_load_dwordx4 v[20:23], v1, s[8:11], s64 offen offset:1024 sc1
  buffer_load_dwordx4 v[24:27], v1, s[8:11], s64 offen offset:2048 sc1
  buffer_load_dwordx4 v[28:31], v1, s[8:11], s64 offen offset:3072 sc1
  s_add_u32 s59, s59, 1
  s_waitcnt vmcnt(3)
  v_max3_u32 v34, v16, v17, v18
  s_waitcnt vmcnt(2)
  v_max3_u32 v34, v34, v19, v20
  v_max3_u32 v34, v34, v21, v22
  s_waitcnt vmcnt(1)
  v_max3_u32 v34, v34, v23, v24
  v_max3_u32 v34, v34, v25, v26
  s_waitcnt vmcnt(0)
  v_max3_u32 v34, v34, v27, v28
  v_max3_u32 v34, v34, v29, v30
  v_max_u32 v34, v34, v31
  v_cmp_eq_u32 vcc, -1, v34
  s_nop 3
  s_cbranch_vccz C_ga
  s_cmp_lt_u32 s59, 0x4000
  s_cbranch_scc1 C_ra
  s_branch C_ga
C_rb:
  buffer_load_dwordx4 v[160:163], v2, s[8:11], s64 offen offset:0 sc1
  buffer_load_dwordx4 v[164:167], v2, s[8:11], s64 offen offset:1024 sc1
  buffer_load_dwordx4 v[168:171], v2, s[8:11], s64 offen offset:2048 sc1
  buffer_load_dwordx4 v[172:175], v2, s[8:11], s64 offen offset:3072 sc1
  s_add_u32 s59, s59, 1
  s_waitcnt vmcnt(3)
  v_max3_u32 v34, v160, v161, v162
  s_waitcnt vmcnt(2)
  v_max3_u32 v34, v34, v163, v164
  v_max3_u32 v34, v34, v165, v166
  s_waitcnt vmcnt(1)
  v_max3_u32 v34, v34, v167, v168
  v_max3_u32 v34, v34, v169, v170
  s_waitcnt vmcnt(0)
  v_max3_u32 v34, v34, v171, v172
  v_max3_u32 v34, v34, v173, v174
  v_max_u32 v34, v34, v175
  v_cmp_eq_u32 vcc, -1, v34
  s_nop 3
  s_cbranch_vccz C_gb
  s_cmp_lt_u32 s59, 0x4000
  s_cbranch_scc1 C_rb
  s_branch C_gb
end_standalone__conformer_family_zipformer__speech_kernel:
.section .rodata,"a"
.p2align 6
.amdhsa_kernel zf_a_kernel
  .amdhsa_next_free_vgpr 512
  .amdhsa_next_free_sgpr 102
  .amdhsa_accum_offset 256
  .amdhsa_group_segment_fixed_size 0
  .amdhsa_kernarg_size 104
  .amdhsa_user_sgpr_count 2
  .amdhsa_user_sgpr_kernarg_segment_ptr 1
  .amdhsa_system_sgpr_workgroup_id_x 1
.end_amdhsa_kernel
.p2align 6
.amdhsa_kernel standalone__conformer_family_zipformer__speech_kernel
  .amdhsa_next_free_vgpr 512
  .amdhsa_next_free_sgpr 102
  .amdhsa_accum_offset 256
  .amdhsa_group_segment_fixed_size 0
  .amdhsa_kernarg_size 104
  .amdhsa_user_sgpr_count 2
  .amdhsa_user_sgpr_kernarg_segment_ptr 1
  .amdhsa_system_sgpr_workgroup_id_x 1
.end_amdhsa_kernel
```
